```python
import torch

def _softmax(x, axis=-1):
    return torch.softmax(x, dim=axis)
def _gelu(x):
    return torch.nn.functional.gelu(x, approximate="tanh")
def _silu(x):
    return torch.nn.functional.silu(x)
def _sigmoid(x):
    return torch.sigmoid(x)
def _layernorm(x, axis=-1, eps=1e-5):
    m = x.mean(dim=axis, keepdim=True)
    v = x.var(dim=axis, keepdim=True, unbiased=False)
    return (x - m) / torch.sqrt(v + eps)
def _scatter_add(tgt, idx, src, axis=0):
    return tgt.clone().index_add_(axis, idx, src)
def _segment_sum(src, seg, n):
    out = torch.zeros((n,) + src.shape[1:], dtype=src.dtype)
    return out.index_add_(0, seg, src)
def _pad(x, pw):
    flat = tuple(v for pair in reversed(pw) for v in pair)
    return torch.nn.functional.pad(x, flat)

kernel_name = 'interleave_layers__spectral_gfnet__glu_gated_geglu__prompt'

def setup_inputs():

    _w = (lambda a: (lambda t: t.to(torch.bfloat16) if t.is_floating_point() else t)(torch.as_tensor(a)))
    def _A_setup():
        B, S, D = 1, 2048, 512
        Df = D // 2 + 1
        return {
            "x": _w((lambda *s: torch.randn(*s, dtype=torch.bfloat16) * 0.05)(B, S, D)),
            "w_r": _w((lambda *s: torch.randn(*s, dtype=torch.bfloat16) * 0.4)(S, Df) * 0.02),
            "w_i": _w((lambda *s: torch.randn(*s, dtype=torch.bfloat16) * 0.4)(S, Df) * 0.02),
        }
    _A_in = _A_setup()

    def _B_setup():
        B, S, Dm, Df = 1, 2048, 512, 1376
        return {
            "x": _w((lambda *s: torch.randn(*s, dtype=torch.bfloat16) * 0.05)(B, S, Dm)),
            "w_gate": _w((lambda *s: torch.randn(*s, dtype=torch.bfloat16) * 0.4)(Dm, Df) * (Dm ** -0.5)),
            "w_up": _w((lambda *s: torch.randn(*s, dtype=torch.bfloat16) * 0.4)(Dm, Df) * (Dm ** -0.5)),
            "w_down": _w((lambda *s: torch.randn(*s, dtype=torch.bfloat16) * 0.4)(Df, Dm) * (Df ** -0.5)),
        }
    _B_in = _B_setup()

    return {
        "A_x": _A_in["x"],
        "A_w_r": _A_in["w_r"],
        "A_w_i": _A_in["w_i"],
        "B_x": _B_in["x"],
        "B_w_gate": _B_in["w_gate"],
        "B_w_up": _B_in["w_up"],
        "B_w_down": _B_in["w_down"],
    }

def reference(A_x, A_w_r, A_w_i, B_x, B_w_gate, B_w_up, B_w_down):
    def _A_ref(x, w_r, w_i):
        B, S, D = x.shape
        X = (lambda x, axes=(-2,-1): torch.fft.rfft2(x.float(), dim=axes))(x, axes=(-2, -1))
        W = w_r + 1j * w_i
        X = X * W
        y = (lambda x, s, axes=(-2,-1): torch.fft.irfft2(x, s=s, dim=axes).to(torch.bfloat16))(X, (S, D), axes=(-2, -1))
        return y

    def _B_ref(x, w_gate, w_up, w_down):
        g = torch.einsum("bsd,df->bsf", x, w_gate)
        u = torch.einsum("bsd,df->bsf", x, w_up)
        h = _gelu(g) * u
        return torch.einsum("bsf,fd->bsd", h, w_down)

    x = A_x
    x = x + _A_ref(_layernorm(x, axis=-1), A_w_r, A_w_i)
    x = x + _B_ref(_layernorm(x, axis=-1), B_w_gate, B_w_up, B_w_down)
    x = x + _A_ref(_layernorm(x, axis=-1), A_w_r, A_w_i)
    x = x + _B_ref(_layernorm(x, axis=-1), B_w_gate, B_w_up, B_w_down)
    return x
```

```asm
; @launch grid=(256,1,1) block=(512,1,1) lds=163840
.amdgcn_target "amdgcn-amd-amdhsa--gfx950"
.text
.globl interleave_layers__spectral_gfnet__glu_gated_geglu__prompt_kernel
.p2align 8
.type interleave_layers__spectral_gfnet__glu_gated_geglu__prompt_kernel,@function
interleave_layers__spectral_gfnet__glu_gated_geglu__prompt_kernel:
    s_cmp_ge_u32 s2, 256
    s_cbranch_scc1 L_END_m
    s_load_dwordx16 s[64:79], s[0:1], 0
    s_load_dwordx4 s[80:83], s[0:1], 64
    v_and_b32 v1, 63, v0
    v_lshrrev_b32 v6, 6, v0
    v_and_b32 v2, 31, v0
    v_bfe_u32 v3, v0, 5, 1
    v_readfirstlane_b32 s3, v6
    v_and_b32 v4, 15, v0
    v_bfe_u32 v5, v0, 4, 2
    s_waitcnt lgkmcnt(0)
    s_mov_b32 s4, s82
    s_mov_b32 s5, s83
    s_mov_b32 s6, 33554432
    s_mov_b32 s7, 0x20000
    s_mov_b32 s8, s64
    s_mov_b32 s9, s65
    s_mov_b32 s10, 2097152
    s_mov_b32 s11, 0x20000
    s_mov_b32 s16, s66
    s_mov_b32 s17, s67
    s_mov_b32 s18, 1052672
    s_mov_b32 s19, 0x20000
    s_mov_b32 s20, s68
    s_mov_b32 s21, s69
    s_mov_b32 s22, 1052672
    s_mov_b32 s23, 0x20000
    s_mov_b32 s24, s72
    s_mov_b32 s25, s73
    s_mov_b32 s26, 1409024
    s_mov_b32 s27, 0x20000
    s_mov_b32 s28, s74
    s_mov_b32 s29, s75
    s_mov_b32 s30, 1409024
    s_mov_b32 s31, 0x20000
    s_mov_b32 s32, s76
    s_mov_b32 s33, s77
    s_mov_b32 s34, 1409024
    s_mov_b32 s35, 0x20000
    s_mov_b32 s12, s78
    s_mov_b32 s13, s79
    s_mov_b32 s14, 2097152
    s_mov_b32 s15, 0x20000
    s_mov_b32 s36, s80
    s_mov_b32 s37, s81
    s_mov_b32 s38, 256
    s_mov_b32 s39, 0x20000
    s_mov_b32 s93, 0
    s_or_b32 s91, s2, s3
    s_cmp_eq_u32 s91, 0
    s_cbranch_scc0 L_m_NM1
    s_memrealtime s[94:95]
    s_waitcnt lgkmcnt(0)
    s_or_b32 s94, s94, 1
    v_mov_b32 v8, s94
    v_mov_b32 v9, 0
    s_mov_b64 exec, 1
    buffer_store_dword v8, v9, s[36:39], 0 offen sc0 sc1
    s_mov_b64 exec, -1
L_m_NM1:
    s_cmp_ge_u32 s2, 128
    s_nop 1
    s_cbranch_scc1 L_NONCOL0
    s_and_b32 s48, s2, 7
    s_lshr_b32 s53, s2, 5
    s_lshl_b32 s53, s53, 3
    s_add_u32 s48, s48, s53
    s_bfe_u32 s49, s2, 0x20003
    s_and_b32 s50, s3, 3
    s_lshr_b32 s51, s3, 2
    s_lshl_b32 s52, s49, 2
    s_add_u32 s52, s52, s50
    s_and_b32 s53, s48, 1
    s_lshl_b32 s53, s53, 20
    s_lshr_b32 s54, s48, 1
    s_lshl_b32 s54, s54, 10
    s_add_u32 s58, s53, s54
    v_lshrrev_b32 v6, 3, v1
    v_mul_u32_u24 v6, 32768, v6
    v_and_b32 v7, 7, v1
    v_xor_b32 v8, v7, v5
    v_lshl_add_u32 v9, v8, 4, v6
    v_xor_b32 v8, 4, v8
    v_lshl_add_u32 v10, v8, 4, v6
    s_lshl_b32 s62, s3, 7
    s_add_u32 s62, s62, s58
    s_lshl_b32 s61, s3, 12
    s_mov_b32 m0, s61
    s_nop 0
    buffer_load_dwordx4 v9, s[8:11], s62 offen lds
    s_add_u32 s61, s61, 1024
    s_add_u32 s62, s62, 262144
    s_mov_b32 m0, s61
    s_nop 0
    buffer_load_dwordx4 v10, s[8:11], s62 offen lds
    s_add_u32 s61, s61, 1024
    s_add_u32 s62, s62, 262144
    s_mov_b32 m0, s61
    s_nop 0
    buffer_load_dwordx4 v9, s[8:11], s62 offen lds
    s_add_u32 s61, s61, 1024
    s_add_u32 s62, s62, 262144
    s_mov_b32 m0, s61
    s_nop 0
    buffer_load_dwordx4 v10, s[8:11], s62 offen lds
    s_and_b32 s45, s2, 3
    s_bfe_u32 s46, s2, 0x20002
    s_lshr_b32 s47, s2, 4
    v_lshrrev_b32 v6, 2, v0
    v_lshrrev_b32 v7, 3, v6
    v_and_b32 v8, 7, v6
    v_and_b32 v9, 3, v8
    v_lshrrev_b32 v10, 2, v8
    v_lshl_add_u32 v9, v10, 4, v9
    s_lshl_b32 s53, s45, 2
    v_add_u32 v9, s53, v9
    v_lshlrev_b32 v9, 6, v9
    s_lshl_b32 s53, s46, 4
    v_add3_u32 v9, v9, v7, s53
    v_mul_u32_u24 v9, 514, v9
    v_and_b32 v10, 3, v0
    v_lshlrev_b32 v10, 2, v10
    s_lshl_b32 s53, s47, 4
    v_add_u32 v10, s53, v10
    v_lshl_add_u32 v11, v10, 1, v9
    buffer_load_dwordx2 v[112:113], v11, s[16:19], 0 offen offset:0
    buffer_load_dwordx2 v[114:115], v11, s[20:23], 0 offen offset:0
    buffer_load_dwordx2 v[128:129], v11, s[16:19], 0 offen offset:256
    buffer_load_dwordx2 v[130:131], v11, s[20:23], 0 offen offset:256
    buffer_load_ushort v116, v9, s[16:19], 0 offen offset:512
    buffer_load_ushort v117, v9, s[20:23], 0 offen offset:512
    v_cmp_eq_u32 vcc, 0, v10
    s_nop 1
    v_cndmask_b32 v118, 0, -1, vcc
    v_and_b32 v10, 3, v0
    v_lshlrev_b32 v10, 11, v10
    v_lshl_add_u32 v10, v7, 5, v10
    v_lshl_add_u32 v120, v8, 2, v10
    v_add_u32 v120, 116736, v120
    s_lshl_b32 s63, s52, 5
    v_add_u32 v243, s63, v2
    v_lshrrev_b32 v240, 1, v243
    v_and_b32 v241, 1, v243
    v_cvt_f32_u32 v241, v241
    v_mul_f32 v241, 0x3e800000, v241
    v_mov_b32 v242, 0x3d800000
    v_mov_b32 v244, 0x3d3504f3
    v_cmp_gt_u32 vcc, 2, v243
    s_nop 1
    v_cndmask_b32 v242, v242, v244, vcc
    v_mov_b32 v244, 0
    v_cndmask_b32 v241, v241, v244, vcc
    v_mov_b32 v244, 256
    v_cmp_eq_u32 vcc, 0, v243
    s_nop 1
    v_cndmask_b32 v240, v240, v244, vcc
    v_cvt_f32_u32 v240, v240
    v_mul_f32 v240, 0x3b000000, v240
    s_lshl_b32 s53, s51, 4
    s_sub_u32 s53, s53, 1
    s_lshl_b32 s53, s53, 4
    v_lshl_add_u32 v243, v3, 3, s53
    v_cvt_f32_i32 v243, v243
    v_fma_f32 v243, v240, v243, v241
    v_mul_f32 v153, 0x41800000, v240
    v_fract_f32 v154, v153
    v_cos_f32 v152, v154
    v_mov_b32 v154, v243
    v_add_f32 v152, v152, v152
    v_fract_f32 v136, v154
    v_add_f32 v144, v154, v153
    v_fract_f32 v144, v144
    v_add_f32 v154, v154, v240
    v_fract_f32 v137, v154
    v_add_f32 v145, v154, v153
    v_fract_f32 v145, v145
    v_add_f32 v154, v154, v240
    v_fract_f32 v138, v154
    v_add_f32 v146, v154, v153
    v_fract_f32 v146, v146
    v_add_f32 v154, v154, v240
    v_fract_f32 v139, v154
    v_add_f32 v147, v154, v153
    v_fract_f32 v147, v147
    v_add_f32 v154, v154, v240
    v_fract_f32 v140, v154
    v_add_f32 v148, v154, v153
    v_fract_f32 v148, v148
    v_add_f32 v154, v154, v240
    v_fract_f32 v141, v154
    v_add_f32 v149, v154, v153
    v_fract_f32 v149, v149
    v_add_f32 v154, v154, v240
    v_fract_f32 v142, v154
    v_add_f32 v150, v154, v153
    v_fract_f32 v150, v150
    v_add_f32 v154, v154, v240
    v_fract_f32 v143, v154
    v_add_f32 v151, v154, v153
    v_fract_f32 v151, v151
    v_cos_f32 v136, v136
    v_cos_f32 v144, v144
    v_cos_f32 v137, v137
    v_cos_f32 v145, v145
    v_cos_f32 v138, v138
    v_cos_f32 v146, v146
    v_cos_f32 v139, v139
    v_cos_f32 v147, v147
    v_cos_f32 v140, v140
    v_cos_f32 v148, v148
    v_cos_f32 v141, v141
    v_cos_f32 v149, v149
    v_cos_f32 v142, v142
    v_cos_f32 v150, v150
    v_cos_f32 v143, v143
    v_cos_f32 v151, v151
    v_mul_f32 v136, v136, v242
    v_mul_f32 v144, v144, v242
    v_mul_f32 v137, v137, v242
    v_mul_f32 v145, v145, v242
    v_mul_f32 v138, v138, v242
    v_mul_f32 v146, v146, v242
    v_mul_f32 v139, v139, v242
    v_mul_f32 v147, v147, v242
    v_mul_f32 v140, v140, v242
    v_mul_f32 v148, v148, v242
    v_mul_f32 v141, v141, v242
    v_mul_f32 v149, v149, v242
    v_mul_f32 v142, v142, v242
    v_mul_f32 v150, v150, v242
    v_mul_f32 v143, v143, v242
    v_mul_f32 v151, v151, v242
    v_cvt_pk_bf16_f32 v176, v144, v145
    v_cvt_pk_bf16_f32 v177, v146, v147
    v_cvt_pk_bf16_f32 v178, v148, v149
    v_cvt_pk_bf16_f32 v179, v150, v151
    v_pk_fma_f32 v[136:137], v[152:153], v[144:145], v[136:137] op_sel_hi:[0,1,1] neg_lo:[0,0,1] neg_hi:[0,0,1]
    v_pk_fma_f32 v[138:139], v[152:153], v[146:147], v[138:139] op_sel_hi:[0,1,1] neg_lo:[0,0,1] neg_hi:[0,0,1]
    v_pk_fma_f32 v[140:141], v[152:153], v[148:149], v[140:141] op_sel_hi:[0,1,1] neg_lo:[0,0,1] neg_hi:[0,0,1]
    v_pk_fma_f32 v[142:143], v[152:153], v[150:151], v[142:143] op_sel_hi:[0,1,1] neg_lo:[0,0,1] neg_hi:[0,0,1]
    v_cvt_pk_bf16_f32 v180, v136, v137
    v_cvt_pk_bf16_f32 v181, v138, v139
    v_cvt_pk_bf16_f32 v182, v140, v141
    v_cvt_pk_bf16_f32 v183, v142, v143
    v_pk_fma_f32 v[144:145], v[152:153], v[136:137], v[144:145] op_sel_hi:[0,1,1] neg_lo:[0,0,1] neg_hi:[0,0,1]
    v_pk_fma_f32 v[146:147], v[152:153], v[138:139], v[146:147] op_sel_hi:[0,1,1] neg_lo:[0,0,1] neg_hi:[0,0,1]
    v_pk_fma_f32 v[148:149], v[152:153], v[140:141], v[148:149] op_sel_hi:[0,1,1] neg_lo:[0,0,1] neg_hi:[0,0,1]
    v_pk_fma_f32 v[150:151], v[152:153], v[142:143], v[150:151] op_sel_hi:[0,1,1] neg_lo:[0,0,1] neg_hi:[0,0,1]
    v_cvt_pk_bf16_f32 v184, v144, v145
    v_cvt_pk_bf16_f32 v185, v146, v147
    v_cvt_pk_bf16_f32 v186, v148, v149
    v_cvt_pk_bf16_f32 v187, v150, v151
    v_pk_fma_f32 v[136:137], v[152:153], v[144:145], v[136:137] op_sel_hi:[0,1,1] neg_lo:[0,0,1] neg_hi:[0,0,1]
    v_pk_fma_f32 v[138:139], v[152:153], v[146:147], v[138:139] op_sel_hi:[0,1,1] neg_lo:[0,0,1] neg_hi:[0,0,1]
    v_pk_fma_f32 v[140:141], v[152:153], v[148:149], v[140:141] op_sel_hi:[0,1,1] neg_lo:[0,0,1] neg_hi:[0,0,1]
    v_pk_fma_f32 v[142:143], v[152:153], v[150:151], v[142:143] op_sel_hi:[0,1,1] neg_lo:[0,0,1] neg_hi:[0,0,1]
    v_cvt_pk_bf16_f32 v188, v136, v137
    v_cvt_pk_bf16_f32 v189, v138, v139
    v_cvt_pk_bf16_f32 v190, v140, v141
    v_cvt_pk_bf16_f32 v191, v142, v143
    v_pk_fma_f32 v[144:145], v[152:153], v[136:137], v[144:145] op_sel_hi:[0,1,1] neg_lo:[0,0,1] neg_hi:[0,0,1]
    v_pk_fma_f32 v[146:147], v[152:153], v[138:139], v[146:147] op_sel_hi:[0,1,1] neg_lo:[0,0,1] neg_hi:[0,0,1]
    v_pk_fma_f32 v[148:149], v[152:153], v[140:141], v[148:149] op_sel_hi:[0,1,1] neg_lo:[0,0,1] neg_hi:[0,0,1]
    v_pk_fma_f32 v[150:151], v[152:153], v[142:143], v[150:151] op_sel_hi:[0,1,1] neg_lo:[0,0,1] neg_hi:[0,0,1]
    v_cvt_pk_bf16_f32 v192, v144, v145
    v_cvt_pk_bf16_f32 v193, v146, v147
    v_cvt_pk_bf16_f32 v194, v148, v149
    v_cvt_pk_bf16_f32 v195, v150, v151
    v_pk_fma_f32 v[136:137], v[152:153], v[144:145], v[136:137] op_sel_hi:[0,1,1] neg_lo:[0,0,1] neg_hi:[0,0,1]
    v_pk_fma_f32 v[138:139], v[152:153], v[146:147], v[138:139] op_sel_hi:[0,1,1] neg_lo:[0,0,1] neg_hi:[0,0,1]
    v_pk_fma_f32 v[140:141], v[152:153], v[148:149], v[140:141] op_sel_hi:[0,1,1] neg_lo:[0,0,1] neg_hi:[0,0,1]
    v_pk_fma_f32 v[142:143], v[152:153], v[150:151], v[142:143] op_sel_hi:[0,1,1] neg_lo:[0,0,1] neg_hi:[0,0,1]
    v_cvt_pk_bf16_f32 v196, v136, v137
    v_cvt_pk_bf16_f32 v197, v138, v139
    v_cvt_pk_bf16_f32 v198, v140, v141
    v_cvt_pk_bf16_f32 v199, v142, v143
    v_pk_fma_f32 v[144:145], v[152:153], v[136:137], v[144:145] op_sel_hi:[0,1,1] neg_lo:[0,0,1] neg_hi:[0,0,1]
    v_pk_fma_f32 v[146:147], v[152:153], v[138:139], v[146:147] op_sel_hi:[0,1,1] neg_lo:[0,0,1] neg_hi:[0,0,1]
    v_pk_fma_f32 v[148:149], v[152:153], v[140:141], v[148:149] op_sel_hi:[0,1,1] neg_lo:[0,0,1] neg_hi:[0,0,1]
    v_pk_fma_f32 v[150:151], v[152:153], v[142:143], v[150:151] op_sel_hi:[0,1,1] neg_lo:[0,0,1] neg_hi:[0,0,1]
    v_cvt_pk_bf16_f32 v200, v144, v145
    v_cvt_pk_bf16_f32 v201, v146, v147
    v_cvt_pk_bf16_f32 v202, v148, v149
    v_cvt_pk_bf16_f32 v203, v150, v151
    v_pk_fma_f32 v[136:137], v[152:153], v[144:145], v[136:137] op_sel_hi:[0,1,1] neg_lo:[0,0,1] neg_hi:[0,0,1]
    v_pk_fma_f32 v[138:139], v[152:153], v[146:147], v[138:139] op_sel_hi:[0,1,1] neg_lo:[0,0,1] neg_hi:[0,0,1]
    v_pk_fma_f32 v[140:141], v[152:153], v[148:149], v[140:141] op_sel_hi:[0,1,1] neg_lo:[0,0,1] neg_hi:[0,0,1]
    v_pk_fma_f32 v[142:143], v[152:153], v[150:151], v[142:143] op_sel_hi:[0,1,1] neg_lo:[0,0,1] neg_hi:[0,0,1]
    v_cvt_pk_bf16_f32 v204, v136, v137
    v_cvt_pk_bf16_f32 v205, v138, v139
    v_cvt_pk_bf16_f32 v206, v140, v141
    v_cvt_pk_bf16_f32 v207, v142, v143
    v_pk_fma_f32 v[144:145], v[152:153], v[136:137], v[144:145] op_sel_hi:[0,1,1] neg_lo:[0,0,1] neg_hi:[0,0,1]
    v_pk_fma_f32 v[146:147], v[152:153], v[138:139], v[146:147] op_sel_hi:[0,1,1] neg_lo:[0,0,1] neg_hi:[0,0,1]
    v_pk_fma_f32 v[148:149], v[152:153], v[140:141], v[148:149] op_sel_hi:[0,1,1] neg_lo:[0,0,1] neg_hi:[0,0,1]
    v_pk_fma_f32 v[150:151], v[152:153], v[142:143], v[150:151] op_sel_hi:[0,1,1] neg_lo:[0,0,1] neg_hi:[0,0,1]
    v_cvt_pk_bf16_f32 v208, v144, v145
    v_cvt_pk_bf16_f32 v209, v146, v147
    v_cvt_pk_bf16_f32 v210, v148, v149
    v_cvt_pk_bf16_f32 v211, v150, v151
    v_pk_fma_f32 v[136:137], v[152:153], v[144:145], v[136:137] op_sel_hi:[0,1,1] neg_lo:[0,0,1] neg_hi:[0,0,1]
    v_pk_fma_f32 v[138:139], v[152:153], v[146:147], v[138:139] op_sel_hi:[0,1,1] neg_lo:[0,0,1] neg_hi:[0,0,1]
    v_pk_fma_f32 v[140:141], v[152:153], v[148:149], v[140:141] op_sel_hi:[0,1,1] neg_lo:[0,0,1] neg_hi:[0,0,1]
    v_pk_fma_f32 v[142:143], v[152:153], v[150:151], v[142:143] op_sel_hi:[0,1,1] neg_lo:[0,0,1] neg_hi:[0,0,1]
    v_cvt_pk_bf16_f32 v212, v136, v137
    v_cvt_pk_bf16_f32 v213, v138, v139
    v_cvt_pk_bf16_f32 v214, v140, v141
    v_cvt_pk_bf16_f32 v215, v142, v143
    v_pk_fma_f32 v[144:145], v[152:153], v[136:137], v[144:145] op_sel_hi:[0,1,1] neg_lo:[0,0,1] neg_hi:[0,0,1]
    v_pk_fma_f32 v[146:147], v[152:153], v[138:139], v[146:147] op_sel_hi:[0,1,1] neg_lo:[0,0,1] neg_hi:[0,0,1]
    v_pk_fma_f32 v[148:149], v[152:153], v[140:141], v[148:149] op_sel_hi:[0,1,1] neg_lo:[0,0,1] neg_hi:[0,0,1]
    v_pk_fma_f32 v[150:151], v[152:153], v[142:143], v[150:151] op_sel_hi:[0,1,1] neg_lo:[0,0,1] neg_hi:[0,0,1]
    v_cvt_pk_bf16_f32 v216, v144, v145
    v_cvt_pk_bf16_f32 v217, v146, v147
    v_cvt_pk_bf16_f32 v218, v148, v149
    v_cvt_pk_bf16_f32 v219, v150, v151
    v_pk_fma_f32 v[136:137], v[152:153], v[144:145], v[136:137] op_sel_hi:[0,1,1] neg_lo:[0,0,1] neg_hi:[0,0,1]
    v_pk_fma_f32 v[138:139], v[152:153], v[146:147], v[138:139] op_sel_hi:[0,1,1] neg_lo:[0,0,1] neg_hi:[0,0,1]
    v_pk_fma_f32 v[140:141], v[152:153], v[148:149], v[140:141] op_sel_hi:[0,1,1] neg_lo:[0,0,1] neg_hi:[0,0,1]
    v_pk_fma_f32 v[142:143], v[152:153], v[150:151], v[142:143] op_sel_hi:[0,1,1] neg_lo:[0,0,1] neg_hi:[0,0,1]
    v_cvt_pk_bf16_f32 v220, v136, v137
    v_cvt_pk_bf16_f32 v221, v138, v139
    v_cvt_pk_bf16_f32 v222, v140, v141
    v_cvt_pk_bf16_f32 v223, v142, v143
    v_pk_fma_f32 v[144:145], v[152:153], v[136:137], v[144:145] op_sel_hi:[0,1,1] neg_lo:[0,0,1] neg_hi:[0,0,1]
    v_pk_fma_f32 v[146:147], v[152:153], v[138:139], v[146:147] op_sel_hi:[0,1,1] neg_lo:[0,0,1] neg_hi:[0,0,1]
    v_pk_fma_f32 v[148:149], v[152:153], v[140:141], v[148:149] op_sel_hi:[0,1,1] neg_lo:[0,0,1] neg_hi:[0,0,1]
    v_pk_fma_f32 v[150:151], v[152:153], v[142:143], v[150:151] op_sel_hi:[0,1,1] neg_lo:[0,0,1] neg_hi:[0,0,1]
    v_cvt_pk_bf16_f32 v224, v144, v145
    v_cvt_pk_bf16_f32 v225, v146, v147
    v_cvt_pk_bf16_f32 v226, v148, v149
    v_cvt_pk_bf16_f32 v227, v150, v151
    v_pk_fma_f32 v[136:137], v[152:153], v[144:145], v[136:137] op_sel_hi:[0,1,1] neg_lo:[0,0,1] neg_hi:[0,0,1]
    v_pk_fma_f32 v[138:139], v[152:153], v[146:147], v[138:139] op_sel_hi:[0,1,1] neg_lo:[0,0,1] neg_hi:[0,0,1]
    v_pk_fma_f32 v[140:141], v[152:153], v[148:149], v[140:141] op_sel_hi:[0,1,1] neg_lo:[0,0,1] neg_hi:[0,0,1]
    v_pk_fma_f32 v[142:143], v[152:153], v[150:151], v[142:143] op_sel_hi:[0,1,1] neg_lo:[0,0,1] neg_hi:[0,0,1]
    v_cvt_pk_bf16_f32 v228, v136, v137
    v_cvt_pk_bf16_f32 v229, v138, v139
    v_cvt_pk_bf16_f32 v230, v140, v141
    v_cvt_pk_bf16_f32 v231, v142, v143
    v_pk_fma_f32 v[144:145], v[152:153], v[136:137], v[144:145] op_sel_hi:[0,1,1] neg_lo:[0,0,1] neg_hi:[0,0,1]
    v_pk_fma_f32 v[146:147], v[152:153], v[138:139], v[146:147] op_sel_hi:[0,1,1] neg_lo:[0,0,1] neg_hi:[0,0,1]
    v_pk_fma_f32 v[148:149], v[152:153], v[140:141], v[148:149] op_sel_hi:[0,1,1] neg_lo:[0,0,1] neg_hi:[0,0,1]
    v_pk_fma_f32 v[150:151], v[152:153], v[142:143], v[150:151] op_sel_hi:[0,1,1] neg_lo:[0,0,1] neg_hi:[0,0,1]
    v_cvt_pk_bf16_f32 v232, v144, v145
    v_cvt_pk_bf16_f32 v233, v146, v147
    v_cvt_pk_bf16_f32 v234, v148, v149
    v_cvt_pk_bf16_f32 v235, v150, v151
    v_pk_fma_f32 v[136:137], v[152:153], v[144:145], v[136:137] op_sel_hi:[0,1,1] neg_lo:[0,0,1] neg_hi:[0,0,1]
    v_pk_fma_f32 v[138:139], v[152:153], v[146:147], v[138:139] op_sel_hi:[0,1,1] neg_lo:[0,0,1] neg_hi:[0,0,1]
    v_pk_fma_f32 v[140:141], v[152:153], v[148:149], v[140:141] op_sel_hi:[0,1,1] neg_lo:[0,0,1] neg_hi:[0,0,1]
    v_pk_fma_f32 v[142:143], v[152:153], v[150:151], v[142:143] op_sel_hi:[0,1,1] neg_lo:[0,0,1] neg_hi:[0,0,1]
    v_cvt_pk_bf16_f32 v236, v136, v137
    v_cvt_pk_bf16_f32 v237, v138, v139
    v_cvt_pk_bf16_f32 v238, v140, v141
    v_cvt_pk_bf16_f32 v239, v142, v143
    s_and_b32 s53, s3, 3
    s_lshl_b32 s53, s53, 4
    v_add_u32 v6, s53, v4
    v_cvt_f32_u32 v6, v6
    v_lshlrev_b32 v7, 2, v5
    v_cvt_f32_u32 v7, v7
    v_cvt_f32_u32 v14, v4
    v_mul_f32 v8, 0x3c800000, v6
    v_mul_f32 v9, v8, v7
    v_mul_f32 v10, 0x41800000, v8
    v_fract_f32 v250, v9
    v_cos_f32 v244, v250
    v_sin_f32 v245, v250
    v_fract_f32 v250, v8
    v_cos_f32 v246, v250
    v_sin_f32 v247, v250
    v_fract_f32 v250, v10
    v_cos_f32 v248, v250
    v_sin_f32 v249, v250
    v_mov_b32 v12, v244
    v_mov_b32 v13, v245
    v_cvt_pk_bf16_f32 v16, v244, v245
    v_cvt_pk_bf16_f32 v32, -v245, v244
    v_pk_mul_f32 v[250:251], v[244:245], v[246:247] op_sel_hi:[1,0]
    v_pk_fma_f32 v[244:245], v[244:245], v[246:247], v[250:251] op_sel:[1,1,0] op_sel_hi:[0,1,1] neg_lo:[0,1,0]
    v_cvt_pk_bf16_f32 v17, v244, v245
    v_cvt_pk_bf16_f32 v33, -v245, v244
    v_pk_mul_f32 v[250:251], v[244:245], v[246:247] op_sel_hi:[1,0]
    v_pk_fma_f32 v[244:245], v[244:245], v[246:247], v[250:251] op_sel:[1,1,0] op_sel_hi:[0,1,1] neg_lo:[0,1,0]
    v_cvt_pk_bf16_f32 v18, v244, v245
    v_cvt_pk_bf16_f32 v34, -v245, v244
    v_pk_mul_f32 v[250:251], v[244:245], v[246:247] op_sel_hi:[1,0]
    v_pk_fma_f32 v[244:245], v[244:245], v[246:247], v[250:251] op_sel:[1,1,0] op_sel_hi:[0,1,1] neg_lo:[0,1,0]
    v_cvt_pk_bf16_f32 v19, v244, v245
    v_cvt_pk_bf16_f32 v35, -v245, v244
    v_pk_mul_f32 v[250:251], v[12:13], v[248:249] op_sel_hi:[1,0]
    v_pk_fma_f32 v[12:13], v[12:13], v[248:249], v[250:251] op_sel:[1,1,0] op_sel_hi:[0,1,1] neg_lo:[0,1,0]
    v_mov_b32 v244, v12
    v_mov_b32 v245, v13
    v_cvt_pk_bf16_f32 v20, v244, v245
    v_cvt_pk_bf16_f32 v36, -v245, v244
    v_pk_mul_f32 v[250:251], v[244:245], v[246:247] op_sel_hi:[1,0]
    v_pk_fma_f32 v[244:245], v[244:245], v[246:247], v[250:251] op_sel:[1,1,0] op_sel_hi:[0,1,1] neg_lo:[0,1,0]
    v_cvt_pk_bf16_f32 v21, v244, v245
    v_cvt_pk_bf16_f32 v37, -v245, v244
    v_pk_mul_f32 v[250:251], v[244:245], v[246:247] op_sel_hi:[1,0]
    v_pk_fma_f32 v[244:245], v[244:245], v[246:247], v[250:251] op_sel:[1,1,0] op_sel_hi:[0,1,1] neg_lo:[0,1,0]
    v_cvt_pk_bf16_f32 v22, v244, v245
    v_cvt_pk_bf16_f32 v38, -v245, v244
    v_pk_mul_f32 v[250:251], v[244:245], v[246:247] op_sel_hi:[1,0]
    v_pk_fma_f32 v[244:245], v[244:245], v[246:247], v[250:251] op_sel:[1,1,0] op_sel_hi:[0,1,1] neg_lo:[0,1,0]
    v_cvt_pk_bf16_f32 v23, v244, v245
    v_cvt_pk_bf16_f32 v39, -v245, v244
    v_pk_mul_f32 v[250:251], v[12:13], v[248:249] op_sel_hi:[1,0]
    v_pk_fma_f32 v[12:13], v[12:13], v[248:249], v[250:251] op_sel:[1,1,0] op_sel_hi:[0,1,1] neg_lo:[0,1,0]
    v_mov_b32 v244, v12
    v_mov_b32 v245, v13
    v_cvt_pk_bf16_f32 v24, v244, v245
    v_cvt_pk_bf16_f32 v40, -v245, v244
    v_pk_mul_f32 v[250:251], v[244:245], v[246:247] op_sel_hi:[1,0]
    v_pk_fma_f32 v[244:245], v[244:245], v[246:247], v[250:251] op_sel:[1,1,0] op_sel_hi:[0,1,1] neg_lo:[0,1,0]
    v_cvt_pk_bf16_f32 v25, v244, v245
    v_cvt_pk_bf16_f32 v41, -v245, v244
    v_pk_mul_f32 v[250:251], v[244:245], v[246:247] op_sel_hi:[1,0]
    v_pk_fma_f32 v[244:245], v[244:245], v[246:247], v[250:251] op_sel:[1,1,0] op_sel_hi:[0,1,1] neg_lo:[0,1,0]
    v_cvt_pk_bf16_f32 v26, v244, v245
    v_cvt_pk_bf16_f32 v42, -v245, v244
    v_pk_mul_f32 v[250:251], v[244:245], v[246:247] op_sel_hi:[1,0]
    v_pk_fma_f32 v[244:245], v[244:245], v[246:247], v[250:251] op_sel:[1,1,0] op_sel_hi:[0,1,1] neg_lo:[0,1,0]
    v_cvt_pk_bf16_f32 v27, v244, v245
    v_cvt_pk_bf16_f32 v43, -v245, v244
    v_pk_mul_f32 v[250:251], v[12:13], v[248:249] op_sel_hi:[1,0]
    v_pk_fma_f32 v[12:13], v[12:13], v[248:249], v[250:251] op_sel:[1,1,0] op_sel_hi:[0,1,1] neg_lo:[0,1,0]
    v_mov_b32 v244, v12
    v_mov_b32 v245, v13
    v_cvt_pk_bf16_f32 v28, v244, v245
    v_cvt_pk_bf16_f32 v44, -v245, v244
    v_pk_mul_f32 v[250:251], v[244:245], v[246:247] op_sel_hi:[1,0]
    v_pk_fma_f32 v[244:245], v[244:245], v[246:247], v[250:251] op_sel:[1,1,0] op_sel_hi:[0,1,1] neg_lo:[0,1,0]
    v_cvt_pk_bf16_f32 v29, v244, v245
    v_cvt_pk_bf16_f32 v45, -v245, v244
    v_pk_mul_f32 v[250:251], v[244:245], v[246:247] op_sel_hi:[1,0]
    v_pk_fma_f32 v[244:245], v[244:245], v[246:247], v[250:251] op_sel:[1,1,0] op_sel_hi:[0,1,1] neg_lo:[0,1,0]
    v_cvt_pk_bf16_f32 v30, v244, v245
    v_cvt_pk_bf16_f32 v46, -v245, v244
    v_pk_mul_f32 v[250:251], v[244:245], v[246:247] op_sel_hi:[1,0]
    v_pk_fma_f32 v[244:245], v[244:245], v[246:247], v[250:251] op_sel:[1,1,0] op_sel_hi:[0,1,1] neg_lo:[0,1,0]
    v_cvt_pk_bf16_f32 v31, v244, v245
    v_cvt_pk_bf16_f32 v47, -v245, v244
    v_mul_f32 v8, 0x3d000000, v14
    v_mul_f32 v9, v8, v7
    v_fract_f32 v250, v9
    v_cos_f32 v244, v250
    v_sin_f32 v245, v250
    v_fract_f32 v250, v8
    v_cos_f32 v246, v250
    v_sin_f32 v247, v250
    v_mov_b32 v64, v244
    v_mov_b32 v65, v245
    v_pk_mul_f32 v[250:251], v[64:65], v[246:247] op_sel_hi:[1,0]
    v_pk_fma_f32 v[66:67], v[64:65], v[246:247], v[250:251] op_sel:[1,1,0] op_sel_hi:[0,1,1] neg_lo:[0,1,0]
    v_pk_mul_f32 v[250:251], v[66:67], v[246:247] op_sel_hi:[1,0]
    v_pk_fma_f32 v[68:69], v[66:67], v[246:247], v[250:251] op_sel:[1,1,0] op_sel_hi:[0,1,1] neg_lo:[0,1,0]
    v_pk_mul_f32 v[250:251], v[68:69], v[246:247] op_sel_hi:[1,0]
    v_pk_fma_f32 v[70:71], v[68:69], v[246:247], v[250:251] op_sel:[1,1,0] op_sel_hi:[0,1,1] neg_lo:[0,1,0]
    v_cvt_pk_bf16_f32 v48, v64, v66
    v_cvt_pk_bf16_f32 v49, v68, v70
    v_cvt_pk_bf16_f32 v50, v65, v67
    v_cvt_pk_bf16_f32 v51, v69, v71
    v_and_b32 v10, 1, v1
    v_mul_u32_u24 v10, 0x8000, v10
    v_lshl_or_b32 v10, v10, 16, v10
    v_xor_b32 v52, v10, v48
    v_xor_b32 v56, 0x80000000, v48
    v_xor_b32 v60, 0x80000000, v52
    v_xor_b32 v53, v10, v49
    v_xor_b32 v57, 0x80000000, v49
    v_xor_b32 v61, 0x80000000, v53
    v_xor_b32 v54, v10, v50
    v_xor_b32 v58, 0x80000000, v50
    v_xor_b32 v62, 0x80000000, v54
    v_xor_b32 v55, v10, v51
    v_xor_b32 v59, 0x80000000, v51
    v_xor_b32 v63, 0x80000000, v55
    v_mul_f32 v8, 0x3a000000, v6
    v_mul_f32 v9, v8, v7
    v_add_f32 v12, v8, v8
    v_mul_f32 v13, 0x41800000, v8
    v_fract_f32 v250, v12
    v_cos_f32 v246, v250
    v_sin_f32 v247, v250
    v_fract_f32 v250, v13
    v_cos_f32 v248, v250
    v_sin_f32 v249, v250
    v_fract_f32 v250, v9
    v_add_f32 v251, v9, v8
    v_cos_f32 v64, v250
    v_fract_f32 v251, v251
    v_sin_f32 v72, v250
    v_cos_f32 v65, v251
    v_sin_f32 v73, v251
    v_pk_mul_f32 v[250:251], v[64:65], v[246:247] op_sel_hi:[1,0]
    v_pk_mul_f32 v[10:11], v[72:73], v[246:247] op_sel_hi:[1,0]
    v_pk_fma_f32 v[66:67], v[72:73], v[246:247], v[250:251] op_sel:[0,1,0] op_sel_hi:[1,1,1] neg_lo:[0,1,0] neg_hi:[0,1,0]
    v_pk_fma_f32 v[74:75], v[64:65], v[246:247], v[10:11] op_sel:[0,1,0] op_sel_hi:[1,1,1]
    v_pk_mul_f32 v[250:251], v[64:65], v[248:249] op_sel_hi:[1,0]
    v_pk_mul_f32 v[10:11], v[72:73], v[248:249] op_sel_hi:[1,0]
    v_pk_fma_f32 v[68:69], v[72:73], v[248:249], v[250:251] op_sel:[0,1,0] op_sel_hi:[1,1,1] neg_lo:[0,1,0] neg_hi:[0,1,0]
    v_pk_fma_f32 v[76:77], v[64:65], v[248:249], v[10:11] op_sel:[0,1,0] op_sel_hi:[1,1,1]
    v_pk_mul_f32 v[250:251], v[66:67], v[248:249] op_sel_hi:[1,0]
    v_pk_mul_f32 v[10:11], v[74:75], v[248:249] op_sel_hi:[1,0]
    v_pk_fma_f32 v[70:71], v[74:75], v[248:249], v[250:251] op_sel:[0,1,0] op_sel_hi:[1,1,1] neg_lo:[0,1,0] neg_hi:[0,1,0]
    v_pk_fma_f32 v[78:79], v[66:67], v[248:249], v[10:11] op_sel:[0,1,0] op_sel_hi:[1,1,1]
    v_mov_b32 v12, s53
    v_cvt_f32_u32 v12, v12
    v_add_f32 v7, v7, v12
    v_add_f32 v8, 0x00000000, v14
    v_mul_f32 v8, 0x3a000000, v8
    v_mul_f32 v9, v8, v7
    v_add_f32 v12, v8, v8
    v_fract_f32 v250, v12
    v_cos_f32 v246, v250
    v_sin_f32 v247, v250
    v_fract_f32 v250, v9
    v_add_f32 v251, v9, v8
    v_cos_f32 v80, v250
    v_fract_f32 v251, v251
    v_sin_f32 v88, v250
    v_cos_f32 v81, v251
    v_sin_f32 v89, v251
    v_mul_f32 v80, 0x3a000000, v80
    v_mul_f32 v81, 0x3a000000, v81
    v_mul_f32 v88, 0x3a000000, v88
    v_mul_f32 v89, 0x3a000000, v89
    v_pk_mul_f32 v[250:251], v[80:81], v[246:247] op_sel_hi:[1,0]
    v_pk_mul_f32 v[10:11], v[88:89], v[246:247] op_sel_hi:[1,0]
    v_pk_fma_f32 v[82:83], v[88:89], v[246:247], v[250:251] op_sel:[0,1,0] op_sel_hi:[1,1,1] neg_lo:[0,1,0] neg_hi:[0,1,0]
    v_pk_fma_f32 v[90:91], v[80:81], v[246:247], v[10:11] op_sel:[0,1,0] op_sel_hi:[1,1,1]
    v_add_f32 v8, 0x41800000, v14
    v_mul_f32 v8, 0x3a000000, v8
    v_mul_f32 v9, v8, v7
    v_add_f32 v12, v8, v8
    v_fract_f32 v250, v12
    v_cos_f32 v246, v250
    v_sin_f32 v247, v250
    v_fract_f32 v250, v9
    v_add_f32 v251, v9, v8
    v_cos_f32 v84, v250
    v_fract_f32 v251, v251
    v_sin_f32 v92, v250
    v_cos_f32 v85, v251
    v_sin_f32 v93, v251
    v_mul_f32 v84, 0x3a000000, v84
    v_mul_f32 v85, 0x3a000000, v85
    v_mul_f32 v92, 0x3a000000, v92
    v_mul_f32 v93, 0x3a000000, v93
    v_pk_mul_f32 v[250:251], v[84:85], v[246:247] op_sel_hi:[1,0]
    v_pk_mul_f32 v[10:11], v[92:93], v[246:247] op_sel_hi:[1,0]
    v_pk_fma_f32 v[86:87], v[92:93], v[246:247], v[250:251] op_sel:[0,1,0] op_sel_hi:[1,1,1] neg_lo:[0,1,0] neg_hi:[0,1,0]
    v_pk_fma_f32 v[94:95], v[84:85], v[246:247], v[10:11] op_sel:[0,1,0] op_sel_hi:[1,1,1]
    v_mov_b32 v9, 0
    buffer_load_dword v126, v9, s[36:39], 0 offen sc0 sc1
    v_lshrrev_b32 v6, 3, v2
    v_lshlrev_b32 v6, 10, v6
    v_and_b32 v7, 7, v2
    v_lshl_add_u32 v6, v7, 7, v6
    v_bfe_u32 v7, v2, 1, 3
    v_add_u32 v8, 0, v3
    v_xor_b32 v8, v8, v7
    v_lshl_add_u32 v121, v8, 4, v6
    v_add_u32 v8, 2, v3
    v_xor_b32 v8, v8, v7
    v_lshl_add_u32 v122, v8, 4, v6
    v_add_u32 v8, 4, v3
    v_xor_b32 v8, v8, v7
    v_lshl_add_u32 v123, v8, 4, v6
    v_add_u32 v8, 6, v3
    v_xor_b32 v8, v8, v7
    v_lshl_add_u32 v124, v8, 4, v6
    s_lshl_b32 s53, s51, 14
    v_add_u32 v121, s53, v121
    v_add_u32 v122, s53, v122
    v_add_u32 v123, s53, v123
    v_add_u32 v124, s53, v124
    s_waitcnt vmcnt(7)
    s_barrier
    ds_read_b128 v[136:139], v121 offset:0
    ds_read_b128 v[140:143], v122 offset:0
    ds_read_b128 v[144:147], v123 offset:0
    ds_read_b128 v[148:151], v124 offset:0
    s_waitcnt lgkmcnt(3)
    v_mfma_f32_32x32x16_bf16 v[96:111], v[176:179], v[136:139], 0
    ds_read_b128 v[136:139], v121 offset:4096
    s_waitcnt lgkmcnt(3)
    v_mfma_f32_32x32x16_bf16 v[96:111], v[180:183], v[140:143], v[96:111]
    ds_read_b128 v[140:143], v122 offset:4096
    s_waitcnt lgkmcnt(3)
    v_mfma_f32_32x32x16_bf16 v[96:111], v[184:187], v[144:147], v[96:111]
    ds_read_b128 v[144:147], v123 offset:4096
    s_waitcnt lgkmcnt(3)
    v_mfma_f32_32x32x16_bf16 v[96:111], v[188:191], v[148:151], v[96:111]
    ds_read_b128 v[148:151], v124 offset:4096
    s_waitcnt lgkmcnt(3)
    v_mfma_f32_32x32x16_bf16 v[96:111], v[192:195], v[136:139], v[96:111]
    ds_read_b128 v[136:139], v121 offset:8192
    s_waitcnt lgkmcnt(3)
    v_mfma_f32_32x32x16_bf16 v[96:111], v[196:199], v[140:143], v[96:111]
    ds_read_b128 v[140:143], v122 offset:8192
    s_waitcnt lgkmcnt(3)
    v_mfma_f32_32x32x16_bf16 v[96:111], v[200:203], v[144:147], v[96:111]
    ds_read_b128 v[144:147], v123 offset:8192
    s_waitcnt lgkmcnt(3)
    v_mfma_f32_32x32x16_bf16 v[96:111], v[204:207], v[148:151], v[96:111]
    ds_read_b128 v[148:151], v124 offset:8192
    s_waitcnt lgkmcnt(3)
    v_mfma_f32_32x32x16_bf16 v[96:111], v[208:211], v[136:139], v[96:111]
    ds_read_b128 v[136:139], v121 offset:12288
    s_waitcnt lgkmcnt(3)
    v_mfma_f32_32x32x16_bf16 v[96:111], v[212:215], v[140:143], v[96:111]
    ds_read_b128 v[140:143], v122 offset:12288
    s_waitcnt lgkmcnt(3)
    v_mfma_f32_32x32x16_bf16 v[96:111], v[216:219], v[144:147], v[96:111]
    ds_read_b128 v[144:147], v123 offset:12288
    s_waitcnt lgkmcnt(3)
    v_mfma_f32_32x32x16_bf16 v[96:111], v[220:223], v[148:151], v[96:111]
    ds_read_b128 v[148:151], v124 offset:12288
    s_waitcnt lgkmcnt(3)
    v_mfma_f32_32x32x16_bf16 v[96:111], v[224:227], v[136:139], v[96:111]
    s_waitcnt lgkmcnt(2)
    v_mfma_f32_32x32x16_bf16 v[96:111], v[228:231], v[140:143], v[96:111]
    s_waitcnt lgkmcnt(1)
    v_mfma_f32_32x32x16_bf16 v[96:111], v[232:235], v[144:147], v[96:111]
    s_waitcnt lgkmcnt(0)
    v_mfma_f32_32x32x16_bf16 v[96:111], v[236:239], v[148:151], v[96:111]
    s_waitcnt vmcnt(0)
    v_mov_b32 v6, 0x05040100
    v_mov_b32 v7, 0x07060302
    v_perm_b32 v8, v114, v112, v6
    v_perm_b32 v9, v114, v112, v7
    v_perm_b32 v10, v115, v113, v6
    v_perm_b32 v11, v115, v113, v7
    v_lshl_or_b32 v12, v117, 16, v116
    v_bfi_b32 v8, v118, v12, v8
    ds_write_b32 v120, v8 offset:0
    ds_write_b32 v120, v9 offset:512
    ds_write_b32 v120, v10 offset:1024
    ds_write_b32 v120, v11 offset:1536
    v_perm_b32 v8, v130, v128, v6
    v_perm_b32 v9, v130, v128, v7
    v_perm_b32 v10, v131, v129, v6
    v_perm_b32 v11, v131, v129, v7
    ds_write_b32 v120, v8 offset:8192
    ds_write_b32 v120, v9 offset:8704
    ds_write_b32 v120, v10 offset:9216
    ds_write_b32 v120, v11 offset:9728
    s_mov_b32 s86, 4194304
    v_lshlrev_b32 v9, 14, v3
    v_lshl_add_u32 v9, v2, 3, v9
    s_lshl_b32 s56, s52, 1
    s_add_u32 s56, s56, s51
    s_lshl_b32 s56, s56, 16
    s_lshl_b32 s57, s48, 8
    s_add_u32 s56, s56, s57
    s_add_u32 s56, s56, s86
    v_mov_b32 v10, -1
    v_mov_b32 v11, -1
    buffer_store_dwordx2 v[10:11], v9, s[4:7], s56 offen sc1
    s_add_u32 s56, s56, 32768
    buffer_store_dwordx2 v[10:11], v9, s[4:7], s56 offen sc1
    s_cmp_eq_u32 s3, 0
    s_cbranch_scc0 L_m_FL2
    v_lshlrev_b32 v9, 2, v2
    s_lshl_b32 s53, s49, 13
    s_lshl_b32 s54, s48, 7
    s_add_u32 s53, s53, s54
    s_add_u32 s53, s53, 30474240
    s_mov_b32 exec_hi, 0
    buffer_store_dword v10, v9, s[4:7], s53 offen sc1
    s_mov_b32 exec_hi, -1
L_m_FL2:
    s_lshl_b32 s53, s50, 1
    s_add_u32 s54, s53, s51
    s_xor_b32 s55, s54, 1
    s_lshl_b32 s54, s54, 11
    s_lshl_b32 s55, s55, 11
    v_lshlrev_b32 v6, 4, v1
    v_add_u32 v7, s55, v6
    v_add_u32 v6, s54, v6
    v_add_u32 v7, 99328, v7
    v_add_u32 v6, 99328, v6
    s_cmp_eq_u32 s51, 0
    s_cbranch_scc0 L_m_RH3_k1
    ds_write_b128 v7, v[104:107] offset:0
    ds_write_b128 v7, v[108:111] offset:1024
    s_branch L_m_RH3_j
L_m_RH3_k1:
    ds_write_b128 v7, v[96:99] offset:0
    ds_write_b128 v7, v[100:103] offset:1024
    v_mov_b32 v96, v104
    v_mov_b32 v97, v105
    v_mov_b32 v98, v106
    v_mov_b32 v99, v107
    v_mov_b32 v100, v108
    v_mov_b32 v101, v109
    v_mov_b32 v102, v110
    v_mov_b32 v103, v111
L_m_RH3_j:
    s_waitcnt lgkmcnt(0)
    s_barrier
    ds_read_b128 v[104:107], v6 offset:0
    ds_read_b128 v[108:111], v6 offset:1024
    s_waitcnt lgkmcnt(0)
    v_pk_add_f32 v[96:97], v[96:97], v[104:105]
    v_pk_add_f32 v[98:99], v[98:99], v[106:107]
    v_pk_add_f32 v[100:101], v[100:101], v[108:109]
    v_pk_add_f32 v[102:103], v[102:103], v[110:111]
    v_lshlrev_b32 v6, 4, v0
    v_add_u32 v6, 116736, v6
    ds_read_b128 v[128:131], v6
    ds_read_b128 v[132:135], v6 offset:8192
    v_lshrrev_b32 v6, 5, v0
    v_lshlrev_b32 v6, 13, v6
    v_and_b32 v7, 1, v0
    v_lshl_add_u32 v6, v7, 10, v6
    v_bfe_u32 v7, v0, 1, 4
    v_lshl_add_u32 v6, v7, 4, v6
    s_lshl_b32 s53, s47, 17
    s_lshl_b32 s54, s46, 11
    s_add_u32 s53, s53, s54
    s_lshl_b32 s54, s45, 8
    s_add_u32 s53, s53, s54
    s_add_u32 s53, s53, 28311552
    s_add_u32 s54, s53, 1048576
    s_waitcnt lgkmcnt(0)
    buffer_store_dwordx4 v[128:131], v6, s[4:7], s53 offen sc1
    buffer_store_dwordx4 v[132:135], v6, s[4:7], s54 offen sc1
    s_mov_b32 s86, 0
    s_mov_b32 s87, 30408704
    v_cvt_pk_bf16_f32 v104, v96, v97
    v_cvt_pk_bf16_f32 v105, v98, v99
    v_cvt_pk_bf16_f32 v106, v100, v101
    v_cvt_pk_bf16_f32 v107, v102, v103
    v_min_u32 v104, -2, v104
    v_min_u32 v105, -2, v105
    v_min_u32 v106, -2, v106
    v_min_u32 v107, -2, v107
    v_lshlrev_b32 v9, 14, v3
    v_lshl_add_u32 v9, v2, 3, v9
    s_lshl_b32 s56, s52, 1
    s_add_u32 s56, s56, s51
    s_lshl_b32 s56, s56, 16
    s_lshl_b32 s57, s48, 8
    s_add_u32 s56, s56, s57
    s_add_u32 s56, s56, s86
    buffer_store_dwordx2 v[104:105], v9, s[4:7], s56 offen offset:0 sc1
    s_add_u32 s56, s56, 32768
    buffer_store_dwordx2 v[106:107], v9, s[4:7], s56 offen offset:0 sc1
    s_or_b32 s53, s52, s51
    s_cmp_eq_u32 s53, 0
    s_cselect_b32 s53, 32, 0
    v_cmp_le_u32 vcc, s53, v1
    s_lshl_b32 s53, s3, 7
    s_add_u32 s53, s53, 115712
    v_lshl_add_u32 v10, v2, 2, s53
    v_cndmask_b32 v6, 0, v97, vcc
    v_mul_f32 v7, v96, v96
    v_fmac_f32 v7, v6, v6
    v_fmac_f32 v7, v98, v98
    v_fmac_f32 v7, v99, v99
    v_fmac_f32 v7, v100, v100
    v_fmac_f32 v7, v101, v101
    v_fmac_f32 v7, v102, v102
    v_fmac_f32 v7, v103, v103
    v_mov_b32 v8, v7
    s_nop 1
    v_permlane32_swap_b32 v7, v8
    v_add_f32 v7, v7, v8
    ds_write_b32 v10, v7 offset:0
    s_waitcnt lgkmcnt(0)
    s_barrier
    s_cmp_ge_u32 s3, 1
    s_cbranch_scc1 L_m_SS4
    v_lshlrev_b32 v6, 2, v2
    s_mul_i32 s53, s3, 17408
    s_add_u32 s53, s53, 115712
    v_add_u32 v7, s53, v6
    ds_read_b32 v96, v7 offset:0
    ds_read_b32 v97, v7 offset:128
    ds_read_b32 v98, v7 offset:256
    ds_read_b32 v99, v7 offset:384
    ds_read_b32 v100, v7 offset:512
    ds_read_b32 v101, v7 offset:640
    ds_read_b32 v102, v7 offset:768
    ds_read_b32 v103, v7 offset:896
    s_waitcnt lgkmcnt(0)
    v_add_f32 v96, v96, v97
    v_add_f32 v96, v96, v98
    v_add_f32 v96, v96, v99
    v_add_f32 v96, v96, v100
    v_add_f32 v96, v96, v101
    v_add_f32 v96, v96, v102
    v_add_f32 v96, v96, v103
    v_min_u32 v96, -2, v96
    s_lshl_b32 s53, s49, 13
    s_lshl_b32 s54, s48, 7
    s_add_u32 s53, s53, s54
    s_mul_i32 s54, s3, 1024
    s_add_u32 s53, s53, s54
    s_add_u32 s53, s53, s87
    s_mov_b32 exec_hi, 0
    buffer_store_dword v96, v6, s[4:7], s53 offen sc1
    s_mov_b32 exec_hi, -1
L_m_SS4:
    s_waitcnt vmcnt(0)
    v_readfirstlane_b32 s40, v126
    s_cmp_lg_u32 s40, 0
    s_nop 2
    s_cbranch_scc1 L_m_NG5_skip
    s_mov_b32 s89, 0x40000
    v_mov_b32 v9, 0
L_m_NG5_loop:
    buffer_load_dword v8, v9, s[36:39], 0 offen sc0 sc1
    s_waitcnt vmcnt(0)
    v_readfirstlane_b32 s40, v8
    s_cmp_lg_u32 s40, 0
    s_nop 2
    s_cbranch_scc1 L_m_NG5_skip
    s_sub_u32 s89, s89, 1
    s_cmp_lg_u32 s89, 0
    s_cbranch_scc1 L_m_NG5_loop
L_m_NG5_skip:
    s_waitcnt vmcnt(0)
    s_barrier
    s_cmp_eq_u32 s3, 0
    s_cbranch_scc0 L_m_PUB6
    s_add_u32 s91, s40, 1
    s_lshl_b32 s90, s2, 7
    s_add_u32 s90, s90, 31457280
    v_mov_b32 v8, s91
    v_mov_b32 v9, 0
    s_mov_b64 exec, 1
    buffer_store_dword v8, v9, s[4:7], s90 offen sc0 sc1
    s_mov_b64 exec, -1
L_m_PUB6:
    s_barrier
    s_nop 1
    s_branch L_S0DONE
L_NONCOL0:
    s_and_b32 s53, s2, 7
    s_bfe_u32 s54, s2, 0x40003
    s_lshr_b32 s55, s54, 2
    s_lshl_b32 s55, s55, 3
    s_add_u32 s55, s55, s53
    s_lshl_b32 s55, s55, 2
    s_and_b32 s56, s54, 3
    s_add_u32 s55, s55, s56
    s_cmp_lt_u32 s53, 5
    s_cselect_b32 s57, 12, 8
    s_lshl_b32 s58, s53, 2
    s_cmp_eq_u32 s53, 5
    s_cselect_b32 s57, 10, s57
    s_cmp_eq_u32 s53, 6
    s_cselect_b32 s58, 26, s58
    s_cmp_eq_u32 s53, 7
    s_cselect_b32 s58, 34, s58
    s_sub_u32 s56, s54, s57
    s_add_u32 s58, s58, s56
    s_add_u32 s58, s58, 86
    s_cmp_lt_u32 s55, 86
    s_cselect_b32 s57, s55, s58
    s_cmp_ge_u32 s54, 12
    s_cselect_b32 s58, s58, s57
    s_mov_b32 s74, s58
    s_and_b32 s48, s2, 7
    s_lshr_b32 s53, s2, 5
    s_lshl_b32 s53, s53, 3
    s_add_u32 s48, s48, s53
    s_bfe_u32 s49, s2, 0x20003
    s_and_b32 s50, s3, 3
    s_lshr_b32 s51, s3, 2
    s_lshl_b32 s52, s49, 2
    s_add_u32 s52, s52, s50
    s_and_b32 s53, s48, 1
    s_lshl_b32 s53, s53, 20
    s_lshr_b32 s54, s48, 1
    s_lshl_b32 s54, s54, 10
    s_add_u32 s58, s53, s54
    v_lshrrev_b32 v6, 3, v1
    v_mul_u32_u24 v6, 32768, v6
    v_and_b32 v7, 7, v1
    v_xor_b32 v8, v7, v5
    v_lshl_add_u32 v9, v8, 4, v6
    v_xor_b32 v8, 4, v8
    v_lshl_add_u32 v10, v8, 4, v6
    s_lshl_b32 s62, s3, 7
    s_add_u32 s62, s62, s58
    s_lshl_b32 s61, s3, 12
    s_mov_b32 m0, s61
    s_nop 0
    buffer_load_dwordx4 v9, s[8:11], s62 offen lds
    s_add_u32 s61, s61, 1024
    s_add_u32 s62, s62, 262144
    s_mov_b32 m0, s61
    s_nop 0
    buffer_load_dwordx4 v10, s[8:11], s62 offen lds
    s_add_u32 s61, s61, 1024
    s_add_u32 s62, s62, 262144
    s_mov_b32 m0, s61
    s_nop 0
    buffer_load_dwordx4 v9, s[8:11], s62 offen lds
    s_add_u32 s61, s61, 1024
    s_add_u32 s62, s62, 262144
    s_mov_b32 m0, s61
    s_nop 0
    buffer_load_dwordx4 v10, s[8:11], s62 offen lds
    s_cmp_ge_u32 s74, 86
    s_cbranch_scc1 L_m_TD8_2
    v_lshrrev_b32 v6, 1, v1
    v_mul_u32_u24 v6, 2752, v6
    v_and_b32 v7, 1, v1
    v_lshl_add_u32 v6, v7, 4, v6
    s_and_b32 s53, s3, 3
    s_mul_i32 s54, s53, 352256
    s_lshl_b32 s55, s74, 5
    s_add_u32 s54, s54, s55
    s_lshl_b32 s55, s53, 12
    s_cmp_ge_u32 s3, 4
    s_cselect_b32 s56, 16512, 0
    s_cselect_b32 s84, s28, s24
    s_cselect_b32 s85, s29, s25
    s_mov_b32 s86, 1409024
    s_mov_b32 s87, 0x20000
    s_add_u32 s55, s55, s56
    s_add_u32 s55, s55, 33024
    s_mov_b32 m0, s55
    s_nop 0
    buffer_load_dwordx4 v6, s[84:87], s54 offen lds
    s_add_u32 s55, s55, 1024
    s_add_u32 s54, s54, 88064
    s_mov_b32 m0, s55
    s_nop 0
    buffer_load_dwordx4 v6, s[84:87], s54 offen lds
    s_add_u32 s55, s55, 1024
    s_add_u32 s54, s54, 88064
    s_mov_b32 m0, s55
    s_nop 0
    buffer_load_dwordx4 v6, s[84:87], s54 offen lds
    s_add_u32 s55, s55, 1024
    s_add_u32 s54, s54, 88064
    s_mov_b32 m0, s55
    s_nop 0
    buffer_load_dwordx4 v6, s[84:87], s54 offen lds
    s_branch L_m_TD8_j
L_m_TD8_2:
    s_sub_u32 s57, s74, 86
    s_lshl_b32 s57, s57, 15
    v_lshrrev_b32 v6, 3, v1
    v_mul_u32_u24 v6, 1024, v6
    v_and_b32 v7, 7, v1
    v_xor_b32 v8, v7, v5
    v_lshl_add_u32 v9, v8, 4, v6
    v_xor_b32 v8, 4, v8
    v_lshl_add_u32 v10, v8, 4, v6
    s_lshl_b32 s62, s3, 7
    s_add_u32 s62, s62, s57
    s_lshl_b32 s61, s3, 12
    s_add_u32 s61, s61, 33024
    s_mov_b32 m0, s61
    s_nop 0
    buffer_load_dwordx4 v9, s[32:35], s62 offen lds
    s_add_u32 s61, s61, 1024
    s_add_u32 s62, s62, 8192
    s_mov_b32 m0, s61
    s_nop 0
    buffer_load_dwordx4 v10, s[32:35], s62 offen lds
    s_add_u32 s61, s61, 1024
    s_add_u32 s62, s62, 8192
    s_mov_b32 m0, s61
    s_nop 0
    buffer_load_dwordx4 v9, s[32:35], s62 offen lds
    s_add_u32 s61, s61, 1024
    s_add_u32 s62, s62, 8192
    s_mov_b32 m0, s61
    s_nop 0
    buffer_load_dwordx4 v10, s[32:35], s62 offen lds
L_m_TD8_j:
    s_cmp_eq_u32 s2, 255
    s_cbranch_scc0 L_m_TX9
    s_mov_b32 s75, 128
    s_cmp_ge_u32 s75, 86
    s_cbranch_scc1 L_m_TD10_2
    v_lshrrev_b32 v6, 1, v1
    v_mul_u32_u24 v6, 2752, v6
    v_and_b32 v7, 1, v1
    v_lshl_add_u32 v6, v7, 4, v6
    s_and_b32 s53, s3, 3
    s_mul_i32 s54, s53, 352256
    s_lshl_b32 s55, s75, 5
    s_add_u32 s54, s54, s55
    s_lshl_b32 s55, s53, 12
    s_cmp_ge_u32 s3, 4
    s_cselect_b32 s56, 16512, 0
    s_cselect_b32 s84, s28, s24
    s_cselect_b32 s85, s29, s25
    s_mov_b32 s86, 1409024
    s_mov_b32 s87, 0x20000
    s_add_u32 s55, s55, s56
    s_add_u32 s55, s55, 66048
    s_mov_b32 m0, s55
    s_nop 0
    buffer_load_dwordx4 v6, s[84:87], s54 offen lds
    s_add_u32 s55, s55, 1024
    s_add_u32 s54, s54, 88064
    s_mov_b32 m0, s55
    s_nop 0
    buffer_load_dwordx4 v6, s[84:87], s54 offen lds
    s_add_u32 s55, s55, 1024
    s_add_u32 s54, s54, 88064
    s_mov_b32 m0, s55
    s_nop 0
    buffer_load_dwordx4 v6, s[84:87], s54 offen lds
    s_add_u32 s55, s55, 1024
    s_add_u32 s54, s54, 88064
    s_mov_b32 m0, s55
    s_nop 0
    buffer_load_dwordx4 v6, s[84:87], s54 offen lds
    s_branch L_m_TD10_j
L_m_TD10_2:
    s_sub_u32 s57, s75, 86
    s_lshl_b32 s57, s57, 15
    v_lshrrev_b32 v6, 3, v1
    v_mul_u32_u24 v6, 1024, v6
    v_and_b32 v7, 7, v1
    v_xor_b32 v8, v7, v5
    v_lshl_add_u32 v9, v8, 4, v6
    v_xor_b32 v8, 4, v8
    v_lshl_add_u32 v10, v8, 4, v6
    s_lshl_b32 s62, s3, 7
    s_add_u32 s62, s62, s57
    s_lshl_b32 s61, s3, 12
    s_add_u32 s61, s61, 66048
    s_mov_b32 m0, s61
    s_nop 0
    buffer_load_dwordx4 v9, s[32:35], s62 offen lds
    s_add_u32 s61, s61, 1024
    s_add_u32 s62, s62, 8192
    s_mov_b32 m0, s61
    s_nop 0
    buffer_load_dwordx4 v10, s[32:35], s62 offen lds
    s_add_u32 s61, s61, 1024
    s_add_u32 s62, s62, 8192
    s_mov_b32 m0, s61
    s_nop 0
    buffer_load_dwordx4 v9, s[32:35], s62 offen lds
    s_add_u32 s61, s61, 1024
    s_add_u32 s62, s62, 8192
    s_mov_b32 m0, s61
    s_nop 0
    buffer_load_dwordx4 v10, s[32:35], s62 offen lds
L_m_TD10_j:
L_m_TX9:
    s_mov_b32 s64, 33024
    s_lshl_b32 s63, s52, 5
    v_add_u32 v95, s63, v2
    v_lshrrev_b32 v92, 1, v95
    v_and_b32 v93, 1, v95
    v_cvt_f32_u32 v93, v93
    v_mul_f32 v93, 0x3e800000, v93
    v_mov_b32 v94, 0x3d800000
    v_mov_b32 v96, 0x3d3504f3
    v_cmp_gt_u32 vcc, 2, v95
    s_nop 1
    v_cndmask_b32 v94, v94, v96, vcc
    v_mov_b32 v96, 0
    v_cndmask_b32 v93, v93, v96, vcc
    v_mov_b32 v96, 256
    v_cmp_eq_u32 vcc, 0, v95
    s_nop 1
    v_cndmask_b32 v92, v92, v96, vcc
    v_cvt_f32_u32 v92, v92
    v_mul_f32 v92, 0x3b000000, v92
    s_lshl_b32 s53, s51, 4
    s_sub_u32 s53, s53, 1
    s_lshl_b32 s53, s53, 4
    v_lshl_add_u32 v95, v3, 3, s53
    v_cvt_f32_i32 v95, v95
    v_fma_f32 v95, v92, v95, v93
    v_mul_f32 v113, 0x41800000, v92
    v_fract_f32 v114, v113
    v_cos_f32 v112, v114
    v_mov_b32 v114, v95
    v_add_f32 v112, v112, v112
    v_fract_f32 v96, v114
    v_add_f32 v104, v114, v113
    v_fract_f32 v104, v104
    v_add_f32 v114, v114, v92
    v_fract_f32 v97, v114
    v_add_f32 v105, v114, v113
    v_fract_f32 v105, v105
    v_add_f32 v114, v114, v92
    v_fract_f32 v98, v114
    v_add_f32 v106, v114, v113
    v_fract_f32 v106, v106
    v_add_f32 v114, v114, v92
    v_fract_f32 v99, v114
    v_add_f32 v107, v114, v113
    v_fract_f32 v107, v107
    v_add_f32 v114, v114, v92
    v_fract_f32 v100, v114
    v_add_f32 v108, v114, v113
    v_fract_f32 v108, v108
    v_add_f32 v114, v114, v92
    v_fract_f32 v101, v114
    v_add_f32 v109, v114, v113
    v_fract_f32 v109, v109
    v_add_f32 v114, v114, v92
    v_fract_f32 v102, v114
    v_add_f32 v110, v114, v113
    v_fract_f32 v110, v110
    v_add_f32 v114, v114, v92
    v_fract_f32 v103, v114
    v_add_f32 v111, v114, v113
    v_fract_f32 v111, v111
    v_cos_f32 v96, v96
    v_cos_f32 v104, v104
    v_cos_f32 v97, v97
    v_cos_f32 v105, v105
    v_cos_f32 v98, v98
    v_cos_f32 v106, v106
    v_cos_f32 v99, v99
    v_cos_f32 v107, v107
    v_cos_f32 v100, v100
    v_cos_f32 v108, v108
    v_cos_f32 v101, v101
    v_cos_f32 v109, v109
    v_cos_f32 v102, v102
    v_cos_f32 v110, v110
    v_cos_f32 v103, v103
    v_cos_f32 v111, v111
    v_mul_f32 v96, v96, v94
    v_mul_f32 v104, v104, v94
    v_mul_f32 v97, v97, v94
    v_mul_f32 v105, v105, v94
    v_mul_f32 v98, v98, v94
    v_mul_f32 v106, v106, v94
    v_mul_f32 v99, v99, v94
    v_mul_f32 v107, v107, v94
    v_mul_f32 v100, v100, v94
    v_mul_f32 v108, v108, v94
    v_mul_f32 v101, v101, v94
    v_mul_f32 v109, v109, v94
    v_mul_f32 v102, v102, v94
    v_mul_f32 v110, v110, v94
    v_mul_f32 v103, v103, v94
    v_mul_f32 v111, v111, v94
    v_cvt_pk_bf16_f32 v16, v104, v105
    v_cvt_pk_bf16_f32 v17, v106, v107
    v_cvt_pk_bf16_f32 v18, v108, v109
    v_cvt_pk_bf16_f32 v19, v110, v111
    v_pk_fma_f32 v[96:97], v[112:113], v[104:105], v[96:97] op_sel_hi:[0,1,1] neg_lo:[0,0,1] neg_hi:[0,0,1]
    v_pk_fma_f32 v[98:99], v[112:113], v[106:107], v[98:99] op_sel_hi:[0,1,1] neg_lo:[0,0,1] neg_hi:[0,0,1]
    v_pk_fma_f32 v[100:101], v[112:113], v[108:109], v[100:101] op_sel_hi:[0,1,1] neg_lo:[0,0,1] neg_hi:[0,0,1]
    v_pk_fma_f32 v[102:103], v[112:113], v[110:111], v[102:103] op_sel_hi:[0,1,1] neg_lo:[0,0,1] neg_hi:[0,0,1]
    v_cvt_pk_bf16_f32 v20, v96, v97
    v_cvt_pk_bf16_f32 v21, v98, v99
    v_cvt_pk_bf16_f32 v22, v100, v101
    v_cvt_pk_bf16_f32 v23, v102, v103
    v_pk_fma_f32 v[104:105], v[112:113], v[96:97], v[104:105] op_sel_hi:[0,1,1] neg_lo:[0,0,1] neg_hi:[0,0,1]
    v_pk_fma_f32 v[106:107], v[112:113], v[98:99], v[106:107] op_sel_hi:[0,1,1] neg_lo:[0,0,1] neg_hi:[0,0,1]
    v_pk_fma_f32 v[108:109], v[112:113], v[100:101], v[108:109] op_sel_hi:[0,1,1] neg_lo:[0,0,1] neg_hi:[0,0,1]
    v_pk_fma_f32 v[110:111], v[112:113], v[102:103], v[110:111] op_sel_hi:[0,1,1] neg_lo:[0,0,1] neg_hi:[0,0,1]
    v_cvt_pk_bf16_f32 v24, v104, v105
    v_cvt_pk_bf16_f32 v25, v106, v107
    v_cvt_pk_bf16_f32 v26, v108, v109
    v_cvt_pk_bf16_f32 v27, v110, v111
    v_pk_fma_f32 v[96:97], v[112:113], v[104:105], v[96:97] op_sel_hi:[0,1,1] neg_lo:[0,0,1] neg_hi:[0,0,1]
    v_pk_fma_f32 v[98:99], v[112:113], v[106:107], v[98:99] op_sel_hi:[0,1,1] neg_lo:[0,0,1] neg_hi:[0,0,1]
    v_pk_fma_f32 v[100:101], v[112:113], v[108:109], v[100:101] op_sel_hi:[0,1,1] neg_lo:[0,0,1] neg_hi:[0,0,1]
    v_pk_fma_f32 v[102:103], v[112:113], v[110:111], v[102:103] op_sel_hi:[0,1,1] neg_lo:[0,0,1] neg_hi:[0,0,1]
    v_cvt_pk_bf16_f32 v28, v96, v97
    v_cvt_pk_bf16_f32 v29, v98, v99
    v_cvt_pk_bf16_f32 v30, v100, v101
    v_cvt_pk_bf16_f32 v31, v102, v103
    v_pk_fma_f32 v[104:105], v[112:113], v[96:97], v[104:105] op_sel_hi:[0,1,1] neg_lo:[0,0,1] neg_hi:[0,0,1]
    v_pk_fma_f32 v[106:107], v[112:113], v[98:99], v[106:107] op_sel_hi:[0,1,1] neg_lo:[0,0,1] neg_hi:[0,0,1]
    v_pk_fma_f32 v[108:109], v[112:113], v[100:101], v[108:109] op_sel_hi:[0,1,1] neg_lo:[0,0,1] neg_hi:[0,0,1]
    v_pk_fma_f32 v[110:111], v[112:113], v[102:103], v[110:111] op_sel_hi:[0,1,1] neg_lo:[0,0,1] neg_hi:[0,0,1]
    v_cvt_pk_bf16_f32 v32, v104, v105
    v_cvt_pk_bf16_f32 v33, v106, v107
    v_cvt_pk_bf16_f32 v34, v108, v109
    v_cvt_pk_bf16_f32 v35, v110, v111
    v_pk_fma_f32 v[96:97], v[112:113], v[104:105], v[96:97] op_sel_hi:[0,1,1] neg_lo:[0,0,1] neg_hi:[0,0,1]
    v_pk_fma_f32 v[98:99], v[112:113], v[106:107], v[98:99] op_sel_hi:[0,1,1] neg_lo:[0,0,1] neg_hi:[0,0,1]
    v_pk_fma_f32 v[100:101], v[112:113], v[108:109], v[100:101] op_sel_hi:[0,1,1] neg_lo:[0,0,1] neg_hi:[0,0,1]
    v_pk_fma_f32 v[102:103], v[112:113], v[110:111], v[102:103] op_sel_hi:[0,1,1] neg_lo:[0,0,1] neg_hi:[0,0,1]
    v_cvt_pk_bf16_f32 v36, v96, v97
    v_cvt_pk_bf16_f32 v37, v98, v99
    v_cvt_pk_bf16_f32 v38, v100, v101
    v_cvt_pk_bf16_f32 v39, v102, v103
    v_pk_fma_f32 v[104:105], v[112:113], v[96:97], v[104:105] op_sel_hi:[0,1,1] neg_lo:[0,0,1] neg_hi:[0,0,1]
    v_pk_fma_f32 v[106:107], v[112:113], v[98:99], v[106:107] op_sel_hi:[0,1,1] neg_lo:[0,0,1] neg_hi:[0,0,1]
    v_pk_fma_f32 v[108:109], v[112:113], v[100:101], v[108:109] op_sel_hi:[0,1,1] neg_lo:[0,0,1] neg_hi:[0,0,1]
    v_pk_fma_f32 v[110:111], v[112:113], v[102:103], v[110:111] op_sel_hi:[0,1,1] neg_lo:[0,0,1] neg_hi:[0,0,1]
    v_cvt_pk_bf16_f32 v40, v104, v105
    v_cvt_pk_bf16_f32 v41, v106, v107
    v_cvt_pk_bf16_f32 v42, v108, v109
    v_cvt_pk_bf16_f32 v43, v110, v111
    v_pk_fma_f32 v[96:97], v[112:113], v[104:105], v[96:97] op_sel_hi:[0,1,1] neg_lo:[0,0,1] neg_hi:[0,0,1]
    v_pk_fma_f32 v[98:99], v[112:113], v[106:107], v[98:99] op_sel_hi:[0,1,1] neg_lo:[0,0,1] neg_hi:[0,0,1]
    v_pk_fma_f32 v[100:101], v[112:113], v[108:109], v[100:101] op_sel_hi:[0,1,1] neg_lo:[0,0,1] neg_hi:[0,0,1]
    v_pk_fma_f32 v[102:103], v[112:113], v[110:111], v[102:103] op_sel_hi:[0,1,1] neg_lo:[0,0,1] neg_hi:[0,0,1]
    v_cvt_pk_bf16_f32 v44, v96, v97
    v_cvt_pk_bf16_f32 v45, v98, v99
    v_cvt_pk_bf16_f32 v46, v100, v101
    v_cvt_pk_bf16_f32 v47, v102, v103
    v_pk_fma_f32 v[104:105], v[112:113], v[96:97], v[104:105] op_sel_hi:[0,1,1] neg_lo:[0,0,1] neg_hi:[0,0,1]
    v_pk_fma_f32 v[106:107], v[112:113], v[98:99], v[106:107] op_sel_hi:[0,1,1] neg_lo:[0,0,1] neg_hi:[0,0,1]
    v_pk_fma_f32 v[108:109], v[112:113], v[100:101], v[108:109] op_sel_hi:[0,1,1] neg_lo:[0,0,1] neg_hi:[0,0,1]
    v_pk_fma_f32 v[110:111], v[112:113], v[102:103], v[110:111] op_sel_hi:[0,1,1] neg_lo:[0,0,1] neg_hi:[0,0,1]
    v_cvt_pk_bf16_f32 v48, v104, v105
    v_cvt_pk_bf16_f32 v49, v106, v107
    v_cvt_pk_bf16_f32 v50, v108, v109
    v_cvt_pk_bf16_f32 v51, v110, v111
    v_pk_fma_f32 v[96:97], v[112:113], v[104:105], v[96:97] op_sel_hi:[0,1,1] neg_lo:[0,0,1] neg_hi:[0,0,1]
    v_pk_fma_f32 v[98:99], v[112:113], v[106:107], v[98:99] op_sel_hi:[0,1,1] neg_lo:[0,0,1] neg_hi:[0,0,1]
    v_pk_fma_f32 v[100:101], v[112:113], v[108:109], v[100:101] op_sel_hi:[0,1,1] neg_lo:[0,0,1] neg_hi:[0,0,1]
    v_pk_fma_f32 v[102:103], v[112:113], v[110:111], v[102:103] op_sel_hi:[0,1,1] neg_lo:[0,0,1] neg_hi:[0,0,1]
    v_cvt_pk_bf16_f32 v52, v96, v97
    v_cvt_pk_bf16_f32 v53, v98, v99
    v_cvt_pk_bf16_f32 v54, v100, v101
    v_cvt_pk_bf16_f32 v55, v102, v103
    v_pk_fma_f32 v[104:105], v[112:113], v[96:97], v[104:105] op_sel_hi:[0,1,1] neg_lo:[0,0,1] neg_hi:[0,0,1]
    v_pk_fma_f32 v[106:107], v[112:113], v[98:99], v[106:107] op_sel_hi:[0,1,1] neg_lo:[0,0,1] neg_hi:[0,0,1]
    v_pk_fma_f32 v[108:109], v[112:113], v[100:101], v[108:109] op_sel_hi:[0,1,1] neg_lo:[0,0,1] neg_hi:[0,0,1]
    v_pk_fma_f32 v[110:111], v[112:113], v[102:103], v[110:111] op_sel_hi:[0,1,1] neg_lo:[0,0,1] neg_hi:[0,0,1]
    v_cvt_pk_bf16_f32 v56, v104, v105
    v_cvt_pk_bf16_f32 v57, v106, v107
    v_cvt_pk_bf16_f32 v58, v108, v109
    v_cvt_pk_bf16_f32 v59, v110, v111
    v_pk_fma_f32 v[96:97], v[112:113], v[104:105], v[96:97] op_sel_hi:[0,1,1] neg_lo:[0,0,1] neg_hi:[0,0,1]
    v_pk_fma_f32 v[98:99], v[112:113], v[106:107], v[98:99] op_sel_hi:[0,1,1] neg_lo:[0,0,1] neg_hi:[0,0,1]
    v_pk_fma_f32 v[100:101], v[112:113], v[108:109], v[100:101] op_sel_hi:[0,1,1] neg_lo:[0,0,1] neg_hi:[0,0,1]
    v_pk_fma_f32 v[102:103], v[112:113], v[110:111], v[102:103] op_sel_hi:[0,1,1] neg_lo:[0,0,1] neg_hi:[0,0,1]
    v_cvt_pk_bf16_f32 v60, v96, v97
    v_cvt_pk_bf16_f32 v61, v98, v99
    v_cvt_pk_bf16_f32 v62, v100, v101
    v_cvt_pk_bf16_f32 v63, v102, v103
    v_pk_fma_f32 v[104:105], v[112:113], v[96:97], v[104:105] op_sel_hi:[0,1,1] neg_lo:[0,0,1] neg_hi:[0,0,1]
    v_pk_fma_f32 v[106:107], v[112:113], v[98:99], v[106:107] op_sel_hi:[0,1,1] neg_lo:[0,0,1] neg_hi:[0,0,1]
    v_pk_fma_f32 v[108:109], v[112:113], v[100:101], v[108:109] op_sel_hi:[0,1,1] neg_lo:[0,0,1] neg_hi:[0,0,1]
    v_pk_fma_f32 v[110:111], v[112:113], v[102:103], v[110:111] op_sel_hi:[0,1,1] neg_lo:[0,0,1] neg_hi:[0,0,1]
    v_cvt_pk_bf16_f32 v64, v104, v105
    v_cvt_pk_bf16_f32 v65, v106, v107
    v_cvt_pk_bf16_f32 v66, v108, v109
    v_cvt_pk_bf16_f32 v67, v110, v111
    v_pk_fma_f32 v[96:97], v[112:113], v[104:105], v[96:97] op_sel_hi:[0,1,1] neg_lo:[0,0,1] neg_hi:[0,0,1]
    v_pk_fma_f32 v[98:99], v[112:113], v[106:107], v[98:99] op_sel_hi:[0,1,1] neg_lo:[0,0,1] neg_hi:[0,0,1]
    v_pk_fma_f32 v[100:101], v[112:113], v[108:109], v[100:101] op_sel_hi:[0,1,1] neg_lo:[0,0,1] neg_hi:[0,0,1]
    v_pk_fma_f32 v[102:103], v[112:113], v[110:111], v[102:103] op_sel_hi:[0,1,1] neg_lo:[0,0,1] neg_hi:[0,0,1]
    v_cvt_pk_bf16_f32 v68, v96, v97
    v_cvt_pk_bf16_f32 v69, v98, v99
    v_cvt_pk_bf16_f32 v70, v100, v101
    v_cvt_pk_bf16_f32 v71, v102, v103
    v_pk_fma_f32 v[104:105], v[112:113], v[96:97], v[104:105] op_sel_hi:[0,1,1] neg_lo:[0,0,1] neg_hi:[0,0,1]
    v_pk_fma_f32 v[106:107], v[112:113], v[98:99], v[106:107] op_sel_hi:[0,1,1] neg_lo:[0,0,1] neg_hi:[0,0,1]
    v_pk_fma_f32 v[108:109], v[112:113], v[100:101], v[108:109] op_sel_hi:[0,1,1] neg_lo:[0,0,1] neg_hi:[0,0,1]
    v_pk_fma_f32 v[110:111], v[112:113], v[102:103], v[110:111] op_sel_hi:[0,1,1] neg_lo:[0,0,1] neg_hi:[0,0,1]
    v_cvt_pk_bf16_f32 v72, v104, v105
    v_cvt_pk_bf16_f32 v73, v106, v107
    v_cvt_pk_bf16_f32 v74, v108, v109
    v_cvt_pk_bf16_f32 v75, v110, v111
    v_pk_fma_f32 v[96:97], v[112:113], v[104:105], v[96:97] op_sel_hi:[0,1,1] neg_lo:[0,0,1] neg_hi:[0,0,1]
    v_pk_fma_f32 v[98:99], v[112:113], v[106:107], v[98:99] op_sel_hi:[0,1,1] neg_lo:[0,0,1] neg_hi:[0,0,1]
    v_pk_fma_f32 v[100:101], v[112:113], v[108:109], v[100:101] op_sel_hi:[0,1,1] neg_lo:[0,0,1] neg_hi:[0,0,1]
    v_pk_fma_f32 v[102:103], v[112:113], v[110:111], v[102:103] op_sel_hi:[0,1,1] neg_lo:[0,0,1] neg_hi:[0,0,1]
    v_cvt_pk_bf16_f32 v76, v96, v97
    v_cvt_pk_bf16_f32 v77, v98, v99
    v_cvt_pk_bf16_f32 v78, v100, v101
    v_cvt_pk_bf16_f32 v79, v102, v103
    s_lshl_b32 s63, s3, 5
    v_add_u32 v95, s63, v2
    v_lshrrev_b32 v92, 1, v95
    v_and_b32 v93, 1, v95
    v_cvt_f32_u32 v93, v93
    v_mul_f32 v93, 0x3e800000, v93
    v_mov_b32 v94, 0x3d800000
    v_mov_b32 v96, 0x3d3504f3
    v_cmp_gt_u32 vcc, 2, v95
    s_nop 1
    v_cndmask_b32 v94, v94, v96, vcc
    v_mov_b32 v96, 0
    v_cndmask_b32 v93, v93, v96, vcc
    v_mov_b32 v96, 256
    v_cmp_eq_u32 vcc, 0, v95
    s_nop 1
    v_cndmask_b32 v92, v92, v96, vcc
    v_cvt_f32_u32 v92, v92
    v_mul_f32 v92, 0x3b000000, v92
    v_lshl_add_u32 v95, v3, 3, -16
    v_cvt_f32_i32 v95, v95
    v_fma_f32 v95, v92, v95, v93
    v_mul_f32 v113, 0x41800000, v92
    v_fract_f32 v114, v113
    v_cos_f32 v112, v114
    v_mov_b32 v114, v95
    v_add_f32 v112, v112, v112
    v_fract_f32 v96, v114
    v_add_f32 v104, v114, v113
    v_fract_f32 v104, v104
    v_add_f32 v114, v114, v92
    v_fract_f32 v97, v114
    v_add_f32 v105, v114, v113
    v_fract_f32 v105, v105
    v_add_f32 v114, v114, v92
    v_fract_f32 v98, v114
    v_add_f32 v106, v114, v113
    v_fract_f32 v106, v106
    v_add_f32 v114, v114, v92
    v_fract_f32 v99, v114
    v_add_f32 v107, v114, v113
    v_fract_f32 v107, v107
    v_add_f32 v114, v114, v92
    v_fract_f32 v100, v114
    v_add_f32 v108, v114, v113
    v_fract_f32 v108, v108
    v_add_f32 v114, v114, v92
    v_fract_f32 v101, v114
    v_add_f32 v109, v114, v113
    v_fract_f32 v109, v109
    v_add_f32 v114, v114, v92
    v_fract_f32 v102, v114
    v_add_f32 v110, v114, v113
    v_fract_f32 v110, v110
    v_add_f32 v114, v114, v92
    v_fract_f32 v103, v114
    v_add_f32 v111, v114, v113
    v_fract_f32 v111, v111
    v_cos_f32 v96, v96
    v_cos_f32 v104, v104
    v_cos_f32 v97, v97
    v_cos_f32 v105, v105
    v_cos_f32 v98, v98
    v_cos_f32 v106, v106
    v_cos_f32 v99, v99
    v_cos_f32 v107, v107
    v_cos_f32 v100, v100
    v_cos_f32 v108, v108
    v_cos_f32 v101, v101
    v_cos_f32 v109, v109
    v_cos_f32 v102, v102
    v_cos_f32 v110, v110
    v_cos_f32 v103, v103
    v_cos_f32 v111, v111
    v_mul_f32 v96, v96, v94
    v_mul_f32 v104, v104, v94
    v_mul_f32 v97, v97, v94
    v_mul_f32 v105, v105, v94
    v_mul_f32 v98, v98, v94
    v_mul_f32 v106, v106, v94
    v_mul_f32 v99, v99, v94
    v_mul_f32 v107, v107, v94
    v_mul_f32 v100, v100, v94
    v_mul_f32 v108, v108, v94
    v_mul_f32 v101, v101, v94
    v_mul_f32 v109, v109, v94
    v_mul_f32 v102, v102, v94
    v_mul_f32 v110, v110, v94
    v_mul_f32 v103, v103, v94
    v_mul_f32 v111, v111, v94
    v_cvt_pk_bf16_f32 v128, v104, v105
    v_cvt_pk_bf16_f32 v129, v106, v107
    v_cvt_pk_bf16_f32 v130, v108, v109
    v_cvt_pk_bf16_f32 v131, v110, v111
    v_pk_fma_f32 v[96:97], v[112:113], v[104:105], v[96:97] op_sel_hi:[0,1,1] neg_lo:[0,0,1] neg_hi:[0,0,1]
    v_pk_fma_f32 v[98:99], v[112:113], v[106:107], v[98:99] op_sel_hi:[0,1,1] neg_lo:[0,0,1] neg_hi:[0,0,1]
    v_pk_fma_f32 v[100:101], v[112:113], v[108:109], v[100:101] op_sel_hi:[0,1,1] neg_lo:[0,0,1] neg_hi:[0,0,1]
    v_pk_fma_f32 v[102:103], v[112:113], v[110:111], v[102:103] op_sel_hi:[0,1,1] neg_lo:[0,0,1] neg_hi:[0,0,1]
    v_cvt_pk_bf16_f32 v132, v96, v97
    v_cvt_pk_bf16_f32 v133, v98, v99
    v_cvt_pk_bf16_f32 v134, v100, v101
    v_cvt_pk_bf16_f32 v135, v102, v103
    v_pk_fma_f32 v[104:105], v[112:113], v[96:97], v[104:105] op_sel_hi:[0,1,1] neg_lo:[0,0,1] neg_hi:[0,0,1]
    v_pk_fma_f32 v[106:107], v[112:113], v[98:99], v[106:107] op_sel_hi:[0,1,1] neg_lo:[0,0,1] neg_hi:[0,0,1]
    v_pk_fma_f32 v[108:109], v[112:113], v[100:101], v[108:109] op_sel_hi:[0,1,1] neg_lo:[0,0,1] neg_hi:[0,0,1]
    v_pk_fma_f32 v[110:111], v[112:113], v[102:103], v[110:111] op_sel_hi:[0,1,1] neg_lo:[0,0,1] neg_hi:[0,0,1]
    v_cvt_pk_bf16_f32 v136, v104, v105
    v_cvt_pk_bf16_f32 v137, v106, v107
    v_cvt_pk_bf16_f32 v138, v108, v109
    v_cvt_pk_bf16_f32 v139, v110, v111
    v_pk_fma_f32 v[96:97], v[112:113], v[104:105], v[96:97] op_sel_hi:[0,1,1] neg_lo:[0,0,1] neg_hi:[0,0,1]
    v_pk_fma_f32 v[98:99], v[112:113], v[106:107], v[98:99] op_sel_hi:[0,1,1] neg_lo:[0,0,1] neg_hi:[0,0,1]
    v_pk_fma_f32 v[100:101], v[112:113], v[108:109], v[100:101] op_sel_hi:[0,1,1] neg_lo:[0,0,1] neg_hi:[0,0,1]
    v_pk_fma_f32 v[102:103], v[112:113], v[110:111], v[102:103] op_sel_hi:[0,1,1] neg_lo:[0,0,1] neg_hi:[0,0,1]
    v_cvt_pk_bf16_f32 v140, v96, v97
    v_cvt_pk_bf16_f32 v141, v98, v99
    v_cvt_pk_bf16_f32 v142, v100, v101
    v_cvt_pk_bf16_f32 v143, v102, v103
    v_pk_fma_f32 v[104:105], v[112:113], v[96:97], v[104:105] op_sel_hi:[0,1,1] neg_lo:[0,0,1] neg_hi:[0,0,1]
    v_pk_fma_f32 v[106:107], v[112:113], v[98:99], v[106:107] op_sel_hi:[0,1,1] neg_lo:[0,0,1] neg_hi:[0,0,1]
    v_pk_fma_f32 v[108:109], v[112:113], v[100:101], v[108:109] op_sel_hi:[0,1,1] neg_lo:[0,0,1] neg_hi:[0,0,1]
    v_pk_fma_f32 v[110:111], v[112:113], v[102:103], v[110:111] op_sel_hi:[0,1,1] neg_lo:[0,0,1] neg_hi:[0,0,1]
    v_cvt_pk_bf16_f32 v144, v104, v105
    v_cvt_pk_bf16_f32 v145, v106, v107
    v_cvt_pk_bf16_f32 v146, v108, v109
    v_cvt_pk_bf16_f32 v147, v110, v111
    v_pk_fma_f32 v[96:97], v[112:113], v[104:105], v[96:97] op_sel_hi:[0,1,1] neg_lo:[0,0,1] neg_hi:[0,0,1]
    v_pk_fma_f32 v[98:99], v[112:113], v[106:107], v[98:99] op_sel_hi:[0,1,1] neg_lo:[0,0,1] neg_hi:[0,0,1]
    v_pk_fma_f32 v[100:101], v[112:113], v[108:109], v[100:101] op_sel_hi:[0,1,1] neg_lo:[0,0,1] neg_hi:[0,0,1]
    v_pk_fma_f32 v[102:103], v[112:113], v[110:111], v[102:103] op_sel_hi:[0,1,1] neg_lo:[0,0,1] neg_hi:[0,0,1]
    v_cvt_pk_bf16_f32 v148, v96, v97
    v_cvt_pk_bf16_f32 v149, v98, v99
    v_cvt_pk_bf16_f32 v150, v100, v101
    v_cvt_pk_bf16_f32 v151, v102, v103
    v_pk_fma_f32 v[104:105], v[112:113], v[96:97], v[104:105] op_sel_hi:[0,1,1] neg_lo:[0,0,1] neg_hi:[0,0,1]
    v_pk_fma_f32 v[106:107], v[112:113], v[98:99], v[106:107] op_sel_hi:[0,1,1] neg_lo:[0,0,1] neg_hi:[0,0,1]
    v_pk_fma_f32 v[108:109], v[112:113], v[100:101], v[108:109] op_sel_hi:[0,1,1] neg_lo:[0,0,1] neg_hi:[0,0,1]
    v_pk_fma_f32 v[110:111], v[112:113], v[102:103], v[110:111] op_sel_hi:[0,1,1] neg_lo:[0,0,1] neg_hi:[0,0,1]
    v_cvt_pk_bf16_f32 v152, v104, v105
    v_cvt_pk_bf16_f32 v153, v106, v107
    v_cvt_pk_bf16_f32 v154, v108, v109
    v_cvt_pk_bf16_f32 v155, v110, v111
    v_pk_fma_f32 v[96:97], v[112:113], v[104:105], v[96:97] op_sel_hi:[0,1,1] neg_lo:[0,0,1] neg_hi:[0,0,1]
    v_pk_fma_f32 v[98:99], v[112:113], v[106:107], v[98:99] op_sel_hi:[0,1,1] neg_lo:[0,0,1] neg_hi:[0,0,1]
    v_pk_fma_f32 v[100:101], v[112:113], v[108:109], v[100:101] op_sel_hi:[0,1,1] neg_lo:[0,0,1] neg_hi:[0,0,1]
    v_pk_fma_f32 v[102:103], v[112:113], v[110:111], v[102:103] op_sel_hi:[0,1,1] neg_lo:[0,0,1] neg_hi:[0,0,1]
    v_cvt_pk_bf16_f32 v156, v96, v97
    v_cvt_pk_bf16_f32 v157, v98, v99
    v_cvt_pk_bf16_f32 v158, v100, v101
    v_cvt_pk_bf16_f32 v159, v102, v103
    v_pk_fma_f32 v[104:105], v[112:113], v[96:97], v[104:105] op_sel_hi:[0,1,1] neg_lo:[0,0,1] neg_hi:[0,0,1]
    v_pk_fma_f32 v[106:107], v[112:113], v[98:99], v[106:107] op_sel_hi:[0,1,1] neg_lo:[0,0,1] neg_hi:[0,0,1]
    v_pk_fma_f32 v[108:109], v[112:113], v[100:101], v[108:109] op_sel_hi:[0,1,1] neg_lo:[0,0,1] neg_hi:[0,0,1]
    v_pk_fma_f32 v[110:111], v[112:113], v[102:103], v[110:111] op_sel_hi:[0,1,1] neg_lo:[0,0,1] neg_hi:[0,0,1]
    v_cvt_pk_bf16_f32 v160, v104, v105
    v_cvt_pk_bf16_f32 v161, v106, v107
    v_cvt_pk_bf16_f32 v162, v108, v109
    v_cvt_pk_bf16_f32 v163, v110, v111
    v_pk_fma_f32 v[96:97], v[112:113], v[104:105], v[96:97] op_sel_hi:[0,1,1] neg_lo:[0,0,1] neg_hi:[0,0,1]
    v_pk_fma_f32 v[98:99], v[112:113], v[106:107], v[98:99] op_sel_hi:[0,1,1] neg_lo:[0,0,1] neg_hi:[0,0,1]
    v_pk_fma_f32 v[100:101], v[112:113], v[108:109], v[100:101] op_sel_hi:[0,1,1] neg_lo:[0,0,1] neg_hi:[0,0,1]
    v_pk_fma_f32 v[102:103], v[112:113], v[110:111], v[102:103] op_sel_hi:[0,1,1] neg_lo:[0,0,1] neg_hi:[0,0,1]
    v_cvt_pk_bf16_f32 v164, v96, v97
    v_cvt_pk_bf16_f32 v165, v98, v99
    v_cvt_pk_bf16_f32 v166, v100, v101
    v_cvt_pk_bf16_f32 v167, v102, v103
    v_pk_fma_f32 v[104:105], v[112:113], v[96:97], v[104:105] op_sel_hi:[0,1,1] neg_lo:[0,0,1] neg_hi:[0,0,1]
    v_pk_fma_f32 v[106:107], v[112:113], v[98:99], v[106:107] op_sel_hi:[0,1,1] neg_lo:[0,0,1] neg_hi:[0,0,1]
    v_pk_fma_f32 v[108:109], v[112:113], v[100:101], v[108:109] op_sel_hi:[0,1,1] neg_lo:[0,0,1] neg_hi:[0,0,1]
    v_pk_fma_f32 v[110:111], v[112:113], v[102:103], v[110:111] op_sel_hi:[0,1,1] neg_lo:[0,0,1] neg_hi:[0,0,1]
    v_cvt_pk_bf16_f32 v168, v104, v105
    v_cvt_pk_bf16_f32 v169, v106, v107
    v_cvt_pk_bf16_f32 v170, v108, v109
    v_cvt_pk_bf16_f32 v171, v110, v111
    v_pk_fma_f32 v[96:97], v[112:113], v[104:105], v[96:97] op_sel_hi:[0,1,1] neg_lo:[0,0,1] neg_hi:[0,0,1]
    v_pk_fma_f32 v[98:99], v[112:113], v[106:107], v[98:99] op_sel_hi:[0,1,1] neg_lo:[0,0,1] neg_hi:[0,0,1]
    v_pk_fma_f32 v[100:101], v[112:113], v[108:109], v[100:101] op_sel_hi:[0,1,1] neg_lo:[0,0,1] neg_hi:[0,0,1]
    v_pk_fma_f32 v[102:103], v[112:113], v[110:111], v[102:103] op_sel_hi:[0,1,1] neg_lo:[0,0,1] neg_hi:[0,0,1]
    v_cvt_pk_bf16_f32 v172, v96, v97
    v_cvt_pk_bf16_f32 v173, v98, v99
    v_cvt_pk_bf16_f32 v174, v100, v101
    v_cvt_pk_bf16_f32 v175, v102, v103
    v_pk_fma_f32 v[104:105], v[112:113], v[96:97], v[104:105] op_sel_hi:[0,1,1] neg_lo:[0,0,1] neg_hi:[0,0,1]
    v_pk_fma_f32 v[106:107], v[112:113], v[98:99], v[106:107] op_sel_hi:[0,1,1] neg_lo:[0,0,1] neg_hi:[0,0,1]
    v_pk_fma_f32 v[108:109], v[112:113], v[100:101], v[108:109] op_sel_hi:[0,1,1] neg_lo:[0,0,1] neg_hi:[0,0,1]
    v_pk_fma_f32 v[110:111], v[112:113], v[102:103], v[110:111] op_sel_hi:[0,1,1] neg_lo:[0,0,1] neg_hi:[0,0,1]
    v_cvt_pk_bf16_f32 v176, v104, v105
    v_cvt_pk_bf16_f32 v177, v106, v107
    v_cvt_pk_bf16_f32 v178, v108, v109
    v_cvt_pk_bf16_f32 v179, v110, v111
    v_pk_fma_f32 v[96:97], v[112:113], v[104:105], v[96:97] op_sel_hi:[0,1,1] neg_lo:[0,0,1] neg_hi:[0,0,1]
    v_pk_fma_f32 v[98:99], v[112:113], v[106:107], v[98:99] op_sel_hi:[0,1,1] neg_lo:[0,0,1] neg_hi:[0,0,1]
    v_pk_fma_f32 v[100:101], v[112:113], v[108:109], v[100:101] op_sel_hi:[0,1,1] neg_lo:[0,0,1] neg_hi:[0,0,1]
    v_pk_fma_f32 v[102:103], v[112:113], v[110:111], v[102:103] op_sel_hi:[0,1,1] neg_lo:[0,0,1] neg_hi:[0,0,1]
    v_cvt_pk_bf16_f32 v180, v96, v97
    v_cvt_pk_bf16_f32 v181, v98, v99
    v_cvt_pk_bf16_f32 v182, v100, v101
    v_cvt_pk_bf16_f32 v183, v102, v103
    v_pk_fma_f32 v[104:105], v[112:113], v[96:97], v[104:105] op_sel_hi:[0,1,1] neg_lo:[0,0,1] neg_hi:[0,0,1]
    v_pk_fma_f32 v[106:107], v[112:113], v[98:99], v[106:107] op_sel_hi:[0,1,1] neg_lo:[0,0,1] neg_hi:[0,0,1]
    v_pk_fma_f32 v[108:109], v[112:113], v[100:101], v[108:109] op_sel_hi:[0,1,1] neg_lo:[0,0,1] neg_hi:[0,0,1]
    v_pk_fma_f32 v[110:111], v[112:113], v[102:103], v[110:111] op_sel_hi:[0,1,1] neg_lo:[0,0,1] neg_hi:[0,0,1]
    v_cvt_pk_bf16_f32 v184, v104, v105
    v_cvt_pk_bf16_f32 v185, v106, v107
    v_cvt_pk_bf16_f32 v186, v108, v109
    v_cvt_pk_bf16_f32 v187, v110, v111
    v_pk_fma_f32 v[96:97], v[112:113], v[104:105], v[96:97] op_sel_hi:[0,1,1] neg_lo:[0,0,1] neg_hi:[0,0,1]
    v_pk_fma_f32 v[98:99], v[112:113], v[106:107], v[98:99] op_sel_hi:[0,1,1] neg_lo:[0,0,1] neg_hi:[0,0,1]
    v_pk_fma_f32 v[100:101], v[112:113], v[108:109], v[100:101] op_sel_hi:[0,1,1] neg_lo:[0,0,1] neg_hi:[0,0,1]
    v_pk_fma_f32 v[102:103], v[112:113], v[110:111], v[102:103] op_sel_hi:[0,1,1] neg_lo:[0,0,1] neg_hi:[0,0,1]
    v_cvt_pk_bf16_f32 v188, v96, v97
    v_cvt_pk_bf16_f32 v189, v98, v99
    v_cvt_pk_bf16_f32 v190, v100, v101
    v_cvt_pk_bf16_f32 v191, v102, v103
    v_pk_fma_f32 v[104:105], v[112:113], v[96:97], v[104:105] op_sel_hi:[0,1,1] neg_lo:[0,0,1] neg_hi:[0,0,1]
    v_pk_fma_f32 v[106:107], v[112:113], v[98:99], v[106:107] op_sel_hi:[0,1,1] neg_lo:[0,0,1] neg_hi:[0,0,1]
    v_pk_fma_f32 v[108:109], v[112:113], v[100:101], v[108:109] op_sel_hi:[0,1,1] neg_lo:[0,0,1] neg_hi:[0,0,1]
    v_pk_fma_f32 v[110:111], v[112:113], v[102:103], v[110:111] op_sel_hi:[0,1,1] neg_lo:[0,0,1] neg_hi:[0,0,1]
    v_cvt_pk_bf16_f32 v192, v104, v105
    v_cvt_pk_bf16_f32 v193, v106, v107
    v_cvt_pk_bf16_f32 v194, v108, v109
    v_cvt_pk_bf16_f32 v195, v110, v111
    v_pk_fma_f32 v[96:97], v[112:113], v[104:105], v[96:97] op_sel_hi:[0,1,1] neg_lo:[0,0,1] neg_hi:[0,0,1]
    v_pk_fma_f32 v[98:99], v[112:113], v[106:107], v[98:99] op_sel_hi:[0,1,1] neg_lo:[0,0,1] neg_hi:[0,0,1]
    v_pk_fma_f32 v[100:101], v[112:113], v[108:109], v[100:101] op_sel_hi:[0,1,1] neg_lo:[0,0,1] neg_hi:[0,0,1]
    v_pk_fma_f32 v[102:103], v[112:113], v[110:111], v[102:103] op_sel_hi:[0,1,1] neg_lo:[0,0,1] neg_hi:[0,0,1]
    v_cvt_pk_bf16_f32 v196, v96, v97
    v_cvt_pk_bf16_f32 v197, v98, v99
    v_cvt_pk_bf16_f32 v198, v100, v101
    v_cvt_pk_bf16_f32 v199, v102, v103
    v_pk_fma_f32 v[104:105], v[112:113], v[96:97], v[104:105] op_sel_hi:[0,1,1] neg_lo:[0,0,1] neg_hi:[0,0,1]
    v_pk_fma_f32 v[106:107], v[112:113], v[98:99], v[106:107] op_sel_hi:[0,1,1] neg_lo:[0,0,1] neg_hi:[0,0,1]
    v_pk_fma_f32 v[108:109], v[112:113], v[100:101], v[108:109] op_sel_hi:[0,1,1] neg_lo:[0,0,1] neg_hi:[0,0,1]
    v_pk_fma_f32 v[110:111], v[112:113], v[102:103], v[110:111] op_sel_hi:[0,1,1] neg_lo:[0,0,1] neg_hi:[0,0,1]
    v_cvt_pk_bf16_f32 v200, v104, v105
    v_cvt_pk_bf16_f32 v201, v106, v107
    v_cvt_pk_bf16_f32 v202, v108, v109
    v_cvt_pk_bf16_f32 v203, v110, v111
    v_pk_fma_f32 v[96:97], v[112:113], v[104:105], v[96:97] op_sel_hi:[0,1,1] neg_lo:[0,0,1] neg_hi:[0,0,1]
    v_pk_fma_f32 v[98:99], v[112:113], v[106:107], v[98:99] op_sel_hi:[0,1,1] neg_lo:[0,0,1] neg_hi:[0,0,1]
    v_pk_fma_f32 v[100:101], v[112:113], v[108:109], v[100:101] op_sel_hi:[0,1,1] neg_lo:[0,0,1] neg_hi:[0,0,1]
    v_pk_fma_f32 v[102:103], v[112:113], v[110:111], v[102:103] op_sel_hi:[0,1,1] neg_lo:[0,0,1] neg_hi:[0,0,1]
    v_cvt_pk_bf16_f32 v204, v96, v97
    v_cvt_pk_bf16_f32 v205, v98, v99
    v_cvt_pk_bf16_f32 v206, v100, v101
    v_cvt_pk_bf16_f32 v207, v102, v103
    v_pk_fma_f32 v[104:105], v[112:113], v[96:97], v[104:105] op_sel_hi:[0,1,1] neg_lo:[0,0,1] neg_hi:[0,0,1]
    v_pk_fma_f32 v[106:107], v[112:113], v[98:99], v[106:107] op_sel_hi:[0,1,1] neg_lo:[0,0,1] neg_hi:[0,0,1]
    v_pk_fma_f32 v[108:109], v[112:113], v[100:101], v[108:109] op_sel_hi:[0,1,1] neg_lo:[0,0,1] neg_hi:[0,0,1]
    v_pk_fma_f32 v[110:111], v[112:113], v[102:103], v[110:111] op_sel_hi:[0,1,1] neg_lo:[0,0,1] neg_hi:[0,0,1]
    v_cvt_pk_bf16_f32 v208, v104, v105
    v_cvt_pk_bf16_f32 v209, v106, v107
    v_cvt_pk_bf16_f32 v210, v108, v109
    v_cvt_pk_bf16_f32 v211, v110, v111
    v_pk_fma_f32 v[96:97], v[112:113], v[104:105], v[96:97] op_sel_hi:[0,1,1] neg_lo:[0,0,1] neg_hi:[0,0,1]
    v_pk_fma_f32 v[98:99], v[112:113], v[106:107], v[98:99] op_sel_hi:[0,1,1] neg_lo:[0,0,1] neg_hi:[0,0,1]
    v_pk_fma_f32 v[100:101], v[112:113], v[108:109], v[100:101] op_sel_hi:[0,1,1] neg_lo:[0,0,1] neg_hi:[0,0,1]
    v_pk_fma_f32 v[102:103], v[112:113], v[110:111], v[102:103] op_sel_hi:[0,1,1] neg_lo:[0,0,1] neg_hi:[0,0,1]
    v_cvt_pk_bf16_f32 v212, v96, v97
    v_cvt_pk_bf16_f32 v213, v98, v99
    v_cvt_pk_bf16_f32 v214, v100, v101
    v_cvt_pk_bf16_f32 v215, v102, v103
    v_pk_fma_f32 v[104:105], v[112:113], v[96:97], v[104:105] op_sel_hi:[0,1,1] neg_lo:[0,0,1] neg_hi:[0,0,1]
    v_pk_fma_f32 v[106:107], v[112:113], v[98:99], v[106:107] op_sel_hi:[0,1,1] neg_lo:[0,0,1] neg_hi:[0,0,1]
    v_pk_fma_f32 v[108:109], v[112:113], v[100:101], v[108:109] op_sel_hi:[0,1,1] neg_lo:[0,0,1] neg_hi:[0,0,1]
    v_pk_fma_f32 v[110:111], v[112:113], v[102:103], v[110:111] op_sel_hi:[0,1,1] neg_lo:[0,0,1] neg_hi:[0,0,1]
    v_cvt_pk_bf16_f32 v216, v104, v105
    v_cvt_pk_bf16_f32 v217, v106, v107
    v_cvt_pk_bf16_f32 v218, v108, v109
    v_cvt_pk_bf16_f32 v219, v110, v111
    v_pk_fma_f32 v[96:97], v[112:113], v[104:105], v[96:97] op_sel_hi:[0,1,1] neg_lo:[0,0,1] neg_hi:[0,0,1]
    v_pk_fma_f32 v[98:99], v[112:113], v[106:107], v[98:99] op_sel_hi:[0,1,1] neg_lo:[0,0,1] neg_hi:[0,0,1]
    v_pk_fma_f32 v[100:101], v[112:113], v[108:109], v[100:101] op_sel_hi:[0,1,1] neg_lo:[0,0,1] neg_hi:[0,0,1]
    v_pk_fma_f32 v[102:103], v[112:113], v[110:111], v[102:103] op_sel_hi:[0,1,1] neg_lo:[0,0,1] neg_hi:[0,0,1]
    v_cvt_pk_bf16_f32 v220, v96, v97
    v_cvt_pk_bf16_f32 v221, v98, v99
    v_cvt_pk_bf16_f32 v222, v100, v101
    v_cvt_pk_bf16_f32 v223, v102, v103
    v_pk_fma_f32 v[104:105], v[112:113], v[96:97], v[104:105] op_sel_hi:[0,1,1] neg_lo:[0,0,1] neg_hi:[0,0,1]
    v_pk_fma_f32 v[106:107], v[112:113], v[98:99], v[106:107] op_sel_hi:[0,1,1] neg_lo:[0,0,1] neg_hi:[0,0,1]
    v_pk_fma_f32 v[108:109], v[112:113], v[100:101], v[108:109] op_sel_hi:[0,1,1] neg_lo:[0,0,1] neg_hi:[0,0,1]
    v_pk_fma_f32 v[110:111], v[112:113], v[102:103], v[110:111] op_sel_hi:[0,1,1] neg_lo:[0,0,1] neg_hi:[0,0,1]
    v_cvt_pk_bf16_f32 v224, v104, v105
    v_cvt_pk_bf16_f32 v225, v106, v107
    v_cvt_pk_bf16_f32 v226, v108, v109
    v_cvt_pk_bf16_f32 v227, v110, v111
    v_pk_fma_f32 v[96:97], v[112:113], v[104:105], v[96:97] op_sel_hi:[0,1,1] neg_lo:[0,0,1] neg_hi:[0,0,1]
    v_pk_fma_f32 v[98:99], v[112:113], v[106:107], v[98:99] op_sel_hi:[0,1,1] neg_lo:[0,0,1] neg_hi:[0,0,1]
    v_pk_fma_f32 v[100:101], v[112:113], v[108:109], v[100:101] op_sel_hi:[0,1,1] neg_lo:[0,0,1] neg_hi:[0,0,1]
    v_pk_fma_f32 v[102:103], v[112:113], v[110:111], v[102:103] op_sel_hi:[0,1,1] neg_lo:[0,0,1] neg_hi:[0,0,1]
    v_cvt_pk_bf16_f32 v228, v96, v97
    v_cvt_pk_bf16_f32 v229, v98, v99
    v_cvt_pk_bf16_f32 v230, v100, v101
    v_cvt_pk_bf16_f32 v231, v102, v103
    v_pk_fma_f32 v[104:105], v[112:113], v[96:97], v[104:105] op_sel_hi:[0,1,1] neg_lo:[0,0,1] neg_hi:[0,0,1]
    v_pk_fma_f32 v[106:107], v[112:113], v[98:99], v[106:107] op_sel_hi:[0,1,1] neg_lo:[0,0,1] neg_hi:[0,0,1]
    v_pk_fma_f32 v[108:109], v[112:113], v[100:101], v[108:109] op_sel_hi:[0,1,1] neg_lo:[0,0,1] neg_hi:[0,0,1]
    v_pk_fma_f32 v[110:111], v[112:113], v[102:103], v[110:111] op_sel_hi:[0,1,1] neg_lo:[0,0,1] neg_hi:[0,0,1]
    v_cvt_pk_bf16_f32 v232, v104, v105
    v_cvt_pk_bf16_f32 v233, v106, v107
    v_cvt_pk_bf16_f32 v234, v108, v109
    v_cvt_pk_bf16_f32 v235, v110, v111
    v_pk_fma_f32 v[96:97], v[112:113], v[104:105], v[96:97] op_sel_hi:[0,1,1] neg_lo:[0,0,1] neg_hi:[0,0,1]
    v_pk_fma_f32 v[98:99], v[112:113], v[106:107], v[98:99] op_sel_hi:[0,1,1] neg_lo:[0,0,1] neg_hi:[0,0,1]
    v_pk_fma_f32 v[100:101], v[112:113], v[108:109], v[100:101] op_sel_hi:[0,1,1] neg_lo:[0,0,1] neg_hi:[0,0,1]
    v_pk_fma_f32 v[102:103], v[112:113], v[110:111], v[102:103] op_sel_hi:[0,1,1] neg_lo:[0,0,1] neg_hi:[0,0,1]
    v_cvt_pk_bf16_f32 v236, v96, v97
    v_cvt_pk_bf16_f32 v237, v98, v99
    v_cvt_pk_bf16_f32 v238, v100, v101
    v_cvt_pk_bf16_f32 v239, v102, v103
    v_pk_fma_f32 v[104:105], v[112:113], v[96:97], v[104:105] op_sel_hi:[0,1,1] neg_lo:[0,0,1] neg_hi:[0,0,1]
    v_pk_fma_f32 v[106:107], v[112:113], v[98:99], v[106:107] op_sel_hi:[0,1,1] neg_lo:[0,0,1] neg_hi:[0,0,1]
    v_pk_fma_f32 v[108:109], v[112:113], v[100:101], v[108:109] op_sel_hi:[0,1,1] neg_lo:[0,0,1] neg_hi:[0,0,1]
    v_pk_fma_f32 v[110:111], v[112:113], v[102:103], v[110:111] op_sel_hi:[0,1,1] neg_lo:[0,0,1] neg_hi:[0,0,1]
    v_cvt_pk_bf16_f32 v240, v104, v105
    v_cvt_pk_bf16_f32 v241, v106, v107
    v_cvt_pk_bf16_f32 v242, v108, v109
    v_cvt_pk_bf16_f32 v243, v110, v111
    v_pk_fma_f32 v[96:97], v[112:113], v[104:105], v[96:97] op_sel_hi:[0,1,1] neg_lo:[0,0,1] neg_hi:[0,0,1]
    v_pk_fma_f32 v[98:99], v[112:113], v[106:107], v[98:99] op_sel_hi:[0,1,1] neg_lo:[0,0,1] neg_hi:[0,0,1]
    v_pk_fma_f32 v[100:101], v[112:113], v[108:109], v[100:101] op_sel_hi:[0,1,1] neg_lo:[0,0,1] neg_hi:[0,0,1]
    v_pk_fma_f32 v[102:103], v[112:113], v[110:111], v[102:103] op_sel_hi:[0,1,1] neg_lo:[0,0,1] neg_hi:[0,0,1]
    v_cvt_pk_bf16_f32 v244, v96, v97
    v_cvt_pk_bf16_f32 v245, v98, v99
    v_cvt_pk_bf16_f32 v246, v100, v101
    v_cvt_pk_bf16_f32 v247, v102, v103
    v_pk_fma_f32 v[104:105], v[112:113], v[96:97], v[104:105] op_sel_hi:[0,1,1] neg_lo:[0,0,1] neg_hi:[0,0,1]
    v_pk_fma_f32 v[106:107], v[112:113], v[98:99], v[106:107] op_sel_hi:[0,1,1] neg_lo:[0,0,1] neg_hi:[0,0,1]
    v_pk_fma_f32 v[108:109], v[112:113], v[100:101], v[108:109] op_sel_hi:[0,1,1] neg_lo:[0,0,1] neg_hi:[0,0,1]
    v_pk_fma_f32 v[110:111], v[112:113], v[102:103], v[110:111] op_sel_hi:[0,1,1] neg_lo:[0,0,1] neg_hi:[0,0,1]
    v_cvt_pk_bf16_f32 v248, v104, v105
    v_cvt_pk_bf16_f32 v249, v106, v107
    v_cvt_pk_bf16_f32 v250, v108, v109
    v_cvt_pk_bf16_f32 v251, v110, v111
    v_pk_fma_f32 v[96:97], v[112:113], v[104:105], v[96:97] op_sel_hi:[0,1,1] neg_lo:[0,0,1] neg_hi:[0,0,1]
    v_pk_fma_f32 v[98:99], v[112:113], v[106:107], v[98:99] op_sel_hi:[0,1,1] neg_lo:[0,0,1] neg_hi:[0,0,1]
    v_pk_fma_f32 v[100:101], v[112:113], v[108:109], v[100:101] op_sel_hi:[0,1,1] neg_lo:[0,0,1] neg_hi:[0,0,1]
    v_pk_fma_f32 v[102:103], v[112:113], v[110:111], v[102:103] op_sel_hi:[0,1,1] neg_lo:[0,0,1] neg_hi:[0,0,1]
    v_cvt_pk_bf16_f32 v252, v96, v97
    v_cvt_pk_bf16_f32 v253, v98, v99
    v_cvt_pk_bf16_f32 v254, v100, v101
    v_cvt_pk_bf16_f32 v255, v102, v103
    v_mov_b32 v9, 0
    buffer_load_dword v126, v9, s[36:39], 0 offen sc0 sc1
    v_lshrrev_b32 v6, 3, v2
    v_lshlrev_b32 v6, 10, v6
    v_and_b32 v7, 7, v2
    v_lshl_add_u32 v6, v7, 7, v6
    v_bfe_u32 v7, v2, 1, 3
    v_add_u32 v8, 0, v3
    v_xor_b32 v8, v8, v7
    v_lshl_add_u32 v121, v8, 4, v6
    v_add_u32 v8, 2, v3
    v_xor_b32 v8, v8, v7
    v_lshl_add_u32 v122, v8, 4, v6
    v_add_u32 v8, 4, v3
    v_xor_b32 v8, v8, v7
    v_lshl_add_u32 v123, v8, 4, v6
    v_add_u32 v8, 6, v3
    v_xor_b32 v8, v8, v7
    v_lshl_add_u32 v124, v8, 4, v6
    s_lshl_b32 s53, s51, 14
    v_add_u32 v121, s53, v121
    v_add_u32 v122, s53, v122
    v_add_u32 v123, s53, v123
    v_add_u32 v124, s53, v124
    s_waitcnt vmcnt(5)
    s_barrier
    ds_read_b128 v[96:99], v121 offset:0
    ds_read_b128 v[100:103], v122 offset:0
    ds_read_b128 v[104:107], v123 offset:0
    ds_read_b128 v[108:111], v124 offset:0
    s_waitcnt lgkmcnt(3)
    v_mfma_f32_32x32x16_bf16 v[80:95], v[16:19], v[96:99], 0
    ds_read_b128 v[96:99], v121 offset:4096
    s_waitcnt lgkmcnt(3)
    v_mfma_f32_32x32x16_bf16 v[80:95], v[20:23], v[100:103], v[80:95]
    ds_read_b128 v[100:103], v122 offset:4096
    s_waitcnt lgkmcnt(3)
    v_mfma_f32_32x32x16_bf16 v[80:95], v[24:27], v[104:107], v[80:95]
    ds_read_b128 v[104:107], v123 offset:4096
    s_waitcnt lgkmcnt(3)
    v_mfma_f32_32x32x16_bf16 v[80:95], v[28:31], v[108:111], v[80:95]
    ds_read_b128 v[108:111], v124 offset:4096
    s_waitcnt lgkmcnt(3)
    v_mfma_f32_32x32x16_bf16 v[80:95], v[32:35], v[96:99], v[80:95]
    ds_read_b128 v[96:99], v121 offset:8192
    s_waitcnt lgkmcnt(3)
    v_mfma_f32_32x32x16_bf16 v[80:95], v[36:39], v[100:103], v[80:95]
    ds_read_b128 v[100:103], v122 offset:8192
    s_waitcnt lgkmcnt(3)
    v_mfma_f32_32x32x16_bf16 v[80:95], v[40:43], v[104:107], v[80:95]
    ds_read_b128 v[104:107], v123 offset:8192
    s_waitcnt lgkmcnt(3)
    v_mfma_f32_32x32x16_bf16 v[80:95], v[44:47], v[108:111], v[80:95]
    ds_read_b128 v[108:111], v124 offset:8192
    s_waitcnt lgkmcnt(3)
    v_mfma_f32_32x32x16_bf16 v[80:95], v[48:51], v[96:99], v[80:95]
    ds_read_b128 v[96:99], v121 offset:12288
    s_waitcnt lgkmcnt(3)
    v_mfma_f32_32x32x16_bf16 v[80:95], v[52:55], v[100:103], v[80:95]
    ds_read_b128 v[100:103], v122 offset:12288
    s_waitcnt lgkmcnt(3)
    v_mfma_f32_32x32x16_bf16 v[80:95], v[56:59], v[104:107], v[80:95]
    ds_read_b128 v[104:107], v123 offset:12288
    s_waitcnt lgkmcnt(3)
    v_mfma_f32_32x32x16_bf16 v[80:95], v[60:63], v[108:111], v[80:95]
    ds_read_b128 v[108:111], v124 offset:12288
    s_waitcnt lgkmcnt(3)
    v_mfma_f32_32x32x16_bf16 v[80:95], v[64:67], v[96:99], v[80:95]
    s_waitcnt lgkmcnt(2)
    v_mfma_f32_32x32x16_bf16 v[80:95], v[68:71], v[100:103], v[80:95]
    s_waitcnt lgkmcnt(1)
    v_mfma_f32_32x32x16_bf16 v[80:95], v[72:75], v[104:107], v[80:95]
    s_waitcnt lgkmcnt(0)
    v_mfma_f32_32x32x16_bf16 v[80:95], v[76:79], v[108:111], v[80:95]
    s_mov_b32 s86, 4194304
    v_lshlrev_b32 v9, 14, v3
    v_lshl_add_u32 v9, v2, 3, v9
    s_lshl_b32 s56, s52, 1
    s_add_u32 s56, s56, s51
    s_lshl_b32 s56, s56, 16
    s_lshl_b32 s57, s48, 8
    s_add_u32 s56, s56, s57
    s_add_u32 s56, s56, s86
    v_mov_b32 v10, -1
    v_mov_b32 v11, -1
    buffer_store_dwordx2 v[10:11], v9, s[4:7], s56 offen sc1
    s_add_u32 s56, s56, 32768
    buffer_store_dwordx2 v[10:11], v9, s[4:7], s56 offen sc1
    s_cmp_eq_u32 s3, 0
    s_cbranch_scc0 L_m_FL11
    v_lshlrev_b32 v9, 2, v2
    s_lshl_b32 s53, s49, 13
    s_lshl_b32 s54, s48, 7
    s_add_u32 s53, s53, s54
    s_add_u32 s53, s53, 30474240
    s_mov_b32 exec_hi, 0
    buffer_store_dword v10, v9, s[4:7], s53 offen sc1
    s_mov_b32 exec_hi, -1
L_m_FL11:
    s_lshl_b32 s53, s50, 1
    s_add_u32 s54, s53, s51
    s_xor_b32 s55, s54, 1
    s_lshl_b32 s54, s54, 11
    s_lshl_b32 s55, s55, 11
    v_lshlrev_b32 v6, 4, v1
    v_add_u32 v7, s55, v6
    v_add_u32 v6, s54, v6
    v_add_u32 v7, 99328, v7
    v_add_u32 v6, 99328, v6
    s_cmp_eq_u32 s51, 0
    s_cbranch_scc0 L_m_RH12_k1
    ds_write_b128 v7, v[88:91] offset:0
    ds_write_b128 v7, v[92:95] offset:1024
    s_branch L_m_RH12_j
L_m_RH12_k1:
    ds_write_b128 v7, v[80:83] offset:0
    ds_write_b128 v7, v[84:87] offset:1024
    v_mov_b32 v80, v88
    v_mov_b32 v81, v89
    v_mov_b32 v82, v90
    v_mov_b32 v83, v91
    v_mov_b32 v84, v92
    v_mov_b32 v85, v93
    v_mov_b32 v86, v94
    v_mov_b32 v87, v95
L_m_RH12_j:
    s_waitcnt lgkmcnt(0)
    s_barrier
    ds_read_b128 v[88:91], v6 offset:0
    ds_read_b128 v[92:95], v6 offset:1024
    s_waitcnt lgkmcnt(0)
    v_pk_add_f32 v[80:81], v[80:81], v[88:89]
    v_pk_add_f32 v[82:83], v[82:83], v[90:91]
    v_pk_add_f32 v[84:85], v[84:85], v[92:93]
    v_pk_add_f32 v[86:87], v[86:87], v[94:95]
    s_mov_b32 s86, 0
    s_mov_b32 s87, 30408704
    v_cvt_pk_bf16_f32 v88, v80, v81
    v_cvt_pk_bf16_f32 v89, v82, v83
    v_cvt_pk_bf16_f32 v90, v84, v85
    v_cvt_pk_bf16_f32 v91, v86, v87
    v_min_u32 v88, -2, v88
    v_min_u32 v89, -2, v89
    v_min_u32 v90, -2, v90
    v_min_u32 v91, -2, v91
    v_lshlrev_b32 v9, 14, v3
    v_lshl_add_u32 v9, v2, 3, v9
    s_lshl_b32 s56, s52, 1
    s_add_u32 s56, s56, s51
    s_lshl_b32 s56, s56, 16
    s_lshl_b32 s57, s48, 8
    s_add_u32 s56, s56, s57
    s_add_u32 s56, s56, s86
    buffer_store_dwordx2 v[88:89], v9, s[4:7], s56 offen offset:0 sc1
    s_add_u32 s56, s56, 32768
    buffer_store_dwordx2 v[90:91], v9, s[4:7], s56 offen offset:0 sc1
    s_or_b32 s53, s52, s51
    s_cmp_eq_u32 s53, 0
    s_cselect_b32 s53, 32, 0
    v_cmp_le_u32 vcc, s53, v1
    s_lshl_b32 s53, s3, 7
    s_add_u32 s53, s53, 115712
    v_lshl_add_u32 v10, v2, 2, s53
    v_cndmask_b32 v6, 0, v81, vcc
    v_mul_f32 v7, v80, v80
    v_fmac_f32 v7, v6, v6
    v_fmac_f32 v7, v82, v82
    v_fmac_f32 v7, v83, v83
    v_fmac_f32 v7, v84, v84
    v_fmac_f32 v7, v85, v85
    v_fmac_f32 v7, v86, v86
    v_fmac_f32 v7, v87, v87
    v_mov_b32 v8, v7
    s_nop 1
    v_permlane32_swap_b32 v7, v8
    v_add_f32 v7, v7, v8
    ds_write_b32 v10, v7 offset:0
    s_waitcnt lgkmcnt(0)
    s_barrier
    s_cmp_ge_u32 s3, 1
    s_cbranch_scc1 L_m_SS13
    v_lshlrev_b32 v6, 2, v2
    s_mul_i32 s53, s3, 17408
    s_add_u32 s53, s53, 115712
    v_add_u32 v7, s53, v6
    ds_read_b32 v80, v7 offset:0
    ds_read_b32 v81, v7 offset:128
    ds_read_b32 v82, v7 offset:256
    ds_read_b32 v83, v7 offset:384
    ds_read_b32 v84, v7 offset:512
    ds_read_b32 v85, v7 offset:640
    ds_read_b32 v86, v7 offset:768
    ds_read_b32 v87, v7 offset:896
    s_waitcnt lgkmcnt(0)
    v_add_f32 v80, v80, v81
    v_add_f32 v80, v80, v82
    v_add_f32 v80, v80, v83
    v_add_f32 v80, v80, v84
    v_add_f32 v80, v80, v85
    v_add_f32 v80, v80, v86
    v_add_f32 v80, v80, v87
    v_min_u32 v80, -2, v80
    s_lshl_b32 s53, s49, 13
    s_lshl_b32 s54, s48, 7
    s_add_u32 s53, s53, s54
    s_mul_i32 s54, s3, 1024
    s_add_u32 s53, s53, s54
    s_add_u32 s53, s53, s87
    s_mov_b32 exec_hi, 0
    buffer_store_dword v80, v6, s[4:7], s53 offen sc1
    s_mov_b32 exec_hi, -1
L_m_SS13:
    s_waitcnt vmcnt(0)
    v_readfirstlane_b32 s40, v126
    s_cmp_lg_u32 s40, 0
    s_nop 2
    s_cbranch_scc1 L_m_NG14_skip
    s_mov_b32 s89, 0x40000
    v_mov_b32 v9, 0
L_m_NG14_loop:
    buffer_load_dword v8, v9, s[36:39], 0 offen sc0 sc1
    s_waitcnt vmcnt(0)
    v_readfirstlane_b32 s40, v8
    s_cmp_lg_u32 s40, 0
    s_nop 2
    s_cbranch_scc1 L_m_NG14_skip
    s_sub_u32 s89, s89, 1
    s_cmp_lg_u32 s89, 0
    s_cbranch_scc1 L_m_NG14_loop
L_m_NG14_skip:
    s_waitcnt vmcnt(0)
    s_barrier
    s_cmp_eq_u32 s3, 0
    s_cbranch_scc0 L_m_PUB15
    s_add_u32 s91, s40, 1
    s_lshl_b32 s90, s2, 7
    s_add_u32 s90, s90, 31457280
    v_mov_b32 v8, s91
    v_mov_b32 v9, 0
    s_mov_b64 exec, 1
    buffer_store_dword v8, v9, s[4:7], s90 offen sc0 sc1
    s_mov_b64 exec, -1
L_m_PUB15:
    s_barrier
    v_lshlrev_b32 v6, 3, v3
    v_sub_u32 v6, v2, v6
    v_mov_b32 v7, 0
    v_mov_b32 v8, 0x3f80
    v_cmp_eq_u32 vcc, 0, v6
    s_nop 1
    v_cndmask_b32 v7, v7, v8, vcc
    v_mov_b32 v8, 0x3f800000
    v_cmp_eq_u32 vcc, 1, v6
    s_nop 1
    v_cndmask_b32 v16, v7, v8, vcc
    v_mov_b32 v7, 0
    v_mov_b32 v8, 0x3f80
    v_cmp_eq_u32 vcc, 2, v6
    s_nop 1
    v_cndmask_b32 v7, v7, v8, vcc
    v_mov_b32 v8, 0x3f800000
    v_cmp_eq_u32 vcc, 3, v6
    s_nop 1
    v_cndmask_b32 v17, v7, v8, vcc
    v_mov_b32 v7, 0
    v_mov_b32 v8, 0x3f80
    v_cmp_eq_u32 vcc, 4, v6
    s_nop 1
    v_cndmask_b32 v7, v7, v8, vcc
    v_mov_b32 v8, 0x3f800000
    v_cmp_eq_u32 vcc, 5, v6
    s_nop 1
    v_cndmask_b32 v18, v7, v8, vcc
    v_mov_b32 v7, 0
    v_mov_b32 v8, 0x3f80
    v_cmp_eq_u32 vcc, 6, v6
    s_nop 1
    v_cndmask_b32 v7, v7, v8, vcc
    v_mov_b32 v8, 0x3f800000
    v_cmp_eq_u32 vcc, 7, v6
    s_nop 1
    v_cndmask_b32 v19, v7, v8, vcc
    v_mov_b32 v7, 0
    v_mov_b32 v8, 0x3f80
    v_cmp_eq_u32 vcc, 16, v6
    s_nop 1
    v_cndmask_b32 v7, v7, v8, vcc
    v_mov_b32 v8, 0x3f800000
    v_cmp_eq_u32 vcc, 17, v6
    s_nop 1
    v_cndmask_b32 v20, v7, v8, vcc
    v_mov_b32 v7, 0
    v_mov_b32 v8, 0x3f80
    v_cmp_eq_u32 vcc, 18, v6
    s_nop 1
    v_cndmask_b32 v7, v7, v8, vcc
    v_mov_b32 v8, 0x3f800000
    v_cmp_eq_u32 vcc, 19, v6
    s_nop 1
    v_cndmask_b32 v21, v7, v8, vcc
    v_mov_b32 v7, 0
    v_mov_b32 v8, 0x3f80
    v_cmp_eq_u32 vcc, 20, v6
    s_nop 1
    v_cndmask_b32 v7, v7, v8, vcc
    v_mov_b32 v8, 0x3f800000
    v_cmp_eq_u32 vcc, 21, v6
    s_nop 1
    v_cndmask_b32 v22, v7, v8, vcc
    v_mov_b32 v7, 0
    v_mov_b32 v8, 0x3f80
    v_cmp_eq_u32 vcc, 22, v6
    s_nop 1
    v_cndmask_b32 v7, v7, v8, vcc
    v_mov_b32 v8, 0x3f800000
    v_cmp_eq_u32 vcc, 23, v6
    s_nop 1
    v_cndmask_b32 v23, v7, v8, vcc
L_m_T7_loop:
    s_add_u32 s66, s3, 8
    s_lshl_b32 s63, s66, 5
    v_add_u32 v95, s63, v2
    v_lshrrev_b32 v92, 1, v95
    v_and_b32 v93, 1, v95
    v_cvt_f32_u32 v93, v93
    v_mul_f32 v93, 0x3e800000, v93
    v_mov_b32 v94, 0x3d800000
    v_mov_b32 v96, 0x3d3504f3
    v_cmp_gt_u32 vcc, 2, v95
    s_nop 1
    v_cndmask_b32 v94, v94, v96, vcc
    v_mov_b32 v96, 0
    v_cndmask_b32 v93, v93, v96, vcc
    v_mov_b32 v96, 256
    v_cmp_eq_u32 vcc, 0, v95
    s_nop 1
    v_cndmask_b32 v92, v92, v96, vcc
    v_cvt_f32_u32 v92, v92
    v_mul_f32 v92, 0x3b000000, v92
    v_lshl_add_u32 v95, v3, 3, -16
    v_cvt_f32_i32 v95, v95
    v_fma_f32 v95, v92, v95, v93
    v_mul_f32 v113, 0x41800000, v92
    v_fract_f32 v114, v113
    v_cos_f32 v112, v114
    v_mov_b32 v114, v95
    v_add_f32 v112, v112, v112
    v_fract_f32 v96, v114
    v_add_f32 v104, v114, v113
    v_fract_f32 v104, v104
    v_add_f32 v114, v114, v92
    v_fract_f32 v97, v114
    v_add_f32 v105, v114, v113
    v_fract_f32 v105, v105
    v_add_f32 v114, v114, v92
    v_fract_f32 v98, v114
    v_add_f32 v106, v114, v113
    v_fract_f32 v106, v106
    v_add_f32 v114, v114, v92
    v_fract_f32 v99, v114
    v_add_f32 v107, v114, v113
    v_fract_f32 v107, v107
    v_add_f32 v114, v114, v92
    v_fract_f32 v100, v114
    v_add_f32 v108, v114, v113
    v_fract_f32 v108, v108
    v_add_f32 v114, v114, v92
    v_fract_f32 v101, v114
    v_add_f32 v109, v114, v113
    v_fract_f32 v109, v109
    v_add_f32 v114, v114, v92
    v_fract_f32 v102, v114
    v_add_f32 v110, v114, v113
    v_fract_f32 v110, v110
    v_add_f32 v114, v114, v92
    v_fract_f32 v103, v114
    v_add_f32 v111, v114, v113
    v_fract_f32 v111, v111
    v_cos_f32 v96, v96
    v_cos_f32 v104, v104
    v_cos_f32 v97, v97
    v_cos_f32 v105, v105
    v_cos_f32 v98, v98
    v_cos_f32 v106, v106
    v_cos_f32 v99, v99
    v_cos_f32 v107, v107
    v_cos_f32 v100, v100
    v_cos_f32 v108, v108
    v_cos_f32 v101, v101
    v_cos_f32 v109, v109
    v_cos_f32 v102, v102
    v_cos_f32 v110, v110
    v_cos_f32 v103, v103
    v_cos_f32 v111, v111
    v_mul_f32 v96, v96, v94
    v_mul_f32 v104, v104, v94
    v_mul_f32 v97, v97, v94
    v_mul_f32 v105, v105, v94
    v_mul_f32 v98, v98, v94
    v_mul_f32 v106, v106, v94
    v_mul_f32 v99, v99, v94
    v_mul_f32 v107, v107, v94
    v_mul_f32 v100, v100, v94
    v_mul_f32 v108, v108, v94
    v_mul_f32 v101, v101, v94
    v_mul_f32 v109, v109, v94
    v_mul_f32 v102, v102, v94
    v_mul_f32 v110, v110, v94
    v_mul_f32 v103, v103, v94
    v_mul_f32 v111, v111, v94
    s_waitcnt vmcnt(0)
    s_barrier
    s_mov_b32 s58, s74
    s_cmp_ge_u32 s58, 86
    s_cbranch_scc1 L_m_TU16_t2
    v_and_b32 v6, 1, v5
    v_mul_u32_u24 v6, 16512, v6
    v_lshl_add_u32 v6, v3, 8, v6
    v_lshrrev_b32 v7, 2, v4
    v_lshl_add_u32 v6, v7, 5, v6
    v_and_b32 v7, 3, v1
    v_lshl_add_u32 v88, v7, 3, v6
    v_add_u32 v88, s64, v88
    ds_read_b64_tr_b16 v[72:73], v88 offset:0
    ds_read_b64_tr_b16 v[74:75], v88 offset:128
    ds_read_b64_tr_b16 v[76:77], v88 offset:512
    ds_read_b64_tr_b16 v[78:79], v88 offset:640
    ds_read_b64_tr_b16 v[80:81], v88 offset:1024
    ds_read_b64_tr_b16 v[82:83], v88 offset:1152
    ds_read_b64_tr_b16 v[84:85], v88 offset:1536
    ds_read_b64_tr_b16 v[86:87], v88 offset:1664
    v_cvt_pk_bf16_f32 v116, v104, v105
    v_cvt_pk_bf16_f32 v117, v106, v107
    v_cvt_pk_bf16_f32 v118, v108, v109
    v_cvt_pk_bf16_f32 v119, v110, v111
    v_pk_fma_f32 v[96:97], v[112:113], v[104:105], v[96:97] op_sel_hi:[0,1,1] neg_lo:[0,0,1] neg_hi:[0,0,1]
    v_pk_fma_f32 v[98:99], v[112:113], v[106:107], v[98:99] op_sel_hi:[0,1,1] neg_lo:[0,0,1] neg_hi:[0,0,1]
    v_pk_fma_f32 v[100:101], v[112:113], v[108:109], v[100:101] op_sel_hi:[0,1,1] neg_lo:[0,0,1] neg_hi:[0,0,1]
    v_pk_fma_f32 v[102:103], v[112:113], v[110:111], v[102:103] op_sel_hi:[0,1,1] neg_lo:[0,0,1] neg_hi:[0,0,1]
    s_waitcnt lgkmcnt(6)
    v_mfma_f32_32x32x16_bf16 v[24:39], v[128:131], v[72:75], 0
    v_mfma_f32_32x32x16_bf16 v[40:55], v[116:119], v[72:75], 0
    ds_read_b64_tr_b16 v[72:73], v88 offset:2048
    ds_read_b64_tr_b16 v[74:75], v88 offset:2176
    v_cvt_pk_bf16_f32 v120, v96, v97
    v_cvt_pk_bf16_f32 v121, v98, v99
    v_cvt_pk_bf16_f32 v122, v100, v101
    v_cvt_pk_bf16_f32 v123, v102, v103
    v_pk_fma_f32 v[104:105], v[112:113], v[96:97], v[104:105] op_sel_hi:[0,1,1] neg_lo:[0,0,1] neg_hi:[0,0,1]
    v_pk_fma_f32 v[106:107], v[112:113], v[98:99], v[106:107] op_sel_hi:[0,1,1] neg_lo:[0,0,1] neg_hi:[0,0,1]
    v_pk_fma_f32 v[108:109], v[112:113], v[100:101], v[108:109] op_sel_hi:[0,1,1] neg_lo:[0,0,1] neg_hi:[0,0,1]
    v_pk_fma_f32 v[110:111], v[112:113], v[102:103], v[110:111] op_sel_hi:[0,1,1] neg_lo:[0,0,1] neg_hi:[0,0,1]
    s_waitcnt lgkmcnt(6)
    v_mfma_f32_32x32x16_bf16 v[24:39], v[132:135], v[76:79], v[24:39]
    v_mfma_f32_32x32x16_bf16 v[40:55], v[120:123], v[76:79], v[40:55]
    ds_read_b64_tr_b16 v[76:77], v88 offset:2560
    ds_read_b64_tr_b16 v[78:79], v88 offset:2688
    v_cvt_pk_bf16_f32 v116, v104, v105
    v_cvt_pk_bf16_f32 v117, v106, v107
    v_cvt_pk_bf16_f32 v118, v108, v109
    v_cvt_pk_bf16_f32 v119, v110, v111
    v_pk_fma_f32 v[96:97], v[112:113], v[104:105], v[96:97] op_sel_hi:[0,1,1] neg_lo:[0,0,1] neg_hi:[0,0,1]
    v_pk_fma_f32 v[98:99], v[112:113], v[106:107], v[98:99] op_sel_hi:[0,1,1] neg_lo:[0,0,1] neg_hi:[0,0,1]
    v_pk_fma_f32 v[100:101], v[112:113], v[108:109], v[100:101] op_sel_hi:[0,1,1] neg_lo:[0,0,1] neg_hi:[0,0,1]
    v_pk_fma_f32 v[102:103], v[112:113], v[110:111], v[102:103] op_sel_hi:[0,1,1] neg_lo:[0,0,1] neg_hi:[0,0,1]
    s_waitcnt lgkmcnt(6)
    v_mfma_f32_32x32x16_bf16 v[24:39], v[136:139], v[80:83], v[24:39]
    v_mfma_f32_32x32x16_bf16 v[40:55], v[116:119], v[80:83], v[40:55]
    ds_read_b64_tr_b16 v[80:81], v88 offset:3072
    ds_read_b64_tr_b16 v[82:83], v88 offset:3200
    v_cvt_pk_bf16_f32 v120, v96, v97
    v_cvt_pk_bf16_f32 v121, v98, v99
    v_cvt_pk_bf16_f32 v122, v100, v101
    v_cvt_pk_bf16_f32 v123, v102, v103
    v_pk_fma_f32 v[104:105], v[112:113], v[96:97], v[104:105] op_sel_hi:[0,1,1] neg_lo:[0,0,1] neg_hi:[0,0,1]
    v_pk_fma_f32 v[106:107], v[112:113], v[98:99], v[106:107] op_sel_hi:[0,1,1] neg_lo:[0,0,1] neg_hi:[0,0,1]
    v_pk_fma_f32 v[108:109], v[112:113], v[100:101], v[108:109] op_sel_hi:[0,1,1] neg_lo:[0,0,1] neg_hi:[0,0,1]
    v_pk_fma_f32 v[110:111], v[112:113], v[102:103], v[110:111] op_sel_hi:[0,1,1] neg_lo:[0,0,1] neg_hi:[0,0,1]
    s_waitcnt lgkmcnt(6)
    v_mfma_f32_32x32x16_bf16 v[24:39], v[140:143], v[84:87], v[24:39]
    v_mfma_f32_32x32x16_bf16 v[40:55], v[120:123], v[84:87], v[40:55]
    ds_read_b64_tr_b16 v[84:85], v88 offset:3584
    ds_read_b64_tr_b16 v[86:87], v88 offset:3712
    v_cvt_pk_bf16_f32 v116, v104, v105
    v_cvt_pk_bf16_f32 v117, v106, v107
    v_cvt_pk_bf16_f32 v118, v108, v109
    v_cvt_pk_bf16_f32 v119, v110, v111
    v_pk_fma_f32 v[96:97], v[112:113], v[104:105], v[96:97] op_sel_hi:[0,1,1] neg_lo:[0,0,1] neg_hi:[0,0,1]
    v_pk_fma_f32 v[98:99], v[112:113], v[106:107], v[98:99] op_sel_hi:[0,1,1] neg_lo:[0,0,1] neg_hi:[0,0,1]
    v_pk_fma_f32 v[100:101], v[112:113], v[108:109], v[100:101] op_sel_hi:[0,1,1] neg_lo:[0,0,1] neg_hi:[0,0,1]
    v_pk_fma_f32 v[102:103], v[112:113], v[110:111], v[102:103] op_sel_hi:[0,1,1] neg_lo:[0,0,1] neg_hi:[0,0,1]
    s_waitcnt lgkmcnt(6)
    v_mfma_f32_32x32x16_bf16 v[24:39], v[144:147], v[72:75], v[24:39]
    v_mfma_f32_32x32x16_bf16 v[40:55], v[116:119], v[72:75], v[40:55]
    ds_read_b64_tr_b16 v[72:73], v88 offset:4096
    ds_read_b64_tr_b16 v[74:75], v88 offset:4224
    v_cvt_pk_bf16_f32 v120, v96, v97
    v_cvt_pk_bf16_f32 v121, v98, v99
    v_cvt_pk_bf16_f32 v122, v100, v101
    v_cvt_pk_bf16_f32 v123, v102, v103
    v_pk_fma_f32 v[104:105], v[112:113], v[96:97], v[104:105] op_sel_hi:[0,1,1] neg_lo:[0,0,1] neg_hi:[0,0,1]
    v_pk_fma_f32 v[106:107], v[112:113], v[98:99], v[106:107] op_sel_hi:[0,1,1] neg_lo:[0,0,1] neg_hi:[0,0,1]
    v_pk_fma_f32 v[108:109], v[112:113], v[100:101], v[108:109] op_sel_hi:[0,1,1] neg_lo:[0,0,1] neg_hi:[0,0,1]
    v_pk_fma_f32 v[110:111], v[112:113], v[102:103], v[110:111] op_sel_hi:[0,1,1] neg_lo:[0,0,1] neg_hi:[0,0,1]
    s_waitcnt lgkmcnt(6)
    v_mfma_f32_32x32x16_bf16 v[24:39], v[148:151], v[76:79], v[24:39]
    v_mfma_f32_32x32x16_bf16 v[40:55], v[120:123], v[76:79], v[40:55]
    ds_read_b64_tr_b16 v[76:77], v88 offset:4608
    ds_read_b64_tr_b16 v[78:79], v88 offset:4736
    v_cvt_pk_bf16_f32 v116, v104, v105
    v_cvt_pk_bf16_f32 v117, v106, v107
    v_cvt_pk_bf16_f32 v118, v108, v109
    v_cvt_pk_bf16_f32 v119, v110, v111
    v_pk_fma_f32 v[96:97], v[112:113], v[104:105], v[96:97] op_sel_hi:[0,1,1] neg_lo:[0,0,1] neg_hi:[0,0,1]
    v_pk_fma_f32 v[98:99], v[112:113], v[106:107], v[98:99] op_sel_hi:[0,1,1] neg_lo:[0,0,1] neg_hi:[0,0,1]
    v_pk_fma_f32 v[100:101], v[112:113], v[108:109], v[100:101] op_sel_hi:[0,1,1] neg_lo:[0,0,1] neg_hi:[0,0,1]
    v_pk_fma_f32 v[102:103], v[112:113], v[110:111], v[102:103] op_sel_hi:[0,1,1] neg_lo:[0,0,1] neg_hi:[0,0,1]
    s_waitcnt lgkmcnt(6)
    v_mfma_f32_32x32x16_bf16 v[24:39], v[152:155], v[80:83], v[24:39]
    v_mfma_f32_32x32x16_bf16 v[40:55], v[116:119], v[80:83], v[40:55]
    ds_read_b64_tr_b16 v[80:81], v88 offset:5120
    ds_read_b64_tr_b16 v[82:83], v88 offset:5248
    v_cvt_pk_bf16_f32 v120, v96, v97
    v_cvt_pk_bf16_f32 v121, v98, v99
    v_cvt_pk_bf16_f32 v122, v100, v101
    v_cvt_pk_bf16_f32 v123, v102, v103
    v_pk_fma_f32 v[104:105], v[112:113], v[96:97], v[104:105] op_sel_hi:[0,1,1] neg_lo:[0,0,1] neg_hi:[0,0,1]
    v_pk_fma_f32 v[106:107], v[112:113], v[98:99], v[106:107] op_sel_hi:[0,1,1] neg_lo:[0,0,1] neg_hi:[0,0,1]
    v_pk_fma_f32 v[108:109], v[112:113], v[100:101], v[108:109] op_sel_hi:[0,1,1] neg_lo:[0,0,1] neg_hi:[0,0,1]
    v_pk_fma_f32 v[110:111], v[112:113], v[102:103], v[110:111] op_sel_hi:[0,1,1] neg_lo:[0,0,1] neg_hi:[0,0,1]
    s_waitcnt lgkmcnt(6)
    v_mfma_f32_32x32x16_bf16 v[24:39], v[156:159], v[84:87], v[24:39]
    v_mfma_f32_32x32x16_bf16 v[40:55], v[120:123], v[84:87], v[40:55]
    ds_read_b64_tr_b16 v[84:85], v88 offset:5632
    ds_read_b64_tr_b16 v[86:87], v88 offset:5760
    v_cvt_pk_bf16_f32 v116, v104, v105
    v_cvt_pk_bf16_f32 v117, v106, v107
    v_cvt_pk_bf16_f32 v118, v108, v109
    v_cvt_pk_bf16_f32 v119, v110, v111
    v_pk_fma_f32 v[96:97], v[112:113], v[104:105], v[96:97] op_sel_hi:[0,1,1] neg_lo:[0,0,1] neg_hi:[0,0,1]
    v_pk_fma_f32 v[98:99], v[112:113], v[106:107], v[98:99] op_sel_hi:[0,1,1] neg_lo:[0,0,1] neg_hi:[0,0,1]
    v_pk_fma_f32 v[100:101], v[112:113], v[108:109], v[100:101] op_sel_hi:[0,1,1] neg_lo:[0,0,1] neg_hi:[0,0,1]
    v_pk_fma_f32 v[102:103], v[112:113], v[110:111], v[102:103] op_sel_hi:[0,1,1] neg_lo:[0,0,1] neg_hi:[0,0,1]
    s_waitcnt lgkmcnt(6)
    v_mfma_f32_32x32x16_bf16 v[24:39], v[160:163], v[72:75], v[24:39]
    v_mfma_f32_32x32x16_bf16 v[40:55], v[116:119], v[72:75], v[40:55]
    ds_read_b64_tr_b16 v[72:73], v88 offset:6144
    ds_read_b64_tr_b16 v[74:75], v88 offset:6272
    v_cvt_pk_bf16_f32 v120, v96, v97
    v_cvt_pk_bf16_f32 v121, v98, v99
    v_cvt_pk_bf16_f32 v122, v100, v101
    v_cvt_pk_bf16_f32 v123, v102, v103
    v_pk_fma_f32 v[104:105], v[112:113], v[96:97], v[104:105] op_sel_hi:[0,1,1] neg_lo:[0,0,1] neg_hi:[0,0,1]
    v_pk_fma_f32 v[106:107], v[112:113], v[98:99], v[106:107] op_sel_hi:[0,1,1] neg_lo:[0,0,1] neg_hi:[0,0,1]
    v_pk_fma_f32 v[108:109], v[112:113], v[100:101], v[108:109] op_sel_hi:[0,1,1] neg_lo:[0,0,1] neg_hi:[0,0,1]
    v_pk_fma_f32 v[110:111], v[112:113], v[102:103], v[110:111] op_sel_hi:[0,1,1] neg_lo:[0,0,1] neg_hi:[0,0,1]
    s_waitcnt lgkmcnt(6)
    v_mfma_f32_32x32x16_bf16 v[24:39], v[164:167], v[76:79], v[24:39]
    v_mfma_f32_32x32x16_bf16 v[40:55], v[120:123], v[76:79], v[40:55]
    ds_read_b64_tr_b16 v[76:77], v88 offset:6656
    ds_read_b64_tr_b16 v[78:79], v88 offset:6784
    v_cvt_pk_bf16_f32 v116, v104, v105
    v_cvt_pk_bf16_f32 v117, v106, v107
    v_cvt_pk_bf16_f32 v118, v108, v109
    v_cvt_pk_bf16_f32 v119, v110, v111
    v_pk_fma_f32 v[96:97], v[112:113], v[104:105], v[96:97] op_sel_hi:[0,1,1] neg_lo:[0,0,1] neg_hi:[0,0,1]
    v_pk_fma_f32 v[98:99], v[112:113], v[106:107], v[98:99] op_sel_hi:[0,1,1] neg_lo:[0,0,1] neg_hi:[0,0,1]
    v_pk_fma_f32 v[100:101], v[112:113], v[108:109], v[100:101] op_sel_hi:[0,1,1] neg_lo:[0,0,1] neg_hi:[0,0,1]
    v_pk_fma_f32 v[102:103], v[112:113], v[110:111], v[102:103] op_sel_hi:[0,1,1] neg_lo:[0,0,1] neg_hi:[0,0,1]
    s_waitcnt lgkmcnt(6)
    v_mfma_f32_32x32x16_bf16 v[24:39], v[168:171], v[80:83], v[24:39]
    v_mfma_f32_32x32x16_bf16 v[40:55], v[116:119], v[80:83], v[40:55]
    ds_read_b64_tr_b16 v[80:81], v88 offset:7168
    ds_read_b64_tr_b16 v[82:83], v88 offset:7296
    v_cvt_pk_bf16_f32 v120, v96, v97
    v_cvt_pk_bf16_f32 v121, v98, v99
    v_cvt_pk_bf16_f32 v122, v100, v101
    v_cvt_pk_bf16_f32 v123, v102, v103
    v_pk_fma_f32 v[104:105], v[112:113], v[96:97], v[104:105] op_sel_hi:[0,1,1] neg_lo:[0,0,1] neg_hi:[0,0,1]
    v_pk_fma_f32 v[106:107], v[112:113], v[98:99], v[106:107] op_sel_hi:[0,1,1] neg_lo:[0,0,1] neg_hi:[0,0,1]
    v_pk_fma_f32 v[108:109], v[112:113], v[100:101], v[108:109] op_sel_hi:[0,1,1] neg_lo:[0,0,1] neg_hi:[0,0,1]
    v_pk_fma_f32 v[110:111], v[112:113], v[102:103], v[110:111] op_sel_hi:[0,1,1] neg_lo:[0,0,1] neg_hi:[0,0,1]
    s_waitcnt lgkmcnt(6)
    v_mfma_f32_32x32x16_bf16 v[24:39], v[172:175], v[84:87], v[24:39]
    v_mfma_f32_32x32x16_bf16 v[40:55], v[120:123], v[84:87], v[40:55]
    ds_read_b64_tr_b16 v[84:85], v88 offset:7680
    ds_read_b64_tr_b16 v[86:87], v88 offset:7808
    v_cvt_pk_bf16_f32 v116, v104, v105
    v_cvt_pk_bf16_f32 v117, v106, v107
    v_cvt_pk_bf16_f32 v118, v108, v109
    v_cvt_pk_bf16_f32 v119, v110, v111
    v_pk_fma_f32 v[96:97], v[112:113], v[104:105], v[96:97] op_sel_hi:[0,1,1] neg_lo:[0,0,1] neg_hi:[0,0,1]
    v_pk_fma_f32 v[98:99], v[112:113], v[106:107], v[98:99] op_sel_hi:[0,1,1] neg_lo:[0,0,1] neg_hi:[0,0,1]
    v_pk_fma_f32 v[100:101], v[112:113], v[108:109], v[100:101] op_sel_hi:[0,1,1] neg_lo:[0,0,1] neg_hi:[0,0,1]
    v_pk_fma_f32 v[102:103], v[112:113], v[110:111], v[102:103] op_sel_hi:[0,1,1] neg_lo:[0,0,1] neg_hi:[0,0,1]
    s_waitcnt lgkmcnt(6)
    v_mfma_f32_32x32x16_bf16 v[24:39], v[176:179], v[72:75], v[24:39]
    v_mfma_f32_32x32x16_bf16 v[40:55], v[116:119], v[72:75], v[40:55]
    ds_read_b64_tr_b16 v[72:73], v88 offset:8192
    ds_read_b64_tr_b16 v[74:75], v88 offset:8320
    v_cvt_pk_bf16_f32 v120, v96, v97
    v_cvt_pk_bf16_f32 v121, v98, v99
    v_cvt_pk_bf16_f32 v122, v100, v101
    v_cvt_pk_bf16_f32 v123, v102, v103
    v_pk_fma_f32 v[104:105], v[112:113], v[96:97], v[104:105] op_sel_hi:[0,1,1] neg_lo:[0,0,1] neg_hi:[0,0,1]
    v_pk_fma_f32 v[106:107], v[112:113], v[98:99], v[106:107] op_sel_hi:[0,1,1] neg_lo:[0,0,1] neg_hi:[0,0,1]
    v_pk_fma_f32 v[108:109], v[112:113], v[100:101], v[108:109] op_sel_hi:[0,1,1] neg_lo:[0,0,1] neg_hi:[0,0,1]
    v_pk_fma_f32 v[110:111], v[112:113], v[102:103], v[110:111] op_sel_hi:[0,1,1] neg_lo:[0,0,1] neg_hi:[0,0,1]
    s_waitcnt lgkmcnt(6)
    v_mfma_f32_32x32x16_bf16 v[24:39], v[180:183], v[76:79], v[24:39]
    v_mfma_f32_32x32x16_bf16 v[40:55], v[120:123], v[76:79], v[40:55]
    ds_read_b64_tr_b16 v[76:77], v88 offset:8704
    ds_read_b64_tr_b16 v[78:79], v88 offset:8832
    v_cvt_pk_bf16_f32 v116, v104, v105
    v_cvt_pk_bf16_f32 v117, v106, v107
    v_cvt_pk_bf16_f32 v118, v108, v109
    v_cvt_pk_bf16_f32 v119, v110, v111
    v_pk_fma_f32 v[96:97], v[112:113], v[104:105], v[96:97] op_sel_hi:[0,1,1] neg_lo:[0,0,1] neg_hi:[0,0,1]
    v_pk_fma_f32 v[98:99], v[112:113], v[106:107], v[98:99] op_sel_hi:[0,1,1] neg_lo:[0,0,1] neg_hi:[0,0,1]
    v_pk_fma_f32 v[100:101], v[112:113], v[108:109], v[100:101] op_sel_hi:[0,1,1] neg_lo:[0,0,1] neg_hi:[0,0,1]
    v_pk_fma_f32 v[102:103], v[112:113], v[110:111], v[102:103] op_sel_hi:[0,1,1] neg_lo:[0,0,1] neg_hi:[0,0,1]
    s_waitcnt lgkmcnt(6)
    v_mfma_f32_32x32x16_bf16 v[24:39], v[184:187], v[80:83], v[24:39]
    v_mfma_f32_32x32x16_bf16 v[40:55], v[116:119], v[80:83], v[40:55]
    ds_read_b64_tr_b16 v[80:81], v88 offset:9216
    ds_read_b64_tr_b16 v[82:83], v88 offset:9344
    v_cvt_pk_bf16_f32 v120, v96, v97
    v_cvt_pk_bf16_f32 v121, v98, v99
    v_cvt_pk_bf16_f32 v122, v100, v101
    v_cvt_pk_bf16_f32 v123, v102, v103
    v_pk_fma_f32 v[104:105], v[112:113], v[96:97], v[104:105] op_sel_hi:[0,1,1] neg_lo:[0,0,1] neg_hi:[0,0,1]
    v_pk_fma_f32 v[106:107], v[112:113], v[98:99], v[106:107] op_sel_hi:[0,1,1] neg_lo:[0,0,1] neg_hi:[0,0,1]
    v_pk_fma_f32 v[108:109], v[112:113], v[100:101], v[108:109] op_sel_hi:[0,1,1] neg_lo:[0,0,1] neg_hi:[0,0,1]
    v_pk_fma_f32 v[110:111], v[112:113], v[102:103], v[110:111] op_sel_hi:[0,1,1] neg_lo:[0,0,1] neg_hi:[0,0,1]
    s_waitcnt lgkmcnt(6)
    v_mfma_f32_32x32x16_bf16 v[24:39], v[188:191], v[84:87], v[24:39]
    v_mfma_f32_32x32x16_bf16 v[40:55], v[120:123], v[84:87], v[40:55]
    ds_read_b64_tr_b16 v[84:85], v88 offset:9728
    ds_read_b64_tr_b16 v[86:87], v88 offset:9856
    v_cvt_pk_bf16_f32 v116, v104, v105
    v_cvt_pk_bf16_f32 v117, v106, v107
    v_cvt_pk_bf16_f32 v118, v108, v109
    v_cvt_pk_bf16_f32 v119, v110, v111
    v_pk_fma_f32 v[96:97], v[112:113], v[104:105], v[96:97] op_sel_hi:[0,1,1] neg_lo:[0,0,1] neg_hi:[0,0,1]
    v_pk_fma_f32 v[98:99], v[112:113], v[106:107], v[98:99] op_sel_hi:[0,1,1] neg_lo:[0,0,1] neg_hi:[0,0,1]
    v_pk_fma_f32 v[100:101], v[112:113], v[108:109], v[100:101] op_sel_hi:[0,1,1] neg_lo:[0,0,1] neg_hi:[0,0,1]
    v_pk_fma_f32 v[102:103], v[112:113], v[110:111], v[102:103] op_sel_hi:[0,1,1] neg_lo:[0,0,1] neg_hi:[0,0,1]
    s_waitcnt lgkmcnt(6)
    v_mfma_f32_32x32x16_bf16 v[24:39], v[192:195], v[72:75], v[24:39]
    v_mfma_f32_32x32x16_bf16 v[40:55], v[116:119], v[72:75], v[40:55]
    ds_read_b64_tr_b16 v[72:73], v88 offset:10240
    ds_read_b64_tr_b16 v[74:75], v88 offset:10368
    v_cvt_pk_bf16_f32 v120, v96, v97
    v_cvt_pk_bf16_f32 v121, v98, v99
    v_cvt_pk_bf16_f32 v122, v100, v101
    v_cvt_pk_bf16_f32 v123, v102, v103
    v_pk_fma_f32 v[104:105], v[112:113], v[96:97], v[104:105] op_sel_hi:[0,1,1] neg_lo:[0,0,1] neg_hi:[0,0,1]
    v_pk_fma_f32 v[106:107], v[112:113], v[98:99], v[106:107] op_sel_hi:[0,1,1] neg_lo:[0,0,1] neg_hi:[0,0,1]
    v_pk_fma_f32 v[108:109], v[112:113], v[100:101], v[108:109] op_sel_hi:[0,1,1] neg_lo:[0,0,1] neg_hi:[0,0,1]
    v_pk_fma_f32 v[110:111], v[112:113], v[102:103], v[110:111] op_sel_hi:[0,1,1] neg_lo:[0,0,1] neg_hi:[0,0,1]
    s_waitcnt lgkmcnt(6)
    v_mfma_f32_32x32x16_bf16 v[24:39], v[196:199], v[76:79], v[24:39]
    v_mfma_f32_32x32x16_bf16 v[40:55], v[120:123], v[76:79], v[40:55]
    ds_read_b64_tr_b16 v[76:77], v88 offset:10752
    ds_read_b64_tr_b16 v[78:79], v88 offset:10880
    v_cvt_pk_bf16_f32 v116, v104, v105
    v_cvt_pk_bf16_f32 v117, v106, v107
    v_cvt_pk_bf16_f32 v118, v108, v109
    v_cvt_pk_bf16_f32 v119, v110, v111
    v_pk_fma_f32 v[96:97], v[112:113], v[104:105], v[96:97] op_sel_hi:[0,1,1] neg_lo:[0,0,1] neg_hi:[0,0,1]
    v_pk_fma_f32 v[98:99], v[112:113], v[106:107], v[98:99] op_sel_hi:[0,1,1] neg_lo:[0,0,1] neg_hi:[0,0,1]
    v_pk_fma_f32 v[100:101], v[112:113], v[108:109], v[100:101] op_sel_hi:[0,1,1] neg_lo:[0,0,1] neg_hi:[0,0,1]
    v_pk_fma_f32 v[102:103], v[112:113], v[110:111], v[102:103] op_sel_hi:[0,1,1] neg_lo:[0,0,1] neg_hi:[0,0,1]
    s_waitcnt lgkmcnt(6)
    v_mfma_f32_32x32x16_bf16 v[24:39], v[200:203], v[80:83], v[24:39]
    v_mfma_f32_32x32x16_bf16 v[40:55], v[116:119], v[80:83], v[40:55]
    ds_read_b64_tr_b16 v[80:81], v88 offset:11264
    ds_read_b64_tr_b16 v[82:83], v88 offset:11392
    v_cvt_pk_bf16_f32 v120, v96, v97
    v_cvt_pk_bf16_f32 v121, v98, v99
    v_cvt_pk_bf16_f32 v122, v100, v101
    v_cvt_pk_bf16_f32 v123, v102, v103
    v_pk_fma_f32 v[104:105], v[112:113], v[96:97], v[104:105] op_sel_hi:[0,1,1] neg_lo:[0,0,1] neg_hi:[0,0,1]
    v_pk_fma_f32 v[106:107], v[112:113], v[98:99], v[106:107] op_sel_hi:[0,1,1] neg_lo:[0,0,1] neg_hi:[0,0,1]
    v_pk_fma_f32 v[108:109], v[112:113], v[100:101], v[108:109] op_sel_hi:[0,1,1] neg_lo:[0,0,1] neg_hi:[0,0,1]
    v_pk_fma_f32 v[110:111], v[112:113], v[102:103], v[110:111] op_sel_hi:[0,1,1] neg_lo:[0,0,1] neg_hi:[0,0,1]
    s_waitcnt lgkmcnt(6)
    v_mfma_f32_32x32x16_bf16 v[24:39], v[204:207], v[84:87], v[24:39]
    v_mfma_f32_32x32x16_bf16 v[40:55], v[120:123], v[84:87], v[40:55]
    ds_read_b64_tr_b16 v[84:85], v88 offset:11776
    ds_read_b64_tr_b16 v[86:87], v88 offset:11904
    v_cvt_pk_bf16_f32 v116, v104, v105
    v_cvt_pk_bf16_f32 v117, v106, v107
    v_cvt_pk_bf16_f32 v118, v108, v109
    v_cvt_pk_bf16_f32 v119, v110, v111
    v_pk_fma_f32 v[96:97], v[112:113], v[104:105], v[96:97] op_sel_hi:[0,1,1] neg_lo:[0,0,1] neg_hi:[0,0,1]
    v_pk_fma_f32 v[98:99], v[112:113], v[106:107], v[98:99] op_sel_hi:[0,1,1] neg_lo:[0,0,1] neg_hi:[0,0,1]
    v_pk_fma_f32 v[100:101], v[112:113], v[108:109], v[100:101] op_sel_hi:[0,1,1] neg_lo:[0,0,1] neg_hi:[0,0,1]
    v_pk_fma_f32 v[102:103], v[112:113], v[110:111], v[102:103] op_sel_hi:[0,1,1] neg_lo:[0,0,1] neg_hi:[0,0,1]
    s_waitcnt lgkmcnt(6)
    v_mfma_f32_32x32x16_bf16 v[24:39], v[208:211], v[72:75], v[24:39]
    v_mfma_f32_32x32x16_bf16 v[40:55], v[116:119], v[72:75], v[40:55]
    ds_read_b64_tr_b16 v[72:73], v88 offset:12288
    ds_read_b64_tr_b16 v[74:75], v88 offset:12416
    v_cvt_pk_bf16_f32 v120, v96, v97
    v_cvt_pk_bf16_f32 v121, v98, v99
    v_cvt_pk_bf16_f32 v122, v100, v101
    v_cvt_pk_bf16_f32 v123, v102, v103
    v_pk_fma_f32 v[104:105], v[112:113], v[96:97], v[104:105] op_sel_hi:[0,1,1] neg_lo:[0,0,1] neg_hi:[0,0,1]
    v_pk_fma_f32 v[106:107], v[112:113], v[98:99], v[106:107] op_sel_hi:[0,1,1] neg_lo:[0,0,1] neg_hi:[0,0,1]
    v_pk_fma_f32 v[108:109], v[112:113], v[100:101], v[108:109] op_sel_hi:[0,1,1] neg_lo:[0,0,1] neg_hi:[0,0,1]
    v_pk_fma_f32 v[110:111], v[112:113], v[102:103], v[110:111] op_sel_hi:[0,1,1] neg_lo:[0,0,1] neg_hi:[0,0,1]
    s_waitcnt lgkmcnt(6)
    v_mfma_f32_32x32x16_bf16 v[24:39], v[212:215], v[76:79], v[24:39]
    v_mfma_f32_32x32x16_bf16 v[40:55], v[120:123], v[76:79], v[40:55]
    ds_read_b64_tr_b16 v[76:77], v88 offset:12800
    ds_read_b64_tr_b16 v[78:79], v88 offset:12928
    v_cvt_pk_bf16_f32 v116, v104, v105
    v_cvt_pk_bf16_f32 v117, v106, v107
    v_cvt_pk_bf16_f32 v118, v108, v109
    v_cvt_pk_bf16_f32 v119, v110, v111
    v_pk_fma_f32 v[96:97], v[112:113], v[104:105], v[96:97] op_sel_hi:[0,1,1] neg_lo:[0,0,1] neg_hi:[0,0,1]
    v_pk_fma_f32 v[98:99], v[112:113], v[106:107], v[98:99] op_sel_hi:[0,1,1] neg_lo:[0,0,1] neg_hi:[0,0,1]
    v_pk_fma_f32 v[100:101], v[112:113], v[108:109], v[100:101] op_sel_hi:[0,1,1] neg_lo:[0,0,1] neg_hi:[0,0,1]
    v_pk_fma_f32 v[102:103], v[112:113], v[110:111], v[102:103] op_sel_hi:[0,1,1] neg_lo:[0,0,1] neg_hi:[0,0,1]
    s_waitcnt lgkmcnt(6)
    v_mfma_f32_32x32x16_bf16 v[24:39], v[216:219], v[80:83], v[24:39]
    v_mfma_f32_32x32x16_bf16 v[40:55], v[116:119], v[80:83], v[40:55]
    ds_read_b64_tr_b16 v[80:81], v88 offset:13312
    ds_read_b64_tr_b16 v[82:83], v88 offset:13440
    v_cvt_pk_bf16_f32 v120, v96, v97
    v_cvt_pk_bf16_f32 v121, v98, v99
    v_cvt_pk_bf16_f32 v122, v100, v101
    v_cvt_pk_bf16_f32 v123, v102, v103
    v_pk_fma_f32 v[104:105], v[112:113], v[96:97], v[104:105] op_sel_hi:[0,1,1] neg_lo:[0,0,1] neg_hi:[0,0,1]
    v_pk_fma_f32 v[106:107], v[112:113], v[98:99], v[106:107] op_sel_hi:[0,1,1] neg_lo:[0,0,1] neg_hi:[0,0,1]
    v_pk_fma_f32 v[108:109], v[112:113], v[100:101], v[108:109] op_sel_hi:[0,1,1] neg_lo:[0,0,1] neg_hi:[0,0,1]
    v_pk_fma_f32 v[110:111], v[112:113], v[102:103], v[110:111] op_sel_hi:[0,1,1] neg_lo:[0,0,1] neg_hi:[0,0,1]
    s_waitcnt lgkmcnt(6)
    v_mfma_f32_32x32x16_bf16 v[24:39], v[220:223], v[84:87], v[24:39]
    v_mfma_f32_32x32x16_bf16 v[40:55], v[120:123], v[84:87], v[40:55]
    ds_read_b64_tr_b16 v[84:85], v88 offset:13824
    ds_read_b64_tr_b16 v[86:87], v88 offset:13952
    v_cvt_pk_bf16_f32 v116, v104, v105
    v_cvt_pk_bf16_f32 v117, v106, v107
    v_cvt_pk_bf16_f32 v118, v108, v109
    v_cvt_pk_bf16_f32 v119, v110, v111
    v_pk_fma_f32 v[96:97], v[112:113], v[104:105], v[96:97] op_sel_hi:[0,1,1] neg_lo:[0,0,1] neg_hi:[0,0,1]
    v_pk_fma_f32 v[98:99], v[112:113], v[106:107], v[98:99] op_sel_hi:[0,1,1] neg_lo:[0,0,1] neg_hi:[0,0,1]
    v_pk_fma_f32 v[100:101], v[112:113], v[108:109], v[100:101] op_sel_hi:[0,1,1] neg_lo:[0,0,1] neg_hi:[0,0,1]
    v_pk_fma_f32 v[102:103], v[112:113], v[110:111], v[102:103] op_sel_hi:[0,1,1] neg_lo:[0,0,1] neg_hi:[0,0,1]
    s_waitcnt lgkmcnt(6)
    v_mfma_f32_32x32x16_bf16 v[24:39], v[224:227], v[72:75], v[24:39]
    v_mfma_f32_32x32x16_bf16 v[40:55], v[116:119], v[72:75], v[40:55]
    ds_read_b64_tr_b16 v[72:73], v88 offset:14336
    ds_read_b64_tr_b16 v[74:75], v88 offset:14464
    v_cvt_pk_bf16_f32 v120, v96, v97
    v_cvt_pk_bf16_f32 v121, v98, v99
    v_cvt_pk_bf16_f32 v122, v100, v101
    v_cvt_pk_bf16_f32 v123, v102, v103
    v_pk_fma_f32 v[104:105], v[112:113], v[96:97], v[104:105] op_sel_hi:[0,1,1] neg_lo:[0,0,1] neg_hi:[0,0,1]
    v_pk_fma_f32 v[106:107], v[112:113], v[98:99], v[106:107] op_sel_hi:[0,1,1] neg_lo:[0,0,1] neg_hi:[0,0,1]
    v_pk_fma_f32 v[108:109], v[112:113], v[100:101], v[108:109] op_sel_hi:[0,1,1] neg_lo:[0,0,1] neg_hi:[0,0,1]
    v_pk_fma_f32 v[110:111], v[112:113], v[102:103], v[110:111] op_sel_hi:[0,1,1] neg_lo:[0,0,1] neg_hi:[0,0,1]
    s_waitcnt lgkmcnt(6)
    v_mfma_f32_32x32x16_bf16 v[24:39], v[228:231], v[76:79], v[24:39]
    v_mfma_f32_32x32x16_bf16 v[40:55], v[120:123], v[76:79], v[40:55]
    ds_read_b64_tr_b16 v[76:77], v88 offset:14848
    ds_read_b64_tr_b16 v[78:79], v88 offset:14976
    v_cvt_pk_bf16_f32 v116, v104, v105
    v_cvt_pk_bf16_f32 v117, v106, v107
    v_cvt_pk_bf16_f32 v118, v108, v109
    v_cvt_pk_bf16_f32 v119, v110, v111
    v_pk_fma_f32 v[96:97], v[112:113], v[104:105], v[96:97] op_sel_hi:[0,1,1] neg_lo:[0,0,1] neg_hi:[0,0,1]
    v_pk_fma_f32 v[98:99], v[112:113], v[106:107], v[98:99] op_sel_hi:[0,1,1] neg_lo:[0,0,1] neg_hi:[0,0,1]
    v_pk_fma_f32 v[100:101], v[112:113], v[108:109], v[100:101] op_sel_hi:[0,1,1] neg_lo:[0,0,1] neg_hi:[0,0,1]
    v_pk_fma_f32 v[102:103], v[112:113], v[110:111], v[102:103] op_sel_hi:[0,1,1] neg_lo:[0,0,1] neg_hi:[0,0,1]
    s_waitcnt lgkmcnt(6)
    v_mfma_f32_32x32x16_bf16 v[24:39], v[232:235], v[80:83], v[24:39]
    v_mfma_f32_32x32x16_bf16 v[40:55], v[116:119], v[80:83], v[40:55]
    ds_read_b64_tr_b16 v[80:81], v88 offset:15360
    ds_read_b64_tr_b16 v[82:83], v88 offset:15488
    v_cvt_pk_bf16_f32 v120, v96, v97
    v_cvt_pk_bf16_f32 v121, v98, v99
    v_cvt_pk_bf16_f32 v122, v100, v101
    v_cvt_pk_bf16_f32 v123, v102, v103
    v_pk_fma_f32 v[104:105], v[112:113], v[96:97], v[104:105] op_sel_hi:[0,1,1] neg_lo:[0,0,1] neg_hi:[0,0,1]
    v_pk_fma_f32 v[106:107], v[112:113], v[98:99], v[106:107] op_sel_hi:[0,1,1] neg_lo:[0,0,1] neg_hi:[0,0,1]
    v_pk_fma_f32 v[108:109], v[112:113], v[100:101], v[108:109] op_sel_hi:[0,1,1] neg_lo:[0,0,1] neg_hi:[0,0,1]
    v_pk_fma_f32 v[110:111], v[112:113], v[102:103], v[110:111] op_sel_hi:[0,1,1] neg_lo:[0,0,1] neg_hi:[0,0,1]
    s_waitcnt lgkmcnt(6)
    v_mfma_f32_32x32x16_bf16 v[24:39], v[236:239], v[84:87], v[24:39]
    v_mfma_f32_32x32x16_bf16 v[40:55], v[120:123], v[84:87], v[40:55]
    ds_read_b64_tr_b16 v[84:85], v88 offset:15872
    ds_read_b64_tr_b16 v[86:87], v88 offset:16000
    v_cvt_pk_bf16_f32 v116, v104, v105
    v_cvt_pk_bf16_f32 v117, v106, v107
    v_cvt_pk_bf16_f32 v118, v108, v109
    v_cvt_pk_bf16_f32 v119, v110, v111
    v_pk_fma_f32 v[96:97], v[112:113], v[104:105], v[96:97] op_sel_hi:[0,1,1] neg_lo:[0,0,1] neg_hi:[0,0,1]
    v_pk_fma_f32 v[98:99], v[112:113], v[106:107], v[98:99] op_sel_hi:[0,1,1] neg_lo:[0,0,1] neg_hi:[0,0,1]
    v_pk_fma_f32 v[100:101], v[112:113], v[108:109], v[100:101] op_sel_hi:[0,1,1] neg_lo:[0,0,1] neg_hi:[0,0,1]
    v_pk_fma_f32 v[102:103], v[112:113], v[110:111], v[102:103] op_sel_hi:[0,1,1] neg_lo:[0,0,1] neg_hi:[0,0,1]
    s_waitcnt lgkmcnt(6)
    v_mfma_f32_32x32x16_bf16 v[24:39], v[240:243], v[72:75], v[24:39]
    v_mfma_f32_32x32x16_bf16 v[40:55], v[116:119], v[72:75], v[40:55]
    v_cvt_pk_bf16_f32 v120, v96, v97
    v_cvt_pk_bf16_f32 v121, v98, v99
    v_cvt_pk_bf16_f32 v122, v100, v101
    v_cvt_pk_bf16_f32 v123, v102, v103
    v_pk_fma_f32 v[104:105], v[112:113], v[96:97], v[104:105] op_sel_hi:[0,1,1] neg_lo:[0,0,1] neg_hi:[0,0,1]
    v_pk_fma_f32 v[106:107], v[112:113], v[98:99], v[106:107] op_sel_hi:[0,1,1] neg_lo:[0,0,1] neg_hi:[0,0,1]
    v_pk_fma_f32 v[108:109], v[112:113], v[100:101], v[108:109] op_sel_hi:[0,1,1] neg_lo:[0,0,1] neg_hi:[0,0,1]
    v_pk_fma_f32 v[110:111], v[112:113], v[102:103], v[110:111] op_sel_hi:[0,1,1] neg_lo:[0,0,1] neg_hi:[0,0,1]
    s_waitcnt lgkmcnt(4)
    v_mfma_f32_32x32x16_bf16 v[24:39], v[244:247], v[76:79], v[24:39]
    v_mfma_f32_32x32x16_bf16 v[40:55], v[120:123], v[76:79], v[40:55]
    v_cvt_pk_bf16_f32 v116, v104, v105
    v_cvt_pk_bf16_f32 v117, v106, v107
    v_cvt_pk_bf16_f32 v118, v108, v109
    v_cvt_pk_bf16_f32 v119, v110, v111
    v_pk_fma_f32 v[96:97], v[112:113], v[104:105], v[96:97] op_sel_hi:[0,1,1] neg_lo:[0,0,1] neg_hi:[0,0,1]
    v_pk_fma_f32 v[98:99], v[112:113], v[106:107], v[98:99] op_sel_hi:[0,1,1] neg_lo:[0,0,1] neg_hi:[0,0,1]
    v_pk_fma_f32 v[100:101], v[112:113], v[108:109], v[100:101] op_sel_hi:[0,1,1] neg_lo:[0,0,1] neg_hi:[0,0,1]
    v_pk_fma_f32 v[102:103], v[112:113], v[110:111], v[102:103] op_sel_hi:[0,1,1] neg_lo:[0,0,1] neg_hi:[0,0,1]
    s_waitcnt lgkmcnt(2)
    v_mfma_f32_32x32x16_bf16 v[24:39], v[248:251], v[80:83], v[24:39]
    v_mfma_f32_32x32x16_bf16 v[40:55], v[116:119], v[80:83], v[40:55]
    v_cvt_pk_bf16_f32 v120, v96, v97
    v_cvt_pk_bf16_f32 v121, v98, v99
    v_cvt_pk_bf16_f32 v122, v100, v101
    v_cvt_pk_bf16_f32 v123, v102, v103
    s_waitcnt lgkmcnt(0)
    v_mfma_f32_32x32x16_bf16 v[24:39], v[252:255], v[84:87], v[24:39]
    v_mfma_f32_32x32x16_bf16 v[40:55], v[120:123], v[84:87], v[40:55]
    s_cmp_eq_u32 s3, 0
    s_cselect_b32 s53, 32, 0
    v_cmp_le_u32 vcc, s53, v1
    s_nop 7
    v_cndmask_b32 v25, 0, v25, vcc
    s_lshl_b32 s53, s58, 15
    s_lshl_b32 s54, s3, 11
    s_add_u32 s53, s53, s54
    s_add_u32 s53, s53, 20971520
    s_add_u32 s54, s53, 16384
    v_lshlrev_b32 v6, 4, v1
    v_cvt_pk_bf16_f32 v56, v24, v25
    v_cvt_pk_bf16_f32 v57, v26, v27
    v_cvt_pk_bf16_f32 v58, v28, v29
    v_cvt_pk_bf16_f32 v59, v30, v31
    s_nop 0
    v_permlane32_swap_b32 v56, v58
    v_permlane32_swap_b32 v57, v59
    v_cvt_pk_bf16_f32 v60, v32, v33
    v_cvt_pk_bf16_f32 v61, v34, v35
    v_cvt_pk_bf16_f32 v62, v36, v37
    v_cvt_pk_bf16_f32 v63, v38, v39
    s_nop 0
    v_permlane32_swap_b32 v60, v62
    v_permlane32_swap_b32 v61, v63
    v_cvt_pk_bf16_f32 v64, v40, v41
    v_cvt_pk_bf16_f32 v65, v42, v43
    v_cvt_pk_bf16_f32 v66, v44, v45
    v_cvt_pk_bf16_f32 v67, v46, v47
    s_nop 0
    v_permlane32_swap_b32 v64, v66
    v_permlane32_swap_b32 v65, v67
    v_cvt_pk_bf16_f32 v68, v48, v49
    v_cvt_pk_bf16_f32 v69, v50, v51
    v_cvt_pk_bf16_f32 v70, v52, v53
    v_cvt_pk_bf16_f32 v71, v54, v55
    s_nop 0
    v_permlane32_swap_b32 v68, v70
    v_permlane32_swap_b32 v69, v71
    buffer_store_dwordx4 v[56:59], v6, s[4:7], s53 offen sc1
    buffer_store_dwordx4 v[60:63], v6, s[4:7], s53 offen offset:1024 sc1
    buffer_store_dwordx4 v[64:67], v6, s[4:7], s54 offen sc1
    buffer_store_dwordx4 v[68:71], v6, s[4:7], s54 offen offset:1024 sc1
    s_nop 0
    s_branch L_m_TU16_end
L_m_TU16_t2:
    s_sub_u32 s60, s58, 86
    v_lshrrev_b32 v6, 3, v2
    v_lshlrev_b32 v6, 10, v6
    v_and_b32 v7, 7, v2
    v_lshl_add_u32 v6, v7, 7, v6
    v_bfe_u32 v7, v2, 1, 3
    v_add_u32 v8, 0, v3
    v_xor_b32 v8, v8, v7
    v_lshl_add_u32 v88, v8, 4, v6
    v_add_u32 v8, 2, v3
    v_xor_b32 v8, v8, v7
    v_lshl_add_u32 v89, v8, 4, v6
    v_add_u32 v8, 4, v3
    v_xor_b32 v8, v8, v7
    v_lshl_add_u32 v90, v8, 4, v6
    v_add_u32 v8, 6, v3
    v_xor_b32 v8, v8, v7
    v_lshl_add_u32 v91, v8, 4, v6
    v_add_u32 v88, s64, v88
    v_add_u32 v89, s64, v89
    v_add_u32 v90, s64, v90
    v_add_u32 v91, s64, v91
    ds_read_b128 v[72:75], v88 offset:0
    ds_read_b128 v[76:79], v89 offset:0
    ds_read_b128 v[80:83], v90 offset:0
    ds_read_b128 v[84:87], v91 offset:0
    v_cvt_pk_bf16_f32 v116, v104, v105
    v_cvt_pk_bf16_f32 v117, v106, v107
    v_cvt_pk_bf16_f32 v118, v108, v109
    v_cvt_pk_bf16_f32 v119, v110, v111
    v_pk_fma_f32 v[96:97], v[112:113], v[104:105], v[96:97] op_sel_hi:[0,1,1] neg_lo:[0,0,1] neg_hi:[0,0,1]
    v_pk_fma_f32 v[98:99], v[112:113], v[106:107], v[98:99] op_sel_hi:[0,1,1] neg_lo:[0,0,1] neg_hi:[0,0,1]
    v_pk_fma_f32 v[100:101], v[112:113], v[108:109], v[100:101] op_sel_hi:[0,1,1] neg_lo:[0,0,1] neg_hi:[0,0,1]
    v_pk_fma_f32 v[102:103], v[112:113], v[110:111], v[102:103] op_sel_hi:[0,1,1] neg_lo:[0,0,1] neg_hi:[0,0,1]
    s_waitcnt lgkmcnt(3)
    v_mfma_f32_32x32x16_bf16 v[24:39], v[72:75], v[128:131], 0
    v_mfma_f32_32x32x16_bf16 v[40:55], v[72:75], v[116:119], 0
    ds_read_b128 v[72:75], v88 offset:4096
    v_cvt_pk_bf16_f32 v120, v96, v97
    v_cvt_pk_bf16_f32 v121, v98, v99
    v_cvt_pk_bf16_f32 v122, v100, v101
    v_cvt_pk_bf16_f32 v123, v102, v103
    v_pk_fma_f32 v[104:105], v[112:113], v[96:97], v[104:105] op_sel_hi:[0,1,1] neg_lo:[0,0,1] neg_hi:[0,0,1]
    v_pk_fma_f32 v[106:107], v[112:113], v[98:99], v[106:107] op_sel_hi:[0,1,1] neg_lo:[0,0,1] neg_hi:[0,0,1]
    v_pk_fma_f32 v[108:109], v[112:113], v[100:101], v[108:109] op_sel_hi:[0,1,1] neg_lo:[0,0,1] neg_hi:[0,0,1]
    v_pk_fma_f32 v[110:111], v[112:113], v[102:103], v[110:111] op_sel_hi:[0,1,1] neg_lo:[0,0,1] neg_hi:[0,0,1]
    s_waitcnt lgkmcnt(3)
    v_mfma_f32_32x32x16_bf16 v[24:39], v[76:79], v[132:135], v[24:39]
    v_mfma_f32_32x32x16_bf16 v[40:55], v[76:79], v[120:123], v[40:55]
    ds_read_b128 v[76:79], v89 offset:4096
    v_cvt_pk_bf16_f32 v116, v104, v105
    v_cvt_pk_bf16_f32 v117, v106, v107
    v_cvt_pk_bf16_f32 v118, v108, v109
    v_cvt_pk_bf16_f32 v119, v110, v111
    v_pk_fma_f32 v[96:97], v[112:113], v[104:105], v[96:97] op_sel_hi:[0,1,1] neg_lo:[0,0,1] neg_hi:[0,0,1]
    v_pk_fma_f32 v[98:99], v[112:113], v[106:107], v[98:99] op_sel_hi:[0,1,1] neg_lo:[0,0,1] neg_hi:[0,0,1]
    v_pk_fma_f32 v[100:101], v[112:113], v[108:109], v[100:101] op_sel_hi:[0,1,1] neg_lo:[0,0,1] neg_hi:[0,0,1]
    v_pk_fma_f32 v[102:103], v[112:113], v[110:111], v[102:103] op_sel_hi:[0,1,1] neg_lo:[0,0,1] neg_hi:[0,0,1]
    s_waitcnt lgkmcnt(3)
    v_mfma_f32_32x32x16_bf16 v[24:39], v[80:83], v[136:139], v[24:39]
    v_mfma_f32_32x32x16_bf16 v[40:55], v[80:83], v[116:119], v[40:55]
    ds_read_b128 v[80:83], v90 offset:4096
    v_cvt_pk_bf16_f32 v120, v96, v97
    v_cvt_pk_bf16_f32 v121, v98, v99
    v_cvt_pk_bf16_f32 v122, v100, v101
    v_cvt_pk_bf16_f32 v123, v102, v103
    v_pk_fma_f32 v[104:105], v[112:113], v[96:97], v[104:105] op_sel_hi:[0,1,1] neg_lo:[0,0,1] neg_hi:[0,0,1]
    v_pk_fma_f32 v[106:107], v[112:113], v[98:99], v[106:107] op_sel_hi:[0,1,1] neg_lo:[0,0,1] neg_hi:[0,0,1]
    v_pk_fma_f32 v[108:109], v[112:113], v[100:101], v[108:109] op_sel_hi:[0,1,1] neg_lo:[0,0,1] neg_hi:[0,0,1]
    v_pk_fma_f32 v[110:111], v[112:113], v[102:103], v[110:111] op_sel_hi:[0,1,1] neg_lo:[0,0,1] neg_hi:[0,0,1]
    s_waitcnt lgkmcnt(3)
    v_mfma_f32_32x32x16_bf16 v[24:39], v[84:87], v[140:143], v[24:39]
    v_mfma_f32_32x32x16_bf16 v[40:55], v[84:87], v[120:123], v[40:55]
    ds_read_b128 v[84:87], v91 offset:4096
    v_cvt_pk_bf16_f32 v116, v104, v105
    v_cvt_pk_bf16_f32 v117, v106, v107
    v_cvt_pk_bf16_f32 v118, v108, v109
    v_cvt_pk_bf16_f32 v119, v110, v111
    v_pk_fma_f32 v[96:97], v[112:113], v[104:105], v[96:97] op_sel_hi:[0,1,1] neg_lo:[0,0,1] neg_hi:[0,0,1]
    v_pk_fma_f32 v[98:99], v[112:113], v[106:107], v[98:99] op_sel_hi:[0,1,1] neg_lo:[0,0,1] neg_hi:[0,0,1]
    v_pk_fma_f32 v[100:101], v[112:113], v[108:109], v[100:101] op_sel_hi:[0,1,1] neg_lo:[0,0,1] neg_hi:[0,0,1]
    v_pk_fma_f32 v[102:103], v[112:113], v[110:111], v[102:103] op_sel_hi:[0,1,1] neg_lo:[0,0,1] neg_hi:[0,0,1]
    s_waitcnt lgkmcnt(3)
    v_mfma_f32_32x32x16_bf16 v[24:39], v[72:75], v[144:147], v[24:39]
    v_mfma_f32_32x32x16_bf16 v[40:55], v[72:75], v[116:119], v[40:55]
    ds_read_b128 v[72:75], v88 offset:8192
    v_cvt_pk_bf16_f32 v120, v96, v97
    v_cvt_pk_bf16_f32 v121, v98, v99
    v_cvt_pk_bf16_f32 v122, v100, v101
    v_cvt_pk_bf16_f32 v123, v102, v103
    v_pk_fma_f32 v[104:105], v[112:113], v[96:97], v[104:105] op_sel_hi:[0,1,1] neg_lo:[0,0,1] neg_hi:[0,0,1]
    v_pk_fma_f32 v[106:107], v[112:113], v[98:99], v[106:107] op_sel_hi:[0,1,1] neg_lo:[0,0,1] neg_hi:[0,0,1]
    v_pk_fma_f32 v[108:109], v[112:113], v[100:101], v[108:109] op_sel_hi:[0,1,1] neg_lo:[0,0,1] neg_hi:[0,0,1]
    v_pk_fma_f32 v[110:111], v[112:113], v[102:103], v[110:111] op_sel_hi:[0,1,1] neg_lo:[0,0,1] neg_hi:[0,0,1]
    s_waitcnt lgkmcnt(3)
    v_mfma_f32_32x32x16_bf16 v[24:39], v[76:79], v[148:151], v[24:39]
    v_mfma_f32_32x32x16_bf16 v[40:55], v[76:79], v[120:123], v[40:55]
    ds_read_b128 v[76:79], v89 offset:8192
    v_cvt_pk_bf16_f32 v116, v104, v105
    v_cvt_pk_bf16_f32 v117, v106, v107
    v_cvt_pk_bf16_f32 v118, v108, v109
    v_cvt_pk_bf16_f32 v119, v110, v111
    v_pk_fma_f32 v[96:97], v[112:113], v[104:105], v[96:97] op_sel_hi:[0,1,1] neg_lo:[0,0,1] neg_hi:[0,0,1]
    v_pk_fma_f32 v[98:99], v[112:113], v[106:107], v[98:99] op_sel_hi:[0,1,1] neg_lo:[0,0,1] neg_hi:[0,0,1]
    v_pk_fma_f32 v[100:101], v[112:113], v[108:109], v[100:101] op_sel_hi:[0,1,1] neg_lo:[0,0,1] neg_hi:[0,0,1]
    v_pk_fma_f32 v[102:103], v[112:113], v[110:111], v[102:103] op_sel_hi:[0,1,1] neg_lo:[0,0,1] neg_hi:[0,0,1]
    s_waitcnt lgkmcnt(3)
    v_mfma_f32_32x32x16_bf16 v[24:39], v[80:83], v[152:155], v[24:39]
    v_mfma_f32_32x32x16_bf16 v[40:55], v[80:83], v[116:119], v[40:55]
    ds_read_b128 v[80:83], v90 offset:8192
    v_cvt_pk_bf16_f32 v120, v96, v97
    v_cvt_pk_bf16_f32 v121, v98, v99
    v_cvt_pk_bf16_f32 v122, v100, v101
    v_cvt_pk_bf16_f32 v123, v102, v103
    v_pk_fma_f32 v[104:105], v[112:113], v[96:97], v[104:105] op_sel_hi:[0,1,1] neg_lo:[0,0,1] neg_hi:[0,0,1]
    v_pk_fma_f32 v[106:107], v[112:113], v[98:99], v[106:107] op_sel_hi:[0,1,1] neg_lo:[0,0,1] neg_hi:[0,0,1]
    v_pk_fma_f32 v[108:109], v[112:113], v[100:101], v[108:109] op_sel_hi:[0,1,1] neg_lo:[0,0,1] neg_hi:[0,0,1]
    v_pk_fma_f32 v[110:111], v[112:113], v[102:103], v[110:111] op_sel_hi:[0,1,1] neg_lo:[0,0,1] neg_hi:[0,0,1]
    s_waitcnt lgkmcnt(3)
    v_mfma_f32_32x32x16_bf16 v[24:39], v[84:87], v[156:159], v[24:39]
    v_mfma_f32_32x32x16_bf16 v[40:55], v[84:87], v[120:123], v[40:55]
    ds_read_b128 v[84:87], v91 offset:8192
    v_cvt_pk_bf16_f32 v116, v104, v105
    v_cvt_pk_bf16_f32 v117, v106, v107
    v_cvt_pk_bf16_f32 v118, v108, v109
    v_cvt_pk_bf16_f32 v119, v110, v111
    v_pk_fma_f32 v[96:97], v[112:113], v[104:105], v[96:97] op_sel_hi:[0,1,1] neg_lo:[0,0,1] neg_hi:[0,0,1]
    v_pk_fma_f32 v[98:99], v[112:113], v[106:107], v[98:99] op_sel_hi:[0,1,1] neg_lo:[0,0,1] neg_hi:[0,0,1]
    v_pk_fma_f32 v[100:101], v[112:113], v[108:109], v[100:101] op_sel_hi:[0,1,1] neg_lo:[0,0,1] neg_hi:[0,0,1]
    v_pk_fma_f32 v[102:103], v[112:113], v[110:111], v[102:103] op_sel_hi:[0,1,1] neg_lo:[0,0,1] neg_hi:[0,0,1]
    s_waitcnt lgkmcnt(3)
    v_mfma_f32_32x32x16_bf16 v[24:39], v[72:75], v[160:163], v[24:39]
    v_mfma_f32_32x32x16_bf16 v[40:55], v[72:75], v[116:119], v[40:55]
    ds_read_b128 v[72:75], v88 offset:12288
    v_cvt_pk_bf16_f32 v120, v96, v97
    v_cvt_pk_bf16_f32 v121, v98, v99
    v_cvt_pk_bf16_f32 v122, v100, v101
    v_cvt_pk_bf16_f32 v123, v102, v103
    v_pk_fma_f32 v[104:105], v[112:113], v[96:97], v[104:105] op_sel_hi:[0,1,1] neg_lo:[0,0,1] neg_hi:[0,0,1]
    v_pk_fma_f32 v[106:107], v[112:113], v[98:99], v[106:107] op_sel_hi:[0,1,1] neg_lo:[0,0,1] neg_hi:[0,0,1]
    v_pk_fma_f32 v[108:109], v[112:113], v[100:101], v[108:109] op_sel_hi:[0,1,1] neg_lo:[0,0,1] neg_hi:[0,0,1]
    v_pk_fma_f32 v[110:111], v[112:113], v[102:103], v[110:111] op_sel_hi:[0,1,1] neg_lo:[0,0,1] neg_hi:[0,0,1]
    s_waitcnt lgkmcnt(3)
    v_mfma_f32_32x32x16_bf16 v[24:39], v[76:79], v[164:167], v[24:39]
    v_mfma_f32_32x32x16_bf16 v[40:55], v[76:79], v[120:123], v[40:55]
    ds_read_b128 v[76:79], v89 offset:12288
    v_cvt_pk_bf16_f32 v116, v104, v105
    v_cvt_pk_bf16_f32 v117, v106, v107
    v_cvt_pk_bf16_f32 v118, v108, v109
    v_cvt_pk_bf16_f32 v119, v110, v111
    v_pk_fma_f32 v[96:97], v[112:113], v[104:105], v[96:97] op_sel_hi:[0,1,1] neg_lo:[0,0,1] neg_hi:[0,0,1]
    v_pk_fma_f32 v[98:99], v[112:113], v[106:107], v[98:99] op_sel_hi:[0,1,1] neg_lo:[0,0,1] neg_hi:[0,0,1]
    v_pk_fma_f32 v[100:101], v[112:113], v[108:109], v[100:101] op_sel_hi:[0,1,1] neg_lo:[0,0,1] neg_hi:[0,0,1]
    v_pk_fma_f32 v[102:103], v[112:113], v[110:111], v[102:103] op_sel_hi:[0,1,1] neg_lo:[0,0,1] neg_hi:[0,0,1]
    s_waitcnt lgkmcnt(3)
    v_mfma_f32_32x32x16_bf16 v[24:39], v[80:83], v[168:171], v[24:39]
    v_mfma_f32_32x32x16_bf16 v[40:55], v[80:83], v[116:119], v[40:55]
    ds_read_b128 v[80:83], v90 offset:12288
    v_cvt_pk_bf16_f32 v120, v96, v97
    v_cvt_pk_bf16_f32 v121, v98, v99
    v_cvt_pk_bf16_f32 v122, v100, v101
    v_cvt_pk_bf16_f32 v123, v102, v103
    v_pk_fma_f32 v[104:105], v[112:113], v[96:97], v[104:105] op_sel_hi:[0,1,1] neg_lo:[0,0,1] neg_hi:[0,0,1]
    v_pk_fma_f32 v[106:107], v[112:113], v[98:99], v[106:107] op_sel_hi:[0,1,1] neg_lo:[0,0,1] neg_hi:[0,0,1]
    v_pk_fma_f32 v[108:109], v[112:113], v[100:101], v[108:109] op_sel_hi:[0,1,1] neg_lo:[0,0,1] neg_hi:[0,0,1]
    v_pk_fma_f32 v[110:111], v[112:113], v[102:103], v[110:111] op_sel_hi:[0,1,1] neg_lo:[0,0,1] neg_hi:[0,0,1]
    s_waitcnt lgkmcnt(3)
    v_mfma_f32_32x32x16_bf16 v[24:39], v[84:87], v[172:175], v[24:39]
    v_mfma_f32_32x32x16_bf16 v[40:55], v[84:87], v[120:123], v[40:55]
    ds_read_b128 v[84:87], v91 offset:12288
    v_cvt_pk_bf16_f32 v116, v104, v105
    v_cvt_pk_bf16_f32 v117, v106, v107
    v_cvt_pk_bf16_f32 v118, v108, v109
    v_cvt_pk_bf16_f32 v119, v110, v111
    v_pk_fma_f32 v[96:97], v[112:113], v[104:105], v[96:97] op_sel_hi:[0,1,1] neg_lo:[0,0,1] neg_hi:[0,0,1]
    v_pk_fma_f32 v[98:99], v[112:113], v[106:107], v[98:99] op_sel_hi:[0,1,1] neg_lo:[0,0,1] neg_hi:[0,0,1]
    v_pk_fma_f32 v[100:101], v[112:113], v[108:109], v[100:101] op_sel_hi:[0,1,1] neg_lo:[0,0,1] neg_hi:[0,0,1]
    v_pk_fma_f32 v[102:103], v[112:113], v[110:111], v[102:103] op_sel_hi:[0,1,1] neg_lo:[0,0,1] neg_hi:[0,0,1]
    s_waitcnt lgkmcnt(3)
    v_mfma_f32_32x32x16_bf16 v[24:39], v[72:75], v[176:179], v[24:39]
    v_mfma_f32_32x32x16_bf16 v[40:55], v[72:75], v[116:119], v[40:55]
    ds_read_b128 v[72:75], v88 offset:16384
    v_cvt_pk_bf16_f32 v120, v96, v97
    v_cvt_pk_bf16_f32 v121, v98, v99
    v_cvt_pk_bf16_f32 v122, v100, v101
    v_cvt_pk_bf16_f32 v123, v102, v103
    v_pk_fma_f32 v[104:105], v[112:113], v[96:97], v[104:105] op_sel_hi:[0,1,1] neg_lo:[0,0,1] neg_hi:[0,0,1]
    v_pk_fma_f32 v[106:107], v[112:113], v[98:99], v[106:107] op_sel_hi:[0,1,1] neg_lo:[0,0,1] neg_hi:[0,0,1]
    v_pk_fma_f32 v[108:109], v[112:113], v[100:101], v[108:109] op_sel_hi:[0,1,1] neg_lo:[0,0,1] neg_hi:[0,0,1]
    v_pk_fma_f32 v[110:111], v[112:113], v[102:103], v[110:111] op_sel_hi:[0,1,1] neg_lo:[0,0,1] neg_hi:[0,0,1]
    s_waitcnt lgkmcnt(3)
    v_mfma_f32_32x32x16_bf16 v[24:39], v[76:79], v[180:183], v[24:39]
    v_mfma_f32_32x32x16_bf16 v[40:55], v[76:79], v[120:123], v[40:55]
    ds_read_b128 v[76:79], v89 offset:16384
    v_cvt_pk_bf16_f32 v116, v104, v105
    v_cvt_pk_bf16_f32 v117, v106, v107
    v_cvt_pk_bf16_f32 v118, v108, v109
    v_cvt_pk_bf16_f32 v119, v110, v111
    v_pk_fma_f32 v[96:97], v[112:113], v[104:105], v[96:97] op_sel_hi:[0,1,1] neg_lo:[0,0,1] neg_hi:[0,0,1]
    v_pk_fma_f32 v[98:99], v[112:113], v[106:107], v[98:99] op_sel_hi:[0,1,1] neg_lo:[0,0,1] neg_hi:[0,0,1]
    v_pk_fma_f32 v[100:101], v[112:113], v[108:109], v[100:101] op_sel_hi:[0,1,1] neg_lo:[0,0,1] neg_hi:[0,0,1]
    v_pk_fma_f32 v[102:103], v[112:113], v[110:111], v[102:103] op_sel_hi:[0,1,1] neg_lo:[0,0,1] neg_hi:[0,0,1]
    s_waitcnt lgkmcnt(3)
    v_mfma_f32_32x32x16_bf16 v[24:39], v[80:83], v[184:187], v[24:39]
    v_mfma_f32_32x32x16_bf16 v[40:55], v[80:83], v[116:119], v[40:55]
    ds_read_b128 v[80:83], v90 offset:16384
    v_cvt_pk_bf16_f32 v120, v96, v97
    v_cvt_pk_bf16_f32 v121, v98, v99
    v_cvt_pk_bf16_f32 v122, v100, v101
    v_cvt_pk_bf16_f32 v123, v102, v103
    v_pk_fma_f32 v[104:105], v[112:113], v[96:97], v[104:105] op_sel_hi:[0,1,1] neg_lo:[0,0,1] neg_hi:[0,0,1]
    v_pk_fma_f32 v[106:107], v[112:113], v[98:99], v[106:107] op_sel_hi:[0,1,1] neg_lo:[0,0,1] neg_hi:[0,0,1]
    v_pk_fma_f32 v[108:109], v[112:113], v[100:101], v[108:109] op_sel_hi:[0,1,1] neg_lo:[0,0,1] neg_hi:[0,0,1]
    v_pk_fma_f32 v[110:111], v[112:113], v[102:103], v[110:111] op_sel_hi:[0,1,1] neg_lo:[0,0,1] neg_hi:[0,0,1]
    s_waitcnt lgkmcnt(3)
    v_mfma_f32_32x32x16_bf16 v[24:39], v[84:87], v[188:191], v[24:39]
    v_mfma_f32_32x32x16_bf16 v[40:55], v[84:87], v[120:123], v[40:55]
    ds_read_b128 v[84:87], v91 offset:16384
    v_cvt_pk_bf16_f32 v116, v104, v105
    v_cvt_pk_bf16_f32 v117, v106, v107
    v_cvt_pk_bf16_f32 v118, v108, v109
    v_cvt_pk_bf16_f32 v119, v110, v111
    v_pk_fma_f32 v[96:97], v[112:113], v[104:105], v[96:97] op_sel_hi:[0,1,1] neg_lo:[0,0,1] neg_hi:[0,0,1]
    v_pk_fma_f32 v[98:99], v[112:113], v[106:107], v[98:99] op_sel_hi:[0,1,1] neg_lo:[0,0,1] neg_hi:[0,0,1]
    v_pk_fma_f32 v[100:101], v[112:113], v[108:109], v[100:101] op_sel_hi:[0,1,1] neg_lo:[0,0,1] neg_hi:[0,0,1]
    v_pk_fma_f32 v[102:103], v[112:113], v[110:111], v[102:103] op_sel_hi:[0,1,1] neg_lo:[0,0,1] neg_hi:[0,0,1]
    s_waitcnt lgkmcnt(3)
    v_mfma_f32_32x32x16_bf16 v[24:39], v[72:75], v[192:195], v[24:39]
    v_mfma_f32_32x32x16_bf16 v[40:55], v[72:75], v[116:119], v[40:55]
    ds_read_b128 v[72:75], v88 offset:20480
    v_cvt_pk_bf16_f32 v120, v96, v97
    v_cvt_pk_bf16_f32 v121, v98, v99
    v_cvt_pk_bf16_f32 v122, v100, v101
    v_cvt_pk_bf16_f32 v123, v102, v103
    v_pk_fma_f32 v[104:105], v[112:113], v[96:97], v[104:105] op_sel_hi:[0,1,1] neg_lo:[0,0,1] neg_hi:[0,0,1]
    v_pk_fma_f32 v[106:107], v[112:113], v[98:99], v[106:107] op_sel_hi:[0,1,1] neg_lo:[0,0,1] neg_hi:[0,0,1]
    v_pk_fma_f32 v[108:109], v[112:113], v[100:101], v[108:109] op_sel_hi:[0,1,1] neg_lo:[0,0,1] neg_hi:[0,0,1]
    v_pk_fma_f32 v[110:111], v[112:113], v[102:103], v[110:111] op_sel_hi:[0,1,1] neg_lo:[0,0,1] neg_hi:[0,0,1]
    s_waitcnt lgkmcnt(3)
    v_mfma_f32_32x32x16_bf16 v[24:39], v[76:79], v[196:199], v[24:39]
    v_mfma_f32_32x32x16_bf16 v[40:55], v[76:79], v[120:123], v[40:55]
    ds_read_b128 v[76:79], v89 offset:20480
    v_cvt_pk_bf16_f32 v116, v104, v105
    v_cvt_pk_bf16_f32 v117, v106, v107
    v_cvt_pk_bf16_f32 v118, v108, v109
    v_cvt_pk_bf16_f32 v119, v110, v111
    v_pk_fma_f32 v[96:97], v[112:113], v[104:105], v[96:97] op_sel_hi:[0,1,1] neg_lo:[0,0,1] neg_hi:[0,0,1]
    v_pk_fma_f32 v[98:99], v[112:113], v[106:107], v[98:99] op_sel_hi:[0,1,1] neg_lo:[0,0,1] neg_hi:[0,0,1]
    v_pk_fma_f32 v[100:101], v[112:113], v[108:109], v[100:101] op_sel_hi:[0,1,1] neg_lo:[0,0,1] neg_hi:[0,0,1]
    v_pk_fma_f32 v[102:103], v[112:113], v[110:111], v[102:103] op_sel_hi:[0,1,1] neg_lo:[0,0,1] neg_hi:[0,0,1]
    s_waitcnt lgkmcnt(3)
    v_mfma_f32_32x32x16_bf16 v[24:39], v[80:83], v[200:203], v[24:39]
    v_mfma_f32_32x32x16_bf16 v[40:55], v[80:83], v[116:119], v[40:55]
    ds_read_b128 v[80:83], v90 offset:20480
    v_cvt_pk_bf16_f32 v120, v96, v97
    v_cvt_pk_bf16_f32 v121, v98, v99
    v_cvt_pk_bf16_f32 v122, v100, v101
    v_cvt_pk_bf16_f32 v123, v102, v103
    v_pk_fma_f32 v[104:105], v[112:113], v[96:97], v[104:105] op_sel_hi:[0,1,1] neg_lo:[0,0,1] neg_hi:[0,0,1]
    v_pk_fma_f32 v[106:107], v[112:113], v[98:99], v[106:107] op_sel_hi:[0,1,1] neg_lo:[0,0,1] neg_hi:[0,0,1]
    v_pk_fma_f32 v[108:109], v[112:113], v[100:101], v[108:109] op_sel_hi:[0,1,1] neg_lo:[0,0,1] neg_hi:[0,0,1]
    v_pk_fma_f32 v[110:111], v[112:113], v[102:103], v[110:111] op_sel_hi:[0,1,1] neg_lo:[0,0,1] neg_hi:[0,0,1]
    s_waitcnt lgkmcnt(3)
    v_mfma_f32_32x32x16_bf16 v[24:39], v[84:87], v[204:207], v[24:39]
    v_mfma_f32_32x32x16_bf16 v[40:55], v[84:87], v[120:123], v[40:55]
    ds_read_b128 v[84:87], v91 offset:20480
    v_cvt_pk_bf16_f32 v116, v104, v105
    v_cvt_pk_bf16_f32 v117, v106, v107
    v_cvt_pk_bf16_f32 v118, v108, v109
    v_cvt_pk_bf16_f32 v119, v110, v111
    v_pk_fma_f32 v[96:97], v[112:113], v[104:105], v[96:97] op_sel_hi:[0,1,1] neg_lo:[0,0,1] neg_hi:[0,0,1]
    v_pk_fma_f32 v[98:99], v[112:113], v[106:107], v[98:99] op_sel_hi:[0,1,1] neg_lo:[0,0,1] neg_hi:[0,0,1]
    v_pk_fma_f32 v[100:101], v[112:113], v[108:109], v[100:101] op_sel_hi:[0,1,1] neg_lo:[0,0,1] neg_hi:[0,0,1]
    v_pk_fma_f32 v[102:103], v[112:113], v[110:111], v[102:103] op_sel_hi:[0,1,1] neg_lo:[0,0,1] neg_hi:[0,0,1]
    s_waitcnt lgkmcnt(3)
    v_mfma_f32_32x32x16_bf16 v[24:39], v[72:75], v[208:211], v[24:39]
    v_mfma_f32_32x32x16_bf16 v[40:55], v[72:75], v[116:119], v[40:55]
    ds_read_b128 v[72:75], v88 offset:24576
    v_cvt_pk_bf16_f32 v120, v96, v97
    v_cvt_pk_bf16_f32 v121, v98, v99
    v_cvt_pk_bf16_f32 v122, v100, v101
    v_cvt_pk_bf16_f32 v123, v102, v103
    v_pk_fma_f32 v[104:105], v[112:113], v[96:97], v[104:105] op_sel_hi:[0,1,1] neg_lo:[0,0,1] neg_hi:[0,0,1]
    v_pk_fma_f32 v[106:107], v[112:113], v[98:99], v[106:107] op_sel_hi:[0,1,1] neg_lo:[0,0,1] neg_hi:[0,0,1]
    v_pk_fma_f32 v[108:109], v[112:113], v[100:101], v[108:109] op_sel_hi:[0,1,1] neg_lo:[0,0,1] neg_hi:[0,0,1]
    v_pk_fma_f32 v[110:111], v[112:113], v[102:103], v[110:111] op_sel_hi:[0,1,1] neg_lo:[0,0,1] neg_hi:[0,0,1]
    s_waitcnt lgkmcnt(3)
    v_mfma_f32_32x32x16_bf16 v[24:39], v[76:79], v[212:215], v[24:39]
    v_mfma_f32_32x32x16_bf16 v[40:55], v[76:79], v[120:123], v[40:55]
    ds_read_b128 v[76:79], v89 offset:24576
    v_cvt_pk_bf16_f32 v116, v104, v105
    v_cvt_pk_bf16_f32 v117, v106, v107
    v_cvt_pk_bf16_f32 v118, v108, v109
    v_cvt_pk_bf16_f32 v119, v110, v111
    v_pk_fma_f32 v[96:97], v[112:113], v[104:105], v[96:97] op_sel_hi:[0,1,1] neg_lo:[0,0,1] neg_hi:[0,0,1]
    v_pk_fma_f32 v[98:99], v[112:113], v[106:107], v[98:99] op_sel_hi:[0,1,1] neg_lo:[0,0,1] neg_hi:[0,0,1]
    v_pk_fma_f32 v[100:101], v[112:113], v[108:109], v[100:101] op_sel_hi:[0,1,1] neg_lo:[0,0,1] neg_hi:[0,0,1]
    v_pk_fma_f32 v[102:103], v[112:113], v[110:111], v[102:103] op_sel_hi:[0,1,1] neg_lo:[0,0,1] neg_hi:[0,0,1]
    s_waitcnt lgkmcnt(3)
    v_mfma_f32_32x32x16_bf16 v[24:39], v[80:83], v[216:219], v[24:39]
    v_mfma_f32_32x32x16_bf16 v[40:55], v[80:83], v[116:119], v[40:55]
    ds_read_b128 v[80:83], v90 offset:24576
    v_cvt_pk_bf16_f32 v120, v96, v97
    v_cvt_pk_bf16_f32 v121, v98, v99
    v_cvt_pk_bf16_f32 v122, v100, v101
    v_cvt_pk_bf16_f32 v123, v102, v103
    v_pk_fma_f32 v[104:105], v[112:113], v[96:97], v[104:105] op_sel_hi:[0,1,1] neg_lo:[0,0,1] neg_hi:[0,0,1]
    v_pk_fma_f32 v[106:107], v[112:113], v[98:99], v[106:107] op_sel_hi:[0,1,1] neg_lo:[0,0,1] neg_hi:[0,0,1]
    v_pk_fma_f32 v[108:109], v[112:113], v[100:101], v[108:109] op_sel_hi:[0,1,1] neg_lo:[0,0,1] neg_hi:[0,0,1]
    v_pk_fma_f32 v[110:111], v[112:113], v[102:103], v[110:111] op_sel_hi:[0,1,1] neg_lo:[0,0,1] neg_hi:[0,0,1]
    s_waitcnt lgkmcnt(3)
    v_mfma_f32_32x32x16_bf16 v[24:39], v[84:87], v[220:223], v[24:39]
    v_mfma_f32_32x32x16_bf16 v[40:55], v[84:87], v[120:123], v[40:55]
    ds_read_b128 v[84:87], v91 offset:24576
    v_cvt_pk_bf16_f32 v116, v104, v105
    v_cvt_pk_bf16_f32 v117, v106, v107
    v_cvt_pk_bf16_f32 v118, v108, v109
    v_cvt_pk_bf16_f32 v119, v110, v111
    v_pk_fma_f32 v[96:97], v[112:113], v[104:105], v[96:97] op_sel_hi:[0,1,1] neg_lo:[0,0,1] neg_hi:[0,0,1]
    v_pk_fma_f32 v[98:99], v[112:113], v[106:107], v[98:99] op_sel_hi:[0,1,1] neg_lo:[0,0,1] neg_hi:[0,0,1]
    v_pk_fma_f32 v[100:101], v[112:113], v[108:109], v[100:101] op_sel_hi:[0,1,1] neg_lo:[0,0,1] neg_hi:[0,0,1]
    v_pk_fma_f32 v[102:103], v[112:113], v[110:111], v[102:103] op_sel_hi:[0,1,1] neg_lo:[0,0,1] neg_hi:[0,0,1]
    s_waitcnt lgkmcnt(3)
    v_mfma_f32_32x32x16_bf16 v[24:39], v[72:75], v[224:227], v[24:39]
    v_mfma_f32_32x32x16_bf16 v[40:55], v[72:75], v[116:119], v[40:55]
    ds_read_b128 v[72:75], v88 offset:28672
    v_cvt_pk_bf16_f32 v120, v96, v97
    v_cvt_pk_bf16_f32 v121, v98, v99
    v_cvt_pk_bf16_f32 v122, v100, v101
    v_cvt_pk_bf16_f32 v123, v102, v103
    v_pk_fma_f32 v[104:105], v[112:113], v[96:97], v[104:105] op_sel_hi:[0,1,1] neg_lo:[0,0,1] neg_hi:[0,0,1]
    v_pk_fma_f32 v[106:107], v[112:113], v[98:99], v[106:107] op_sel_hi:[0,1,1] neg_lo:[0,0,1] neg_hi:[0,0,1]
    v_pk_fma_f32 v[108:109], v[112:113], v[100:101], v[108:109] op_sel_hi:[0,1,1] neg_lo:[0,0,1] neg_hi:[0,0,1]
    v_pk_fma_f32 v[110:111], v[112:113], v[102:103], v[110:111] op_sel_hi:[0,1,1] neg_lo:[0,0,1] neg_hi:[0,0,1]
    s_waitcnt lgkmcnt(3)
    v_mfma_f32_32x32x16_bf16 v[24:39], v[76:79], v[228:231], v[24:39]
    v_mfma_f32_32x32x16_bf16 v[40:55], v[76:79], v[120:123], v[40:55]
    ds_read_b128 v[76:79], v89 offset:28672
    v_cvt_pk_bf16_f32 v116, v104, v105
    v_cvt_pk_bf16_f32 v117, v106, v107
    v_cvt_pk_bf16_f32 v118, v108, v109
    v_cvt_pk_bf16_f32 v119, v110, v111
    v_pk_fma_f32 v[96:97], v[112:113], v[104:105], v[96:97] op_sel_hi:[0,1,1] neg_lo:[0,0,1] neg_hi:[0,0,1]
    v_pk_fma_f32 v[98:99], v[112:113], v[106:107], v[98:99] op_sel_hi:[0,1,1] neg_lo:[0,0,1] neg_hi:[0,0,1]
    v_pk_fma_f32 v[100:101], v[112:113], v[108:109], v[100:101] op_sel_hi:[0,1,1] neg_lo:[0,0,1] neg_hi:[0,0,1]
    v_pk_fma_f32 v[102:103], v[112:113], v[110:111], v[102:103] op_sel_hi:[0,1,1] neg_lo:[0,0,1] neg_hi:[0,0,1]
    s_waitcnt lgkmcnt(3)
    v_mfma_f32_32x32x16_bf16 v[24:39], v[80:83], v[232:235], v[24:39]
    v_mfma_f32_32x32x16_bf16 v[40:55], v[80:83], v[116:119], v[40:55]
    ds_read_b128 v[80:83], v90 offset:28672
    v_cvt_pk_bf16_f32 v120, v96, v97
    v_cvt_pk_bf16_f32 v121, v98, v99
    v_cvt_pk_bf16_f32 v122, v100, v101
    v_cvt_pk_bf16_f32 v123, v102, v103
    v_pk_fma_f32 v[104:105], v[112:113], v[96:97], v[104:105] op_sel_hi:[0,1,1] neg_lo:[0,0,1] neg_hi:[0,0,1]
    v_pk_fma_f32 v[106:107], v[112:113], v[98:99], v[106:107] op_sel_hi:[0,1,1] neg_lo:[0,0,1] neg_hi:[0,0,1]
    v_pk_fma_f32 v[108:109], v[112:113], v[100:101], v[108:109] op_sel_hi:[0,1,1] neg_lo:[0,0,1] neg_hi:[0,0,1]
    v_pk_fma_f32 v[110:111], v[112:113], v[102:103], v[110:111] op_sel_hi:[0,1,1] neg_lo:[0,0,1] neg_hi:[0,0,1]
    s_waitcnt lgkmcnt(3)
    v_mfma_f32_32x32x16_bf16 v[24:39], v[84:87], v[236:239], v[24:39]
    v_mfma_f32_32x32x16_bf16 v[40:55], v[84:87], v[120:123], v[40:55]
    ds_read_b128 v[84:87], v91 offset:28672
    v_cvt_pk_bf16_f32 v116, v104, v105
    v_cvt_pk_bf16_f32 v117, v106, v107
    v_cvt_pk_bf16_f32 v118, v108, v109
    v_cvt_pk_bf16_f32 v119, v110, v111
    v_pk_fma_f32 v[96:97], v[112:113], v[104:105], v[96:97] op_sel_hi:[0,1,1] neg_lo:[0,0,1] neg_hi:[0,0,1]
    v_pk_fma_f32 v[98:99], v[112:113], v[106:107], v[98:99] op_sel_hi:[0,1,1] neg_lo:[0,0,1] neg_hi:[0,0,1]
    v_pk_fma_f32 v[100:101], v[112:113], v[108:109], v[100:101] op_sel_hi:[0,1,1] neg_lo:[0,0,1] neg_hi:[0,0,1]
    v_pk_fma_f32 v[102:103], v[112:113], v[110:111], v[102:103] op_sel_hi:[0,1,1] neg_lo:[0,0,1] neg_hi:[0,0,1]
    s_waitcnt lgkmcnt(3)
    v_mfma_f32_32x32x16_bf16 v[24:39], v[72:75], v[240:243], v[24:39]
    v_mfma_f32_32x32x16_bf16 v[40:55], v[72:75], v[116:119], v[40:55]
    v_cvt_pk_bf16_f32 v120, v96, v97
    v_cvt_pk_bf16_f32 v121, v98, v99
    v_cvt_pk_bf16_f32 v122, v100, v101
    v_cvt_pk_bf16_f32 v123, v102, v103
    v_pk_fma_f32 v[104:105], v[112:113], v[96:97], v[104:105] op_sel_hi:[0,1,1] neg_lo:[0,0,1] neg_hi:[0,0,1]
    v_pk_fma_f32 v[106:107], v[112:113], v[98:99], v[106:107] op_sel_hi:[0,1,1] neg_lo:[0,0,1] neg_hi:[0,0,1]
    v_pk_fma_f32 v[108:109], v[112:113], v[100:101], v[108:109] op_sel_hi:[0,1,1] neg_lo:[0,0,1] neg_hi:[0,0,1]
    v_pk_fma_f32 v[110:111], v[112:113], v[102:103], v[110:111] op_sel_hi:[0,1,1] neg_lo:[0,0,1] neg_hi:[0,0,1]
    s_waitcnt lgkmcnt(2)
    v_mfma_f32_32x32x16_bf16 v[24:39], v[76:79], v[244:247], v[24:39]
    v_mfma_f32_32x32x16_bf16 v[40:55], v[76:79], v[120:123], v[40:55]
    v_cvt_pk_bf16_f32 v116, v104, v105
    v_cvt_pk_bf16_f32 v117, v106, v107
    v_cvt_pk_bf16_f32 v118, v108, v109
    v_cvt_pk_bf16_f32 v119, v110, v111
    v_pk_fma_f32 v[96:97], v[112:113], v[104:105], v[96:97] op_sel_hi:[0,1,1] neg_lo:[0,0,1] neg_hi:[0,0,1]
    v_pk_fma_f32 v[98:99], v[112:113], v[106:107], v[98:99] op_sel_hi:[0,1,1] neg_lo:[0,0,1] neg_hi:[0,0,1]
    v_pk_fma_f32 v[100:101], v[112:113], v[108:109], v[100:101] op_sel_hi:[0,1,1] neg_lo:[0,0,1] neg_hi:[0,0,1]
    v_pk_fma_f32 v[102:103], v[112:113], v[110:111], v[102:103] op_sel_hi:[0,1,1] neg_lo:[0,0,1] neg_hi:[0,0,1]
    s_waitcnt lgkmcnt(1)
    v_mfma_f32_32x32x16_bf16 v[24:39], v[80:83], v[248:251], v[24:39]
    v_mfma_f32_32x32x16_bf16 v[40:55], v[80:83], v[116:119], v[40:55]
    v_cvt_pk_bf16_f32 v120, v96, v97
    v_cvt_pk_bf16_f32 v121, v98, v99
    v_cvt_pk_bf16_f32 v122, v100, v101
    v_cvt_pk_bf16_f32 v123, v102, v103
    s_waitcnt lgkmcnt(0)
    v_mfma_f32_32x32x16_bf16 v[24:39], v[84:87], v[252:255], v[24:39]
    v_mfma_f32_32x32x16_bf16 v[40:55], v[84:87], v[120:123], v[40:55]
    s_mul_i32 s53, s3, 88064
    s_lshl_b32 s54, s60, 11
    s_add_u32 s53, s53, s54
    s_add_u32 s55, s53, 24117248
    s_add_u32 s56, s55, 704512
    v_lshlrev_b32 v6, 4, v1
    s_nop 4
    v_cvt_pk_bf16_f32 v56, v24, v25
    v_cvt_pk_bf16_f32 v57, v26, v27
    v_cvt_pk_bf16_f32 v58, v28, v29
    v_cvt_pk_bf16_f32 v59, v30, v31
    s_nop 0
    v_permlane32_swap_b32 v56, v58
    v_permlane32_swap_b32 v57, v59
    v_cvt_pk_bf16_f32 v60, v32, v33
    v_cvt_pk_bf16_f32 v61, v34, v35
    v_cvt_pk_bf16_f32 v62, v36, v37
    v_cvt_pk_bf16_f32 v63, v38, v39
    s_nop 0
    v_permlane32_swap_b32 v60, v62
    v_permlane32_swap_b32 v61, v63
    v_cvt_pk_bf16_f32 v64, v40, v41
    v_cvt_pk_bf16_f32 v65, v42, v43
    v_cvt_pk_bf16_f32 v66, v44, v45
    v_cvt_pk_bf16_f32 v67, v46, v47
    s_nop 0
    v_permlane32_swap_b32 v64, v66
    v_permlane32_swap_b32 v65, v67
    v_cvt_pk_bf16_f32 v68, v48, v49
    v_cvt_pk_bf16_f32 v69, v50, v51
    v_cvt_pk_bf16_f32 v70, v52, v53
    v_cvt_pk_bf16_f32 v71, v54, v55
    s_nop 0
    v_permlane32_swap_b32 v68, v70
    v_permlane32_swap_b32 v69, v71
    buffer_store_dwordx4 v[56:59], v6, s[4:7], s55 offen sc1
    buffer_store_dwordx4 v[60:63], v6, s[4:7], s55 offen offset:1024 sc1
    buffer_store_dwordx4 v[64:67], v6, s[4:7], s56 offen sc1
    buffer_store_dwordx4 v[68:71], v6, s[4:7], s56 offen offset:1024 sc1
    s_lshr_b32 s54, s3, 1
    s_lshl_b32 s54, s54, 12
    s_bitcmp1_b32 s3, 0
    s_cbranch_scc1 L_m_T317_o
    v_add_u32 v7, s54, v88
    v_add_u32 v8, s54, v89
    s_nop 0
    s_branch L_m_T317_j
L_m_T317_o:
    v_add_u32 v7, s54, v90
    v_add_u32 v8, s54, v91
L_m_T317_j:
    ds_read_b128 v[72:75], v7
    ds_read_b128 v[76:79], v8
    ds_read_b128 v[80:83], v7 offset:16384
    ds_read_b128 v[84:87], v8 offset:16384
    s_waitcnt lgkmcnt(0)
    v_mfma_f32_32x32x16_bf16 v[24:39], v[72:75], v[16:19], 0
    v_mfma_f32_32x32x16_bf16 v[40:55], v[80:83], v[16:19], 0
    v_mfma_f32_32x32x16_bf16 v[24:39], v[76:79], v[20:23], v[24:39]
    v_mfma_f32_32x32x16_bf16 v[40:55], v[84:87], v[20:23], v[40:55]
    s_add_u32 s55, s53, 26214400
    s_add_u32 s56, s55, 704512
    s_nop 8
    v_cvt_pk_bf16_f32 v72, v24, v25
    v_cvt_pk_bf16_f32 v73, v26, v27
    v_cvt_pk_bf16_f32 v74, v28, v29
    v_cvt_pk_bf16_f32 v75, v30, v31
    s_nop 0
    v_permlane32_swap_b32 v72, v74
    v_permlane32_swap_b32 v73, v75
    v_cvt_pk_bf16_f32 v76, v32, v33
    v_cvt_pk_bf16_f32 v77, v34, v35
    v_cvt_pk_bf16_f32 v78, v36, v37
    v_cvt_pk_bf16_f32 v79, v38, v39
    s_nop 0
    v_permlane32_swap_b32 v76, v78
    v_permlane32_swap_b32 v77, v79
    v_cvt_pk_bf16_f32 v80, v40, v41
    v_cvt_pk_bf16_f32 v81, v42, v43
    v_cvt_pk_bf16_f32 v82, v44, v45
    v_cvt_pk_bf16_f32 v83, v46, v47
    s_nop 0
    v_permlane32_swap_b32 v80, v82
    v_permlane32_swap_b32 v81, v83
    v_cvt_pk_bf16_f32 v84, v48, v49
    v_cvt_pk_bf16_f32 v85, v50, v51
    v_cvt_pk_bf16_f32 v86, v52, v53
    v_cvt_pk_bf16_f32 v87, v54, v55
    s_nop 0
    v_permlane32_swap_b32 v84, v86
    v_permlane32_swap_b32 v85, v87
    buffer_store_dwordx4 v[72:75], v6, s[4:7], s55 offen sc1
    buffer_store_dwordx4 v[76:79], v6, s[4:7], s55 offen offset:1024 sc1
    buffer_store_dwordx4 v[80:83], v6, s[4:7], s56 offen sc1
    buffer_store_dwordx4 v[84:87], v6, s[4:7], s56 offen offset:1024 sc1
L_m_TU16_end:
    s_cmp_eq_u32 s74, 128
    s_cbranch_scc1 L_m_T7_fin
    s_waitcnt vmcnt(0)
    s_barrier
    s_cmp_eq_u32 s3, 0
    s_cbranch_scc0 L_m_PUB18
    s_add_u32 s91, s40, 3
    s_lshl_b32 s90, s2, 7
    s_add_u32 s90, s90, 31457280
    v_mov_b32 v8, s91
    v_mov_b32 v9, 0
    s_mov_b64 exec, 1
    buffer_store_dword v8, v9, s[4:7], s90 offen sc0 sc1
    s_mov_b64 exec, -1
L_m_PUB18:
    s_barrier
    s_cmp_eq_u32 s2, 255
    s_nop 0
    s_cbranch_scc0 L_m_T7_done
    s_mov_b32 s74, 128
    s_mov_b32 s64, 66048
    s_branch L_m_T7_loop
L_m_T7_fin:
    s_waitcnt vmcnt(0)
    s_barrier
    s_cmp_eq_u32 s3, 0
    s_cbranch_scc0 L_m_PUB19
    s_add_u32 s91, s40, 4
    s_lshl_b32 s90, s2, 7
    s_add_u32 s90, s90, 31457280
    v_mov_b32 v8, s91
    v_mov_b32 v9, 0
    s_mov_b64 exec, 1
    buffer_store_dword v8, v9, s[4:7], s90 offen sc0 sc1
    s_mov_b64 exec, -1
L_m_PUB19:
    s_barrier
L_m_T7_done:
    s_cmp_eq_u32 s3, 0
    s_nop 0
    s_cbranch_scc0 L_m_W20_skip
    s_add_u32 s91, s40, 3
    v_lshlrev_b32 v12, 7, v1
    s_mov_b32 s90, 31473664
    s_mov_b32 s89, 0x40000
    v_add_u32 v13, 8192, v12
L_m_W20_loop:
    buffer_load_dword v232, v12, s[4:7], s90 offen sc1
    buffer_load_dword v233, v13, s[4:7], s90 offen sc1
    s_waitcnt vmcnt(0)
    v_subrev_u32 v8, s91, v232
    v_subrev_u32 v9, s91, v233
    v_max_u32 v8, v8, v9
    v_cmp_gt_u32 vcc, 16, v8
    s_cmp_eq_u64 vcc, exec
    s_nop 2
    s_cbranch_scc1 L_m_W20_skip
    s_sleep 1
    s_sub_u32 s89, s89, 1
    s_cmp_lg_u32 s89, 0
    s_cbranch_scc1 L_m_W20_loop
L_m_W20_skip:
    s_barrier
L_S0DONE:
    s_mov_b32 s41, 0
    s_mov_b32 s42, 2097152
    s_mov_b32 s43, 30408704
    s_mov_b32 s44, 8388608
    s_add_u32 s92, s40, 3
L_LAYER:
    s_and_b32 s53, s2, 1
    s_bfe_u32 s54, s2, 0x20001
    s_lshr_b32 s55, s2, 3
    s_mul_i32 s53, s53, 11
    s_mov_b32 s76, 0
    s_cmp_eq_u32 s54, 3
    s_cbranch_scc1 L_m_PI21_f3
    s_mul_i32 s56, s55, 21846
    s_lshr_b32 s56, s56, 16
    s_mul_i32 s57, s56, 3
    s_sub_u32 s57, s55, s57
    s_add_u32 s64, s53, s56
    s_mul_i32 s65, s54, 3
    s_add_u32 s65, s65, s57
    s_branch L_m_PI21_j
L_m_PI21_f3:
    s_lshr_b32 s56, s55, 1
    s_add_u32 s64, s53, s56
    s_and_b32 s65, s55, 1
    s_add_u32 s65, s65, 9
    s_cmp_lt_u32 s55, 22
    s_cbranch_scc1 L_m_PI21_j
    s_add_u32 s64, s53, 10
    s_sub_u32 s56, s55, 22
    s_mul_i32 s65, s56, 3
    s_add_u32 s65, s65, 2
    s_cmp_lt_u32 s55, 25
    s_cbranch_scc1 L_m_PI21_j
    s_mov_b32 s76, 1
    s_mov_b32 s64, 0
    s_mov_b32 s65, 0
L_m_PI21_j:
    s_lshl_b32 s66, s65, 3
    s_add_u32 s66, s66, s3
    s_mul_i32 s67, s64, 3
    s_cmp_eq_u32 s64, 21
    s_cselect_b32 s68, 1, 3
    s_cmp_ge_u32 s2, 128
    s_cbranch_scc1 L_NONCOL1
    s_cmp_eq_u32 s93, 0
    s_cbranch_scc1 L_m_PC22
    s_barrier
    s_and_b32 s53, s3, 3
    s_lshl_b32 s53, s53, 4
    v_add_u32 v6, s53, v4
    v_cvt_f32_u32 v6, v6
    v_lshlrev_b32 v7, 2, v5
    v_cvt_f32_u32 v7, v7
    v_cvt_f32_u32 v14, v4
    v_mul_f32 v8, 0x3c800000, v6
    v_mul_f32 v9, v8, v7
    v_mul_f32 v10, 0x41800000, v8
    v_fract_f32 v250, v9
    v_cos_f32 v244, v250
    v_sin_f32 v245, v250
    v_fract_f32 v250, v8
    v_cos_f32 v246, v250
    v_sin_f32 v247, v250
    v_fract_f32 v250, v10
    v_cos_f32 v248, v250
    v_sin_f32 v249, v250
    v_mov_b32 v12, v244
    v_mov_b32 v13, v245
    v_cvt_pk_bf16_f32 v16, v244, v245
    v_cvt_pk_bf16_f32 v32, -v245, v244
    v_pk_mul_f32 v[250:251], v[244:245], v[246:247] op_sel_hi:[1,0]
    v_pk_fma_f32 v[244:245], v[244:245], v[246:247], v[250:251] op_sel:[1,1,0] op_sel_hi:[0,1,1] neg_lo:[0,1,0]
    v_cvt_pk_bf16_f32 v17, v244, v245
    v_cvt_pk_bf16_f32 v33, -v245, v244
    v_pk_mul_f32 v[250:251], v[244:245], v[246:247] op_sel_hi:[1,0]
    v_pk_fma_f32 v[244:245], v[244:245], v[246:247], v[250:251] op_sel:[1,1,0] op_sel_hi:[0,1,1] neg_lo:[0,1,0]
    v_cvt_pk_bf16_f32 v18, v244, v245
    v_cvt_pk_bf16_f32 v34, -v245, v244
    v_pk_mul_f32 v[250:251], v[244:245], v[246:247] op_sel_hi:[1,0]
    v_pk_fma_f32 v[244:245], v[244:245], v[246:247], v[250:251] op_sel:[1,1,0] op_sel_hi:[0,1,1] neg_lo:[0,1,0]
    v_cvt_pk_bf16_f32 v19, v244, v245
    v_cvt_pk_bf16_f32 v35, -v245, v244
    v_pk_mul_f32 v[250:251], v[12:13], v[248:249] op_sel_hi:[1,0]
    v_pk_fma_f32 v[12:13], v[12:13], v[248:249], v[250:251] op_sel:[1,1,0] op_sel_hi:[0,1,1] neg_lo:[0,1,0]
    v_mov_b32 v244, v12
    v_mov_b32 v245, v13
    v_cvt_pk_bf16_f32 v20, v244, v245
    v_cvt_pk_bf16_f32 v36, -v245, v244
    v_pk_mul_f32 v[250:251], v[244:245], v[246:247] op_sel_hi:[1,0]
    v_pk_fma_f32 v[244:245], v[244:245], v[246:247], v[250:251] op_sel:[1,1,0] op_sel_hi:[0,1,1] neg_lo:[0,1,0]
    v_cvt_pk_bf16_f32 v21, v244, v245
    v_cvt_pk_bf16_f32 v37, -v245, v244
    v_pk_mul_f32 v[250:251], v[244:245], v[246:247] op_sel_hi:[1,0]
    v_pk_fma_f32 v[244:245], v[244:245], v[246:247], v[250:251] op_sel:[1,1,0] op_sel_hi:[0,1,1] neg_lo:[0,1,0]
    v_cvt_pk_bf16_f32 v22, v244, v245
    v_cvt_pk_bf16_f32 v38, -v245, v244
    v_pk_mul_f32 v[250:251], v[244:245], v[246:247] op_sel_hi:[1,0]
    v_pk_fma_f32 v[244:245], v[244:245], v[246:247], v[250:251] op_sel:[1,1,0] op_sel_hi:[0,1,1] neg_lo:[0,1,0]
    v_cvt_pk_bf16_f32 v23, v244, v245
    v_cvt_pk_bf16_f32 v39, -v245, v244
    v_pk_mul_f32 v[250:251], v[12:13], v[248:249] op_sel_hi:[1,0]
    v_pk_fma_f32 v[12:13], v[12:13], v[248:249], v[250:251] op_sel:[1,1,0] op_sel_hi:[0,1,1] neg_lo:[0,1,0]
    v_mov_b32 v244, v12
    v_mov_b32 v245, v13
    v_cvt_pk_bf16_f32 v24, v244, v245
    v_cvt_pk_bf16_f32 v40, -v245, v244
    v_pk_mul_f32 v[250:251], v[244:245], v[246:247] op_sel_hi:[1,0]
    v_pk_fma_f32 v[244:245], v[244:245], v[246:247], v[250:251] op_sel:[1,1,0] op_sel_hi:[0,1,1] neg_lo:[0,1,0]
    v_cvt_pk_bf16_f32 v25, v244, v245
    v_cvt_pk_bf16_f32 v41, -v245, v244
    v_pk_mul_f32 v[250:251], v[244:245], v[246:247] op_sel_hi:[1,0]
    v_pk_fma_f32 v[244:245], v[244:245], v[246:247], v[250:251] op_sel:[1,1,0] op_sel_hi:[0,1,1] neg_lo:[0,1,0]
    v_cvt_pk_bf16_f32 v26, v244, v245
    v_cvt_pk_bf16_f32 v42, -v245, v244
    v_pk_mul_f32 v[250:251], v[244:245], v[246:247] op_sel_hi:[1,0]
    v_pk_fma_f32 v[244:245], v[244:245], v[246:247], v[250:251] op_sel:[1,1,0] op_sel_hi:[0,1,1] neg_lo:[0,1,0]
    v_cvt_pk_bf16_f32 v27, v244, v245
    v_cvt_pk_bf16_f32 v43, -v245, v244
    v_pk_mul_f32 v[250:251], v[12:13], v[248:249] op_sel_hi:[1,0]
    v_pk_fma_f32 v[12:13], v[12:13], v[248:249], v[250:251] op_sel:[1,1,0] op_sel_hi:[0,1,1] neg_lo:[0,1,0]
    v_mov_b32 v244, v12
    v_mov_b32 v245, v13
    v_cvt_pk_bf16_f32 v28, v244, v245
    v_cvt_pk_bf16_f32 v44, -v245, v244
    v_pk_mul_f32 v[250:251], v[244:245], v[246:247] op_sel_hi:[1,0]
    v_pk_fma_f32 v[244:245], v[244:245], v[246:247], v[250:251] op_sel:[1,1,0] op_sel_hi:[0,1,1] neg_lo:[0,1,0]
    v_cvt_pk_bf16_f32 v29, v244, v245
    v_cvt_pk_bf16_f32 v45, -v245, v244
    v_pk_mul_f32 v[250:251], v[244:245], v[246:247] op_sel_hi:[1,0]
    v_pk_fma_f32 v[244:245], v[244:245], v[246:247], v[250:251] op_sel:[1,1,0] op_sel_hi:[0,1,1] neg_lo:[0,1,0]
    v_cvt_pk_bf16_f32 v30, v244, v245
    v_cvt_pk_bf16_f32 v46, -v245, v244
    v_pk_mul_f32 v[250:251], v[244:245], v[246:247] op_sel_hi:[1,0]
    v_pk_fma_f32 v[244:245], v[244:245], v[246:247], v[250:251] op_sel:[1,1,0] op_sel_hi:[0,1,1] neg_lo:[0,1,0]
    v_cvt_pk_bf16_f32 v31, v244, v245
    v_cvt_pk_bf16_f32 v47, -v245, v244
    v_mul_f32 v8, 0x3d000000, v14
    v_mul_f32 v9, v8, v7
    v_fract_f32 v250, v9
    v_cos_f32 v244, v250
    v_sin_f32 v245, v250
    v_fract_f32 v250, v8
    v_cos_f32 v246, v250
    v_sin_f32 v247, v250
    v_mov_b32 v64, v244
    v_mov_b32 v65, v245
    v_pk_mul_f32 v[250:251], v[64:65], v[246:247] op_sel_hi:[1,0]
    v_pk_fma_f32 v[66:67], v[64:65], v[246:247], v[250:251] op_sel:[1,1,0] op_sel_hi:[0,1,1] neg_lo:[0,1,0]
    v_pk_mul_f32 v[250:251], v[66:67], v[246:247] op_sel_hi:[1,0]
    v_pk_fma_f32 v[68:69], v[66:67], v[246:247], v[250:251] op_sel:[1,1,0] op_sel_hi:[0,1,1] neg_lo:[0,1,0]
    v_pk_mul_f32 v[250:251], v[68:69], v[246:247] op_sel_hi:[1,0]
    v_pk_fma_f32 v[70:71], v[68:69], v[246:247], v[250:251] op_sel:[1,1,0] op_sel_hi:[0,1,1] neg_lo:[0,1,0]
    v_cvt_pk_bf16_f32 v48, v64, v66
    v_cvt_pk_bf16_f32 v49, v68, v70
    v_cvt_pk_bf16_f32 v50, v65, v67
    v_cvt_pk_bf16_f32 v51, v69, v71
    v_and_b32 v10, 1, v1
    v_mul_u32_u24 v10, 0x8000, v10
    v_lshl_or_b32 v10, v10, 16, v10
    v_xor_b32 v52, v10, v48
    v_xor_b32 v56, 0x80000000, v48
    v_xor_b32 v60, 0x80000000, v52
    v_xor_b32 v53, v10, v49
    v_xor_b32 v57, 0x80000000, v49
    v_xor_b32 v61, 0x80000000, v53
    v_xor_b32 v54, v10, v50
    v_xor_b32 v58, 0x80000000, v50
    v_xor_b32 v62, 0x80000000, v54
    v_xor_b32 v55, v10, v51
    v_xor_b32 v59, 0x80000000, v51
    v_xor_b32 v63, 0x80000000, v55
    v_mul_f32 v8, 0x3a000000, v6
    v_mul_f32 v9, v8, v7
    v_add_f32 v12, v8, v8
    v_mul_f32 v13, 0x41800000, v8
    v_fract_f32 v250, v12
    v_cos_f32 v246, v250
    v_sin_f32 v247, v250
    v_fract_f32 v250, v13
    v_cos_f32 v248, v250
    v_sin_f32 v249, v250
    v_fract_f32 v250, v9
    v_add_f32 v251, v9, v8
    v_cos_f32 v64, v250
    v_fract_f32 v251, v251
    v_sin_f32 v72, v250
    v_cos_f32 v65, v251
    v_sin_f32 v73, v251
    v_pk_mul_f32 v[250:251], v[64:65], v[246:247] op_sel_hi:[1,0]
    v_pk_mul_f32 v[10:11], v[72:73], v[246:247] op_sel_hi:[1,0]
    v_pk_fma_f32 v[66:67], v[72:73], v[246:247], v[250:251] op_sel:[0,1,0] op_sel_hi:[1,1,1] neg_lo:[0,1,0] neg_hi:[0,1,0]
    v_pk_fma_f32 v[74:75], v[64:65], v[246:247], v[10:11] op_sel:[0,1,0] op_sel_hi:[1,1,1]
    v_pk_mul_f32 v[250:251], v[64:65], v[248:249] op_sel_hi:[1,0]
    v_pk_mul_f32 v[10:11], v[72:73], v[248:249] op_sel_hi:[1,0]
    v_pk_fma_f32 v[68:69], v[72:73], v[248:249], v[250:251] op_sel:[0,1,0] op_sel_hi:[1,1,1] neg_lo:[0,1,0] neg_hi:[0,1,0]
    v_pk_fma_f32 v[76:77], v[64:65], v[248:249], v[10:11] op_sel:[0,1,0] op_sel_hi:[1,1,1]
    v_pk_mul_f32 v[250:251], v[66:67], v[248:249] op_sel_hi:[1,0]
    v_pk_mul_f32 v[10:11], v[74:75], v[248:249] op_sel_hi:[1,0]
    v_pk_fma_f32 v[70:71], v[74:75], v[248:249], v[250:251] op_sel:[0,1,0] op_sel_hi:[1,1,1] neg_lo:[0,1,0] neg_hi:[0,1,0]
    v_pk_fma_f32 v[78:79], v[66:67], v[248:249], v[10:11] op_sel:[0,1,0] op_sel_hi:[1,1,1]
    v_mov_b32 v12, s53
    v_cvt_f32_u32 v12, v12
    v_add_f32 v7, v7, v12
    v_add_f32 v8, 0x00000000, v14
    v_mul_f32 v8, 0x3a000000, v8
    v_mul_f32 v9, v8, v7
    v_add_f32 v12, v8, v8
    v_fract_f32 v250, v12
    v_cos_f32 v246, v250
    v_sin_f32 v247, v250
    v_fract_f32 v250, v9
    v_add_f32 v251, v9, v8
    v_cos_f32 v80, v250
    v_fract_f32 v251, v251
    v_sin_f32 v88, v250
    v_cos_f32 v81, v251
    v_sin_f32 v89, v251
    v_mul_f32 v80, 0x3a000000, v80
    v_mul_f32 v81, 0x3a000000, v81
    v_mul_f32 v88, 0x3a000000, v88
    v_mul_f32 v89, 0x3a000000, v89
    v_pk_mul_f32 v[250:251], v[80:81], v[246:247] op_sel_hi:[1,0]
    v_pk_mul_f32 v[10:11], v[88:89], v[246:247] op_sel_hi:[1,0]
    v_pk_fma_f32 v[82:83], v[88:89], v[246:247], v[250:251] op_sel:[0,1,0] op_sel_hi:[1,1,1] neg_lo:[0,1,0] neg_hi:[0,1,0]
    v_pk_fma_f32 v[90:91], v[80:81], v[246:247], v[10:11] op_sel:[0,1,0] op_sel_hi:[1,1,1]
    v_add_f32 v8, 0x41800000, v14
    v_mul_f32 v8, 0x3a000000, v8
    v_mul_f32 v9, v8, v7
    v_add_f32 v12, v8, v8
    v_fract_f32 v250, v12
    v_cos_f32 v246, v250
    v_sin_f32 v247, v250
    v_fract_f32 v250, v9
    v_add_f32 v251, v9, v8
    v_cos_f32 v84, v250
    v_fract_f32 v251, v251
    v_sin_f32 v92, v250
    v_cos_f32 v85, v251
    v_sin_f32 v93, v251
    v_mul_f32 v84, 0x3a000000, v84
    v_mul_f32 v85, 0x3a000000, v85
    v_mul_f32 v92, 0x3a000000, v92
    v_mul_f32 v93, 0x3a000000, v93
    v_pk_mul_f32 v[250:251], v[84:85], v[246:247] op_sel_hi:[1,0]
    v_pk_mul_f32 v[10:11], v[92:93], v[246:247] op_sel_hi:[1,0]
    v_pk_fma_f32 v[86:87], v[92:93], v[246:247], v[250:251] op_sel:[0,1,0] op_sel_hi:[1,1,1] neg_lo:[0,1,0] neg_hi:[0,1,0]
    v_pk_fma_f32 v[94:95], v[84:85], v[246:247], v[10:11] op_sel:[0,1,0] op_sel_hi:[1,1,1]
L_m_PC22:
    s_lshr_b32 s50, s3, 2
    s_and_b32 s51, s3, 3
    s_lshl_b32 s53, s2, 1
    s_add_u32 s53, s53, s50
    s_lshl_b32 s53, s53, 13
    s_lshl_b32 s54, s51, 11
    s_add_u32 s53, s53, s54
    s_add_u32 s52, s53, 28311552
    s_lshl_b32 s54, s2, 14
    s_lshl_b32 s55, s50, 13
    s_add_u32 s54, s54, s55
    s_lshl_b32 s55, s51, 7
    s_add_u32 s54, s54, s55
    s_add_u32 s57, s54, s41
    s_add_u32 s58, s54, s42
    s_lshl_b32 s55, s3, 10
    s_add_u32 s59, s55, s43
    s_lshl_b32 s55, s2, 14
    s_lshl_b32 s56, s3, 11
    s_add_u32 s55, s55, s56
    s_add_u32 s62, s55, s41
    s_lshl_b32 s55, s51, 2
    v_add_u32 v8, s55, v5
    v_xor_b32 v8, v8, v4
    v_lshlrev_b32 v9, 8, v4
    v_lshl_add_u32 v180, v8, 4, v9
    v_add_u32 v8, 0, v5
    v_xor_b32 v8, v8, v4
    v_lshl_add_u32 v181, v8, 4, v9
    v_add_u32 v8, 4, v5
    v_xor_b32 v8, v8, v4
    v_lshl_add_u32 v182, v8, 4, v9
    v_add_u32 v8, 8, v5
    v_xor_b32 v8, v8, v4
    v_lshl_add_u32 v183, v8, 4, v9
    v_add_u32 v8, 12, v5
    v_xor_b32 v8, v8, v4
    v_lshl_add_u32 v184, v8, 4, v9
    s_lshl_b32 s55, s50, 12
    s_lshl_b32 s56, s50, 13
    s_add_u32 s60, s56, 16384
    v_add_u32 v186, s60, v180
    s_lshl_b32 s60, s3, 2
    v_add_u32 v8, s60, v3
    v_bfe_u32 v9, v1, 1, 4
    v_and_b32 v10, 1, v1
    v_and_b32 v11, 15, v8
    v_xor_b32 v11, v11, v9
    v_lshlrev_b32 v11, 4, v11
    v_lshl_add_u32 v11, v8, 8, v11
    v_lshl_add_u32 v185, v10, 3, v11
    v_add_u32 v8, 2, v8
    v_and_b32 v11, 15, v8
    v_xor_b32 v11, v11, v9
    v_lshlrev_b32 v11, 4, v11
    v_lshl_add_u32 v11, v8, 8, v11
    v_lshl_add_u32 v180, v10, 3, v11
    v_add_u32 v187, s55, v181
    v_add_u32 v181, s56, v181
    v_add_u32 v188, s55, v182
    v_add_u32 v182, s56, v182
    v_add_u32 v189, s55, v183
    v_add_u32 v183, s56, v183
    v_add_u32 v190, s55, v184
    v_add_u32 v184, s56, v184
    v_lshlrev_b32 v191, 11, v5
    v_lshl_add_u32 v191, v4, 3, v191
    s_cmp_eq_u32 s93, 0
    s_cbranch_scc0 L_m_WS23
    s_cmp_eq_u32 s3, 0
    s_cbranch_scc0 L_m_W24_skip
    s_add_u32 s91, s40, 1
    s_add_u32 s87, s40, 1
    v_lshlrev_b32 v12, 7, v1
    s_mov_b32 s90, 31457280
    s_mov_b32 s89, 0x40000
    v_add_u32 v13, 8192, v12
    v_add_u32 v14, 16384, v12
    v_add_u32 v15, 24576, v12
L_m_W24_loop:
    buffer_load_dword v232, v12, s[4:7], s90 offen sc1
    buffer_load_dword v233, v13, s[4:7], s90 offen sc1
    buffer_load_dword v234, v14, s[4:7], s90 offen sc1
    buffer_load_dword v235, v15, s[4:7], s90 offen sc1
    s_waitcnt vmcnt(0)
    v_subrev_u32 v8, s91, v232
    v_subrev_u32 v9, s91, v233
    v_max_u32 v8, v8, v9
    v_subrev_u32 v9, s87, v234
    v_max_u32 v8, v8, v9
    v_subrev_u32 v9, s87, v235
    v_max_u32 v8, v8, v9
    v_cmp_gt_u32 vcc, 16, v8
    s_cmp_eq_u64 vcc, exec
    s_nop 2
    s_cbranch_scc1 L_m_W24_skip
    s_sleep 1
    s_sub_u32 s89, s89, 1
    s_cmp_lg_u32 s89, 0
    s_cbranch_scc1 L_m_W24_loop
L_m_W24_skip:
    s_barrier
L_m_WS23:
    s_cmp_eq_u32 s2, 0
    s_cselect_b32 s60, 0, 1.0
    v_lshlrev_b32 v6, 4, v1
    v_lshlrev_b32 v7, 3, v1
    buffer_load_dwordx4 v[152:155], v6, s[4:7], s52 offen sc1
    buffer_load_dwordx4 v[156:159], v6, s[4:7], s52 offen offset:1024 sc1
    s_mov_b32 s89, 0x40000
L_m_VL25:
    buffer_load_dwordx4 v[144:147], v6, s[4:7], s62 offen sc1
    buffer_load_dwordx4 v[148:151], v6, s[4:7], s62 offen offset:1024 sc1
    s_mov_b32 s63, s59
    buffer_load_dwordx2 v[160:161], v7, s[4:7], s63 offen sc1
    buffer_load_dwordx2 v[162:163], v7, s[4:7], s63 offen offset:512 sc1
    s_add_u32 s63, s63, 8192
    buffer_load_dwordx2 v[164:165], v7, s[4:7], s63 offen sc1
    buffer_load_dwordx2 v[166:167], v7, s[4:7], s63 offen offset:512 sc1
    s_add_u32 s63, s63, 8192
    buffer_load_dwordx2 v[168:169], v7, s[4:7], s63 offen sc1
    buffer_load_dwordx2 v[170:171], v7, s[4:7], s63 offen offset:512 sc1
    s_add_u32 s63, s63, 8192
    buffer_load_dwordx2 v[172:173], v7, s[4:7], s63 offen sc1
    buffer_load_dwordx2 v[174:175], v7, s[4:7], s63 offen offset:512 sc1
    s_waitcnt vmcnt(0)
    v_max3_u32 v8, v144, v145, v146
    v_max3_u32 v9, v147, v148, v149
    v_max3_u32 v8, v8, v150, v151
    v_max3_u32 v9, v9, v160, v161
    v_max3_u32 v8, v8, v162, v163
    v_max3_u32 v9, v9, v164, v165
    v_max3_u32 v8, v8, v166, v167
    v_max3_u32 v9, v9, v168, v169
    v_max3_u32 v8, v8, v170, v171
    v_max3_u32 v9, v9, v172, v173
    v_max3_u32 v8, v8, v174, v175
    v_max_u32 v8, v8, v9
    v_cmp_eq_u32 vcc, -1, v8
    s_nop 3
    s_cbranch_vccz L_m_VL25_ok
    s_sleep 1
    s_sub_u32 s89, s89, 1
    s_cmp_lg_u32 s89, 0
    s_cbranch_scc1 L_m_VL25
L_m_VL25_ok:
    s_mov_b32 s61, 0x3b000000
    v_mov_b32 v6, 0x3727c5ac
    s_min_u32 s78, s66, 85
    s_lshl_b32 s78, s78, 15
    s_add_u32 s78, s78, 20971520
    s_lshl_b32 s79, s3, 12
    s_mul_i32 s80, s3, 16384
    s_add_u32 s80, s80, 32768
    v_lshlrev_b32 v15, 4, v1
    v_add_f32 v160, v160, v164
    v_add_f32 v168, v168, v172
    v_add_f32 v161, v161, v165
    v_add_f32 v169, v169, v173
    v_add_f32 v162, v162, v166
    v_add_f32 v170, v170, v174
    v_add_f32 v163, v163, v167
    v_add_f32 v171, v171, v175
    v_add_f32 v160, v160, v168
    v_add_f32 v161, v161, v169
    v_add_f32 v162, v162, v170
    v_add_f32 v163, v163, v171
    v_fma_f32 v160, v160, s61, v6
    v_fma_f32 v161, v161, s61, v6
    v_fma_f32 v162, v162, s61, v6
    v_fma_f32 v163, v163, s61, v6
    v_rsq_f32 v176, v160
    v_rsq_f32 v177, v161
    v_rsq_f32 v178, v162
    v_rsq_f32 v179, v163
    v_lshlrev_b32 v6, 16, v144
    v_and_b32 v7, 0xffff0000, v144
    v_lshlrev_b32 v8, 16, v145
    v_and_b32 v9, 0xffff0000, v145
    v_mul_f32 v7, s60, v7
    v_mul_f32 v6, v6, v176
    v_mul_f32 v7, v7, v176
    v_mul_f32 v8, v8, v176
    v_mul_f32 v9, v9, v176
    v_cvt_pk_bf16_f32 v128, v6, v7
    v_cvt_pk_bf16_f32 v132, v8, v9
    s_cmp_eq_u32 s93, 0
    s_cbranch_scc1 L_m_LS26
    s_xor_b32 s81, s79, 0
    s_add_u32 s81, s81, s78
    s_add_u32 m0, s80, 0
    buffer_load_dwordx4 v15, s[4:7], s81 offen offset:0 sc1 lds
L_m_LS26:
    v_lshlrev_b32 v6, 16, v146
    v_and_b32 v7, 0xffff0000, v146
    v_lshlrev_b32 v8, 16, v147
    v_and_b32 v9, 0xffff0000, v147
    v_mul_f32 v7, s60, v7
    v_mul_f32 v6, v6, v177
    v_mul_f32 v7, v7, v177
    v_mul_f32 v8, v8, v177
    v_mul_f32 v9, v9, v177
    v_cvt_pk_bf16_f32 v129, v6, v7
    v_cvt_pk_bf16_f32 v133, v8, v9
    s_cmp_eq_u32 s93, 0
    s_cbranch_scc1 L_m_LS27
    s_xor_b32 s81, s79, 0
    s_add_u32 s81, s81, s78
    s_add_u32 m0, s80, 0
    buffer_load_dwordx4 v15, s[4:7], s81 offen offset:1024 sc1 lds
L_m_LS27:
    v_lshlrev_b32 v6, 16, v148
    v_and_b32 v7, 0xffff0000, v148
    v_lshlrev_b32 v8, 16, v149
    v_and_b32 v9, 0xffff0000, v149
    v_mul_f32 v7, s60, v7
    v_mul_f32 v6, v6, v178
    v_mul_f32 v7, v7, v178
    v_mul_f32 v8, v8, v178
    v_mul_f32 v9, v9, v178
    v_cvt_pk_bf16_f32 v130, v6, v7
    v_cvt_pk_bf16_f32 v134, v8, v9
    s_cmp_eq_u32 s93, 0
    s_cbranch_scc1 L_m_LS28
    s_xor_b32 s81, s79, 0
    s_add_u32 s81, s81, s78
    s_add_u32 m0, s80, 0
    buffer_load_dwordx4 v15, s[4:7], s81 offen offset:2048 sc1 lds
L_m_LS28:
    v_lshlrev_b32 v6, 16, v150
    v_and_b32 v7, 0xffff0000, v150
    v_lshlrev_b32 v8, 16, v151
    v_and_b32 v9, 0xffff0000, v151
    v_mul_f32 v7, s60, v7
    v_mul_f32 v6, v6, v179
    v_mul_f32 v7, v7, v179
    v_mul_f32 v8, v8, v179
    v_mul_f32 v9, v9, v179
    v_cvt_pk_bf16_f32 v131, v6, v7
    v_cvt_pk_bf16_f32 v135, v8, v9
    s_cmp_eq_u32 s93, 0
    s_cbranch_scc1 L_m_LS29
    s_xor_b32 s81, s79, 0
    s_add_u32 s81, s81, s78
    s_add_u32 m0, s80, 0
    buffer_load_dwordx4 v15, s[4:7], s81 offen offset:3072 sc1 lds
L_m_LS29:
    ds_write_b64 v185, v[128:129] offset:0
    ds_write_b64 v180, v[130:131] offset:0
    s_cmp_eq_u32 s93, 0
    s_cbranch_scc1 L_m_LS30
    s_xor_b32 s81, s79, 4096
    s_add_u32 s81, s81, s78
    s_add_u32 m0, s80, 4096
    buffer_load_dwordx4 v15, s[4:7], s81 offen offset:0 sc1 lds
L_m_LS30:
    ds_write_b64 v185, v[132:133] offset:8192
    ds_write_b64 v180, v[134:135] offset:8192
    s_cmp_eq_u32 s93, 0
    s_cbranch_scc1 L_m_LS31
    s_xor_b32 s81, s79, 4096
    s_add_u32 s81, s81, s78
    s_add_u32 m0, s80, 4096
    buffer_load_dwordx4 v15, s[4:7], s81 offen offset:1024 sc1 lds
L_m_LS31:
    s_waitcnt lgkmcnt(0)
    s_barrier
    buffer_load_dwordx2 v[236:237], v191, s[4:7], s57 offen offset:0 sc1
    buffer_load_dwordx2 v[238:239], v191, s[4:7], s57 offen offset:512 sc1
    buffer_load_dwordx2 v[240:241], v191, s[4:7], s57 offen offset:1024 sc1
    buffer_load_dwordx2 v[242:243], v191, s[4:7], s57 offen offset:1536 sc1
    ds_read_b128 v[96:99], v181 offset:0
    ds_read_b128 v[100:103], v182 offset:0
    ds_read_b128 v[104:107], v183 offset:0
    ds_read_b128 v[108:111], v184 offset:0
    ds_read_b128 v[112:115], v181 offset:4096
    ds_read_b128 v[116:119], v182 offset:4096
    ds_read_b128 v[120:123], v183 offset:4096
    ds_read_b128 v[124:127], v184 offset:4096
    s_waitcnt lgkmcnt(7)
    v_mfma_f32_16x16x32_bf16 v[192:195], v[96:99], v[16:19], 0
    v_mfma_f32_16x16x32_bf16 v[200:203], v[96:99], v[32:35], 0
    s_cmp_eq_u32 s93, 0
    s_cbranch_scc1 L_m_LS32
    s_xor_b32 s81, s79, 4096
    s_add_u32 s81, s81, s78
    s_add_u32 m0, s80, 4096
    buffer_load_dwordx4 v15, s[4:7], s81 offen offset:2048 sc1 lds
L_m_LS32:
    s_waitcnt lgkmcnt(6)
    v_mfma_f32_16x16x32_bf16 v[192:195], v[100:103], v[20:23], v[192:195]
    v_mfma_f32_16x16x32_bf16 v[200:203], v[100:103], v[36:39], v[200:203]
    s_cmp_eq_u32 s93, 0
    s_cbranch_scc1 L_m_LS33
    s_xor_b32 s81, s79, 4096
    s_add_u32 s81, s81, s78
    s_add_u32 m0, s80, 4096
    buffer_load_dwordx4 v15, s[4:7], s81 offen offset:3072 sc1 lds
L_m_LS33:
    s_waitcnt lgkmcnt(5)
    v_mfma_f32_16x16x32_bf16 v[192:195], v[104:107], v[24:27], v[192:195]
    v_mfma_f32_16x16x32_bf16 v[200:203], v[104:107], v[40:43], v[200:203]
    s_cmp_eq_u32 s93, 0
    s_cbranch_scc1 L_m_LS34
    s_xor_b32 s81, s79, 8192
    s_add_u32 s81, s81, s78
    s_add_u32 m0, s80, 8192
    buffer_load_dwordx4 v15, s[4:7], s81 offen offset:0 sc1 lds
L_m_LS34:
    s_waitcnt lgkmcnt(4)
    v_mfma_f32_16x16x32_bf16 v[192:195], v[108:111], v[28:31], v[192:195]
    v_mfma_f32_16x16x32_bf16 v[200:203], v[108:111], v[44:47], v[200:203]
    s_cmp_eq_u32 s93, 0
    s_cbranch_scc1 L_m_LS35
    s_xor_b32 s81, s79, 8192
    s_add_u32 s81, s81, s78
    s_add_u32 m0, s80, 8192
    buffer_load_dwordx4 v15, s[4:7], s81 offen offset:1024 sc1 lds
L_m_LS35:
    s_waitcnt lgkmcnt(0)
    v_mfma_f32_16x16x32_bf16 v[196:199], v[112:115], v[16:19], 0
    v_lshlrev_b32 v160, 16, v152
    v_and_b32 v168, 0xffff0000, v152
    v_mfma_f32_16x16x32_bf16 v[204:207], v[112:115], v[32:35], 0
    v_lshlrev_b32 v161, 16, v153
    v_and_b32 v169, 0xffff0000, v153
    v_lshlrev_b32 v162, 16, v154
    v_mfma_f32_16x16x32_bf16 v[196:199], v[116:119], v[20:23], v[196:199]
    v_and_b32 v170, 0xffff0000, v154
    v_lshlrev_b32 v163, 16, v155
    v_and_b32 v171, 0xffff0000, v155
    v_mfma_f32_16x16x32_bf16 v[204:207], v[116:119], v[36:39], v[204:207]
    v_pk_mul_f32 v[136:137], v[192:193], v[64:65]
    v_pk_mul_f32 v[140:141], v[200:201], v[64:65]
    v_pk_mul_f32 v[138:139], v[194:195], v[66:67]
    v_mfma_f32_16x16x32_bf16 v[196:199], v[120:123], v[24:27], v[196:199]
    v_pk_mul_f32 v[142:143], v[202:203], v[66:67]
    v_pk_fma_f32 v[136:137], v[200:201], v[72:73], v[136:137]
    v_mfma_f32_16x16x32_bf16 v[204:207], v[120:123], v[40:43], v[204:207]
    v_pk_fma_f32 v[140:141], v[192:193], v[72:73], v[140:141] neg_lo:[1,0,0] neg_hi:[1,0,0]
    v_pk_fma_f32 v[138:139], v[202:203], v[74:75], v[138:139]
    v_pk_fma_f32 v[142:143], v[194:195], v[74:75], v[142:143] neg_lo:[1,0,0] neg_hi:[1,0,0]
    v_mfma_f32_16x16x32_bf16 v[196:199], v[124:127], v[28:31], v[196:199]
    v_cvt_pk_bf16_f32 v224, v136, v137
    v_cvt_pk_bf16_f32 v225, v138, v139
    v_cvt_pk_bf16_f32 v226, v140, v141
    v_mfma_f32_16x16x32_bf16 v[204:207], v[124:127], v[44:47], v[204:207]
    v_cvt_pk_bf16_f32 v227, v142, v143
    v_cvt_pk_bf16_f32 v228, -v136, -v137
    v_cvt_pk_bf16_f32 v229, -v138, -v139
    v_mfma_f32_16x16x32_bf16 v[208:211], v[48:51], v[224:227], 0
    v_lshlrev_b32 v164, 16, v156
    v_and_b32 v172, 0xffff0000, v156
    v_lshlrev_b32 v165, 16, v157
    v_and_b32 v173, 0xffff0000, v157
    v_lshlrev_b32 v166, 16, v158
    v_mfma_f32_16x16x32_bf16 v[216:219], v[48:51], v[226:229], 0
    v_and_b32 v174, 0xffff0000, v158
    v_lshlrev_b32 v167, 16, v159
    v_and_b32 v175, 0xffff0000, v159
    v_pk_mul_f32 v[136:137], v[196:197], v[68:69]
    v_pk_mul_f32 v[140:141], v[204:205], v[68:69]
    v_pk_mul_f32 v[138:139], v[198:199], v[70:71]
    v_mfma_f32_16x16x32_bf16 v[212:215], v[56:59], v[224:227], 0
    v_pk_mul_f32 v[142:143], v[206:207], v[70:71]
    v_pk_fma_f32 v[136:137], v[204:205], v[76:77], v[136:137]
    v_pk_fma_f32 v[140:141], v[196:197], v[76:77], v[140:141] neg_lo:[1,0,0] neg_hi:[1,0,0]
    v_pk_fma_f32 v[138:139], v[206:207], v[78:79], v[138:139]
    v_pk_fma_f32 v[142:143], v[198:199], v[78:79], v[142:143] neg_lo:[1,0,0] neg_hi:[1,0,0]
    v_mfma_f32_16x16x32_bf16 v[220:223], v[56:59], v[226:229], 0
    v_cvt_pk_bf16_f32 v230, v136, v137
    v_cvt_pk_bf16_f32 v231, v138, v139
    v_cvt_pk_bf16_f32 v232, v140, v141
    v_cvt_pk_bf16_f32 v233, v142, v143
    v_cvt_pk_bf16_f32 v234, -v136, -v137
    v_cvt_pk_bf16_f32 v235, -v138, -v139
    s_cmp_eq_u32 s93, 0
    s_cbranch_scc1 L_m_LS36
    s_xor_b32 s81, s79, 8192
    s_add_u32 s81, s81, s78
    s_add_u32 m0, s80, 8192
    buffer_load_dwordx4 v15, s[4:7], s81 offen offset:2048 sc1 lds
L_m_LS36:
    v_mfma_f32_16x16x32_bf16 v[208:211], v[52:55], v[230:233], v[208:211]
    s_nop 0
    v_mfma_f32_16x16x32_bf16 v[216:219], v[52:55], v[232:235], v[216:219]
    v_mfma_f32_16x16x32_bf16 v[212:215], v[60:63], v[230:233], v[212:215]
    v_mfma_f32_16x16x32_bf16 v[220:223], v[60:63], v[232:235], v[220:223]
    s_cmp_eq_u32 s93, 0
    s_cbranch_scc1 L_m_LS37
    s_xor_b32 s81, s79, 8192
    s_add_u32 s81, s81, s78
    s_add_u32 m0, s80, 8192
    buffer_load_dwordx4 v15, s[4:7], s81 offen offset:3072 sc1 lds
L_m_LS37:
    s_nop 3
    v_pk_mul_f32 v[136:137], v[208:209], v[160:161]
    s_nop 0
    v_pk_mul_f32 v[140:141], v[216:217], v[160:161]
    v_pk_mul_f32 v[138:139], v[210:211], v[162:163]
    v_pk_mul_f32 v[142:143], v[218:219], v[162:163]
    v_pk_fma_f32 v[136:137], v[216:217], v[168:169], v[136:137] neg_lo:[1,0,0] neg_hi:[1,0,0]
    v_pk_fma_f32 v[140:141], v[208:209], v[168:169], v[140:141]
    v_pk_fma_f32 v[138:139], v[218:219], v[170:171], v[138:139] neg_lo:[1,0,0] neg_hi:[1,0,0]
    v_pk_fma_f32 v[142:143], v[210:211], v[170:171], v[142:143]
    v_cvt_pk_bf16_f32 v224, v140, v141
    v_cvt_pk_bf16_f32 v225, v142, v143
    v_cvt_pk_bf16_f32 v226, v136, v137
    v_cvt_pk_bf16_f32 v227, v138, v139
    v_cvt_pk_bf16_f32 v228, -v140, -v141
    v_cvt_pk_bf16_f32 v229, -v142, -v143
    s_nop 1
    v_mfma_f32_16x16x32_bf16 v[192:195], v[226:229], v[48:51], 0
    v_pk_mul_f32 v[136:137], v[212:213], v[164:165]
    v_pk_mul_f32 v[140:141], v[220:221], v[164:165]
    v_pk_mul_f32 v[138:139], v[214:215], v[166:167]
    v_mfma_f32_16x16x32_bf16 v[200:203], v[224:227], v[48:51], 0
    v_pk_mul_f32 v[142:143], v[222:223], v[166:167]
    v_pk_fma_f32 v[136:137], v[220:221], v[172:173], v[136:137] neg_lo:[1,0,0] neg_hi:[1,0,0]
    v_pk_fma_f32 v[140:141], v[212:213], v[172:173], v[140:141]
    v_pk_fma_f32 v[138:139], v[222:223], v[174:175], v[138:139] neg_lo:[1,0,0] neg_hi:[1,0,0]
    v_mfma_f32_16x16x32_bf16 v[196:199], v[226:229], v[56:59], 0
    v_pk_fma_f32 v[142:143], v[214:215], v[174:175], v[142:143]
    v_cvt_pk_bf16_f32 v230, v140, v141
    v_cvt_pk_bf16_f32 v231, v142, v143
    v_mfma_f32_16x16x32_bf16 v[204:207], v[224:227], v[56:59], 0
    v_cvt_pk_bf16_f32 v232, v136, v137
    v_cvt_pk_bf16_f32 v233, v138, v139
    v_cvt_pk_bf16_f32 v234, -v140, -v141
    v_cvt_pk_bf16_f32 v235, -v142, -v143
    s_cmp_eq_u32 s93, 0
    s_cbranch_scc1 L_m_LS38
    s_xor_b32 s81, s79, 12288
    s_add_u32 s81, s81, s78
    s_add_u32 m0, s80, 12288
    buffer_load_dwordx4 v15, s[4:7], s81 offen offset:0 sc1 lds
L_m_LS38:
    s_nop 1
    v_mfma_f32_16x16x32_bf16 v[192:195], v[232:235], v[52:55], v[192:195]
    v_mfma_f32_16x16x32_bf16 v[200:203], v[230:233], v[52:55], v[200:203]
    v_mfma_f32_16x16x32_bf16 v[196:199], v[232:235], v[60:63], v[196:199]
    v_mfma_f32_16x16x32_bf16 v[204:207], v[230:233], v[60:63], v[204:207]
    s_cmp_eq_u32 s93, 0
    s_cbranch_scc1 L_m_LS39
    s_xor_b32 s81, s79, 12288
    s_add_u32 s81, s81, s78
    s_add_u32 m0, s80, 12288
    buffer_load_dwordx4 v15, s[4:7], s81 offen offset:1024 sc1 lds
L_m_LS39:
    s_nop 4
    v_pk_mul_f32 v[136:137], v[192:193], v[80:81]
    v_pk_mul_f32 v[140:141], v[200:201], v[80:81]
    v_pk_mul_f32 v[138:139], v[194:195], v[82:83]
    v_pk_mul_f32 v[142:143], v[202:203], v[82:83]
    v_pk_fma_f32 v[136:137], v[200:201], v[88:89], v[136:137] neg_lo:[1,0,0] neg_hi:[1,0,0]
    v_pk_fma_f32 v[140:141], v[192:193], v[88:89], v[140:141]
    v_pk_fma_f32 v[138:139], v[202:203], v[90:91], v[138:139] neg_lo:[1,0,0] neg_hi:[1,0,0]
    v_pk_fma_f32 v[142:143], v[194:195], v[90:91], v[142:143]
    v_cvt_pk_bf16_f32 v128, v136, -v140
    v_cvt_pk_bf16_f32 v129, v137, -v141
    v_cvt_pk_bf16_f32 v130, v138, -v142
    v_cvt_pk_bf16_f32 v131, v139, -v143
    ds_write_b128 v186, v[128:131] offset:0
    s_cmp_eq_u32 s93, 0
    s_cbranch_scc1 L_m_LS40
    s_xor_b32 s81, s79, 12288
    s_add_u32 s81, s81, s78
    s_add_u32 m0, s80, 12288
    buffer_load_dwordx4 v15, s[4:7], s81 offen offset:2048 sc1 lds
L_m_LS40:
    v_pk_mul_f32 v[136:137], v[196:197], v[84:85]
    v_pk_mul_f32 v[140:141], v[204:205], v[84:85]
    v_pk_mul_f32 v[138:139], v[198:199], v[86:87]
    v_pk_mul_f32 v[142:143], v[206:207], v[86:87]
    v_pk_fma_f32 v[136:137], v[204:205], v[92:93], v[136:137] neg_lo:[1,0,0] neg_hi:[1,0,0]
    v_pk_fma_f32 v[140:141], v[196:197], v[92:93], v[140:141]
    v_pk_fma_f32 v[138:139], v[206:207], v[94:95], v[138:139] neg_lo:[1,0,0] neg_hi:[1,0,0]
    v_pk_fma_f32 v[142:143], v[198:199], v[94:95], v[142:143]
    v_cvt_pk_bf16_f32 v132, v136, -v140
    v_cvt_pk_bf16_f32 v133, v137, -v141
    v_cvt_pk_bf16_f32 v134, v138, -v142
    v_cvt_pk_bf16_f32 v135, v139, -v143
    ds_write_b128 v186, v[132:135] offset:4096
    s_cmp_eq_u32 s93, 0
    s_cbranch_scc1 L_m_LS41
    s_xor_b32 s81, s79, 12288
    s_add_u32 s81, s81, s78
    s_add_u32 m0, s80, 12288
    buffer_load_dwordx4 v15, s[4:7], s81 offen offset:3072 sc1 lds
L_m_LS41:
    s_cmp_eq_u32 s93, 0
    s_cbranch_scc0 L_m_LW42
    s_waitcnt vmcnt(0)
L_m_LW42:
    s_waitcnt vmcnt(10)
    v_lshlrev_b32 v160, 16, v236
    v_and_b32 v164, 0xffff0000, v236
    v_lshlrev_b32 v168, 16, v237
    v_and_b32 v172, 0xffff0000, v237
    v_lshlrev_b32 v161, 16, v238
    v_and_b32 v165, 0xffff0000, v238
    v_lshlrev_b32 v169, 16, v239
    v_and_b32 v173, 0xffff0000, v239
    v_lshlrev_b32 v162, 16, v240
    v_and_b32 v166, 0xffff0000, v240
    v_lshlrev_b32 v170, 16, v241
    v_and_b32 v174, 0xffff0000, v241
    v_lshlrev_b32 v163, 16, v242
    v_and_b32 v167, 0xffff0000, v242
    v_lshlrev_b32 v171, 16, v243
    v_and_b32 v175, 0xffff0000, v243
    s_waitcnt lgkmcnt(0)
    s_barrier
    ds_read_b128 v[96:99], v187 offset:16384
    ds_read_b128 v[100:103], v188 offset:16384
    ds_read_b128 v[104:107], v189 offset:16384
    ds_read_b128 v[108:111], v190 offset:16384
    ds_read_b128 v[112:115], v187 offset:24576
    ds_read_b128 v[116:119], v188 offset:24576
    ds_read_b128 v[120:123], v189 offset:24576
    ds_read_b128 v[124:127], v190 offset:24576
    s_waitcnt lgkmcnt(7)
    v_mfma_f32_16x16x32_bf16 v[208:211], v[96:99], v[16:19], 0
    v_mfma_f32_16x16x32_bf16 v[216:219], v[96:99], v[32:35], 0
    s_waitcnt lgkmcnt(6)
    v_mfma_f32_16x16x32_bf16 v[208:211], v[100:103], v[20:23], v[208:211]
    v_mfma_f32_16x16x32_bf16 v[216:219], v[100:103], v[36:39], v[216:219]
    s_waitcnt lgkmcnt(5)
    v_mfma_f32_16x16x32_bf16 v[208:211], v[104:107], v[24:27], v[208:211]
    v_mfma_f32_16x16x32_bf16 v[216:219], v[104:107], v[40:43], v[216:219]
    s_waitcnt lgkmcnt(4)
    v_mfma_f32_16x16x32_bf16 v[208:211], v[108:111], v[28:31], v[208:211]
    v_mfma_f32_16x16x32_bf16 v[216:219], v[108:111], v[44:47], v[216:219]
    s_waitcnt lgkmcnt(0)
    v_mfma_f32_16x16x32_bf16 v[212:215], v[112:115], v[16:19], 0
    v_mfma_f32_16x16x32_bf16 v[220:223], v[112:115], v[32:35], 0
    v_mfma_f32_16x16x32_bf16 v[212:215], v[116:119], v[20:23], v[212:215]
    v_mfma_f32_16x16x32_bf16 v[220:223], v[116:119], v[36:39], v[220:223]
    v_mfma_f32_16x16x32_bf16 v[212:215], v[120:123], v[24:27], v[212:215]
    s_nop 0
    v_pk_add_f32 v[160:161], v[160:161], v[208:209]
    v_pk_add_f32 v[162:163], v[162:163], v[210:211]
    v_mfma_f32_16x16x32_bf16 v[220:223], v[120:123], v[40:43], v[220:223]
    v_fma_f32 v164, -v216, s60, v164
    v_fma_f32 v165, -v217, s60, v165
    v_fma_f32 v166, -v218, s60, v166
    v_mfma_f32_16x16x32_bf16 v[212:215], v[124:127], v[28:31], v[212:215]
    v_fma_f32 v167, -v219, s60, v167
    v_cvt_pk_bf16_f32 v236, v160, v164
    v_mfma_f32_16x16x32_bf16 v[220:223], v[124:127], v[44:47], v[220:223]
    v_cvt_pk_bf16_f32 v238, v161, v165
    v_cvt_pk_bf16_f32 v240, v162, v166
    v_cvt_pk_bf16_f32 v242, v163, v167
    s_nop 1
    v_pk_add_f32 v[168:169], v[168:169], v[212:213]
    v_pk_add_f32 v[170:171], v[170:171], v[214:215]
    s_nop 0
    v_sub_f32 v172, v172, v220
    v_sub_f32 v173, v173, v221
    v_sub_f32 v174, v174, v222
    v_sub_f32 v175, v175, v223
    v_cvt_pk_bf16_f32 v237, v168, v172
    v_cvt_pk_bf16_f32 v239, v169, v173
    v_cvt_pk_bf16_f32 v241, v170, v174
    v_cvt_pk_bf16_f32 v243, v171, v175
    v_min_u32 v236, -2, v236
    v_min_u32 v237, -2, v237
    v_min_u32 v238, -2, v238
    v_min_u32 v239, -2, v239
    v_min_u32 v240, -2, v240
    v_min_u32 v241, -2, v241
    v_min_u32 v242, -2, v242
    v_min_u32 v243, -2, v243
    buffer_store_dwordx2 v[236:237], v191, s[4:7], s58 offen offset:0 sc1
    buffer_store_dwordx2 v[238:239], v191, s[4:7], s58 offen offset:512 sc1
    buffer_store_dwordx2 v[240:241], v191, s[4:7], s58 offen offset:1024 sc1
    buffer_store_dwordx2 v[242:243], v191, s[4:7], s58 offen offset:1536 sc1
    s_waitcnt vmcnt(0)
    s_barrier
    s_cmp_eq_u32 s3, 0
    s_cbranch_scc0 L_m_PUB43
    s_add_u32 s91, s92, 0
    s_lshl_b32 s90, s2, 7
    s_add_u32 s90, s90, 31457280
    v_mov_b32 v8, s91
    v_mov_b32 v9, 0
    s_mov_b64 exec, 1
    buffer_store_dword v8, v9, s[4:7], s90 offen sc0 sc1
    s_mov_b64 exec, -1
L_m_PUB43:
    s_barrier
    s_cmp_eq_u32 s93, 0
    s_nop 0
    s_cbranch_scc1 L_P1L0
    s_mul_i32 s56, s3, 16384
    s_add_u32 s56, s56, 32768
    v_lshl_add_u32 v6, v1, 4, s56
    ds_read_b128 v[16:19], v6 offset:0
    ds_read_b128 v[20:23], v6 offset:1024
    ds_read_b128 v[24:27], v6 offset:2048
    ds_read_b128 v[28:31], v6 offset:3072
    ds_read_b128 v[32:35], v6 offset:4096
    ds_read_b128 v[36:39], v6 offset:5120
    ds_read_b128 v[40:43], v6 offset:6144
    ds_read_b128 v[44:47], v6 offset:7168
    ds_read_b128 v[48:51], v6 offset:8192
    ds_read_b128 v[52:55], v6 offset:9216
    ds_read_b128 v[56:59], v6 offset:10240
    ds_read_b128 v[60:63], v6 offset:11264
    ds_read_b128 v[64:67], v6 offset:12288
    ds_read_b128 v[68:71], v6 offset:13312
    ds_read_b128 v[72:75], v6 offset:14336
    ds_read_b128 v[76:79], v6 offset:15360
    s_waitcnt lgkmcnt(0)
    s_branch L_P1DONE
L_P1L0:
    s_cmp_eq_u32 s3, 0
    s_cbranch_scc0 L_m_W44_skip
    s_add_u32 s91, s40, 3
    v_lshlrev_b32 v12, 7, v1
    s_mov_b32 s90, 31473664
    s_mov_b32 s89, 0x40000
    v_add_u32 v13, 8192, v12
L_m_W44_loop:
    buffer_load_dword v232, v12, s[4:7], s90 offen sc1
    buffer_load_dword v233, v13, s[4:7], s90 offen sc1
    s_waitcnt vmcnt(0)
    v_subrev_u32 v8, s91, v232
    v_subrev_u32 v9, s91, v233
    v_max_u32 v8, v8, v9
    v_cmp_gt_u32 vcc, 16, v8
    s_cmp_eq_u64 vcc, exec
    s_nop 2
    s_cbranch_scc1 L_m_W44_skip
    s_sleep 1
    s_sub_u32 s89, s89, 1
    s_cmp_lg_u32 s89, 0
    s_cbranch_scc1 L_m_W44_loop
L_m_W44_skip:
    s_barrier
    s_min_u32 s53, s66, 85
    s_lshl_b32 s53, s53, 15
    s_add_u32 s73, s53, 20971520
    s_lshl_b32 s55, s3, 12
    v_lshlrev_b32 v6, 4, v1
    s_xor_b32 s54, s55, 0
    s_add_u32 s54, s54, s73
    buffer_load_dwordx4 v[16:19], v6, s[4:7], s54 offen offset:0 sc1
    buffer_load_dwordx4 v[20:23], v6, s[4:7], s54 offen offset:1024 sc1
    buffer_load_dwordx4 v[24:27], v6, s[4:7], s54 offen offset:2048 sc1
    buffer_load_dwordx4 v[28:31], v6, s[4:7], s54 offen offset:3072 sc1
    s_xor_b32 s54, s55, 4096
    s_add_u32 s54, s54, s73
    buffer_load_dwordx4 v[32:35], v6, s[4:7], s54 offen offset:0 sc1
    buffer_load_dwordx4 v[36:39], v6, s[4:7], s54 offen offset:1024 sc1
    buffer_load_dwordx4 v[40:43], v6, s[4:7], s54 offen offset:2048 sc1
    buffer_load_dwordx4 v[44:47], v6, s[4:7], s54 offen offset:3072 sc1
    s_xor_b32 s54, s55, 8192
    s_add_u32 s54, s54, s73
    buffer_load_dwordx4 v[48:51], v6, s[4:7], s54 offen offset:0 sc1
    buffer_load_dwordx4 v[52:55], v6, s[4:7], s54 offen offset:1024 sc1
    buffer_load_dwordx4 v[56:59], v6, s[4:7], s54 offen offset:2048 sc1
    buffer_load_dwordx4 v[60:63], v6, s[4:7], s54 offen offset:3072 sc1
    s_xor_b32 s54, s55, 12288
    s_add_u32 s54, s54, s73
    buffer_load_dwordx4 v[64:67], v6, s[4:7], s54 offen offset:0 sc1
    buffer_load_dwordx4 v[68:71], v6, s[4:7], s54 offen offset:1024 sc1
    buffer_load_dwordx4 v[72:75], v6, s[4:7], s54 offen offset:2048 sc1
    buffer_load_dwordx4 v[76:79], v6, s[4:7], s54 offen offset:3072 sc1
    s_branch L_P1DONE
L_NONCOL1:
    s_min_u32 s53, s66, 85
    s_lshl_b32 s53, s53, 15
    s_add_u32 s73, s53, 20971520
    s_lshl_b32 s55, s3, 12
    v_lshlrev_b32 v6, 4, v1
    s_xor_b32 s54, s55, 0
    s_add_u32 s54, s54, s73
    buffer_load_dwordx4 v[16:19], v6, s[4:7], s54 offen offset:0 sc1
    buffer_load_dwordx4 v[20:23], v6, s[4:7], s54 offen offset:1024 sc1
    buffer_load_dwordx4 v[24:27], v6, s[4:7], s54 offen offset:2048 sc1
    buffer_load_dwordx4 v[28:31], v6, s[4:7], s54 offen offset:3072 sc1
    s_xor_b32 s54, s55, 4096
    s_add_u32 s54, s54, s73
    buffer_load_dwordx4 v[32:35], v6, s[4:7], s54 offen offset:0 sc1
    buffer_load_dwordx4 v[36:39], v6, s[4:7], s54 offen offset:1024 sc1
    buffer_load_dwordx4 v[40:43], v6, s[4:7], s54 offen offset:2048 sc1
    buffer_load_dwordx4 v[44:47], v6, s[4:7], s54 offen offset:3072 sc1
    s_xor_b32 s54, s55, 8192
    s_add_u32 s54, s54, s73
    buffer_load_dwordx4 v[48:51], v6, s[4:7], s54 offen offset:0 sc1
    buffer_load_dwordx4 v[52:55], v6, s[4:7], s54 offen offset:1024 sc1
    buffer_load_dwordx4 v[56:59], v6, s[4:7], s54 offen offset:2048 sc1
    buffer_load_dwordx4 v[60:63], v6, s[4:7], s54 offen offset:3072 sc1
    s_xor_b32 s54, s55, 12288
    s_add_u32 s54, s54, s73
    buffer_load_dwordx4 v[64:67], v6, s[4:7], s54 offen offset:0 sc1
    buffer_load_dwordx4 v[68:71], v6, s[4:7], s54 offen offset:1024 sc1
    buffer_load_dwordx4 v[72:75], v6, s[4:7], s54 offen offset:2048 sc1
    buffer_load_dwordx4 v[76:79], v6, s[4:7], s54 offen offset:3072 sc1
    s_xor_b32 s54, s55, 16384
    s_add_u32 s54, s54, s73
    s_waitcnt vmcnt(15)
    buffer_load_dwordx4 v[80:83], v6, s[4:7], s54 offen offset:0 sc1
    s_waitcnt vmcnt(15)
    buffer_load_dwordx4 v[84:87], v6, s[4:7], s54 offen offset:1024 sc1
    s_waitcnt vmcnt(15)
    buffer_load_dwordx4 v[88:91], v6, s[4:7], s54 offen offset:2048 sc1
    s_waitcnt vmcnt(15)
    buffer_load_dwordx4 v[92:95], v6, s[4:7], s54 offen offset:3072 sc1
    s_xor_b32 s54, s55, 20480
    s_add_u32 s54, s54, s73
    s_waitcnt vmcnt(15)
    buffer_load_dwordx4 v[96:99], v6, s[4:7], s54 offen offset:0 sc1
    s_waitcnt vmcnt(15)
    buffer_load_dwordx4 v[100:103], v6, s[4:7], s54 offen offset:1024 sc1
    s_waitcnt vmcnt(15)
    buffer_load_dwordx4 v[104:107], v6, s[4:7], s54 offen offset:2048 sc1
    s_waitcnt vmcnt(15)
    buffer_load_dwordx4 v[108:111], v6, s[4:7], s54 offen offset:3072 sc1
    s_xor_b32 s54, s55, 24576
    s_add_u32 s54, s54, s73
    s_waitcnt vmcnt(15)
    buffer_load_dwordx4 v[112:115], v6, s[4:7], s54 offen offset:0 sc1
    s_waitcnt vmcnt(15)
    buffer_load_dwordx4 v[116:119], v6, s[4:7], s54 offen offset:1024 sc1
    s_waitcnt vmcnt(15)
    buffer_load_dwordx4 v[120:123], v6, s[4:7], s54 offen offset:2048 sc1
    s_waitcnt vmcnt(15)
    buffer_load_dwordx4 v[124:127], v6, s[4:7], s54 offen offset:3072 sc1
    s_xor_b32 s54, s55, 28672
    s_add_u32 s54, s54, s73
    s_waitcnt vmcnt(15)
    buffer_load_dwordx4 v[128:131], v6, s[4:7], s54 offen offset:0 sc1
    s_waitcnt vmcnt(15)
    buffer_load_dwordx4 v[132:135], v6, s[4:7], s54 offen offset:1024 sc1
    s_waitcnt vmcnt(15)
    buffer_load_dwordx4 v[136:139], v6, s[4:7], s54 offen offset:2048 sc1
    s_waitcnt vmcnt(15)
    buffer_load_dwordx4 v[140:143], v6, s[4:7], s54 offen offset:3072 sc1
L_P1DONE:
    s_cmp_eq_u32 s3, 0
    s_cbranch_scc0 L_m_W45_skip
    s_add_u32 s91, s92, 0
    v_lshlrev_b32 v12, 7, v1
    s_mov_b32 s90, 31457280
    s_mov_b32 s89, 0x40000
    v_add_u32 v13, 8192, v12
L_m_W45_loop:
    buffer_load_dword v232, v12, s[4:7], s90 offen sc1
    buffer_load_dword v233, v13, s[4:7], s90 offen sc1
    s_waitcnt vmcnt(0)
    v_subrev_u32 v8, s91, v232
    v_subrev_u32 v9, s91, v233
    v_max_u32 v8, v8, v9
    v_cmp_gt_u32 vcc, 16, v8
    s_cmp_eq_u64 vcc, exec
    s_nop 2
    s_cbranch_scc1 L_m_W45_skip
    s_sleep 1
    s_sub_u32 s89, s89, 1
    s_cmp_lg_u32 s89, 0
    s_cbranch_scc1 L_m_W45_loop
L_m_W45_skip:
    s_barrier
L_P2GO:
    s_mov_b32 s72, 0
    s_cmp_eq_u32 s76, 1
    s_cbranch_scc0 L_m_P246_act
    s_waitcnt vmcnt(0)
    s_branch L_m_P246_idle
L_m_P246_act:
    s_mov_b32 s55, s67
    v_lshlrev_b32 v6, 14, v5
    v_lshl_add_u32 v6, v4, 4, v6
    s_lshl_b32 s62, s3, 18
    s_lshl_b32 s61, s55, 8
    s_add_u32 s62, s62, s61
    s_add_u32 s62, s62, s42
    s_lshl_b32 s61, s3, 12
    s_add_u32 s61, s61, 0
    s_mov_b32 m0, s61
    s_nop 0
    buffer_load_dwordx4 v6, s[4:7], s62 offen sc1 lds
    s_add_u32 s61, s61, 1024
    s_add_u32 s62, s62, 65536
    s_mov_b32 m0, s61
    s_nop 0
    buffer_load_dwordx4 v6, s[4:7], s62 offen sc1 lds
    s_add_u32 s61, s61, 1024
    s_add_u32 s62, s62, 65536
    s_mov_b32 m0, s61
    s_nop 0
    buffer_load_dwordx4 v6, s[4:7], s62 offen sc1 lds
    s_add_u32 s61, s61, 1024
    s_add_u32 s62, s62, 65536
    s_mov_b32 m0, s61
    s_nop 0
    buffer_load_dwordx4 v6, s[4:7], s62 offen sc1 lds
    s_min_u32 s53, s66, 85
    s_lshl_b32 s53, s53, 15
    s_add_u32 s73, s53, 20971520
    s_lshl_b32 s55, s3, 12
    s_mov_b32 s77, s55
    s_lshl_b32 s82, s3, 18
    s_lshl_b32 s83, s67, 8
    s_add_u32 s82, s82, s83
    s_add_u32 s82, s82, s42
    s_add_u32 s82, s82, 256
    s_lshl_b32 s83, s3, 12
    s_add_u32 s83, s83, 32768
    v_lshlrev_b32 v223, 14, v5
    v_lshl_add_u32 v223, v4, 4, v223
    v_lshlrev_b32 v217, 4, v1
    v_lshlrev_b32 v6, 9, v3
    v_lshl_add_u32 v6, v2, 3, v6
    s_lshl_b32 s55, s3, 12
    s_xor_b32 s54, s55, 0
    v_add_u32 v224, s54, v6
    s_xor_b32 s54, s55, 4096
    v_add_u32 v225, s54, v6
    s_xor_b32 s54, s55, 8192
    v_add_u32 v226, s54, v6
    s_xor_b32 s54, s55, 12288
    v_add_u32 v227, s54, v6
    s_xor_b32 s54, s55, 16384
    v_add_u32 v228, s54, v6
    s_xor_b32 s54, s55, 20480
    v_add_u32 v229, s54, v6
    s_xor_b32 s54, s55, 24576
    v_add_u32 v230, s54, v6
    s_xor_b32 s54, s55, 28672
    v_add_u32 v231, s54, v6
    v_mov_b32 v221, 0xffff
    s_cmp_eq_u32 s3, 0
    s_cselect_b32 s54, 32, 0
    v_cmp_gt_u32 vcc, s54, v1
    s_nop 1
    v_cndmask_b32 v221, -1, v221, vcc
    v_mov_b32 v220, 0xbdd2d3e8
    s_mov_b32 s60, 0x3b000000
    s_lshl_b32 s53, s3, 2
    s_add_u32 s53, s53, 98304
    v_lshl_add_u32 v244, v2, 5, s53
    v_lshlrev_b32 v245, 5, v2
    v_add_u32 v245, 98304, v245
    s_cmp_ge_u32 s66, 86
    s_cselect_b32 s71, 0x40000000, 0
L_m_P246_t0w:
    s_waitcnt vmcnt(0)
L_m_P246_t0d:
    s_barrier
    s_and_b32 s74, s2, 7
    s_lshr_b32 s75, s2, 5
    s_lshl_b32 s75, s75, 3
    s_add_u32 s74, s74, s75
    s_lshl_b32 s74, s74, 8
    s_lshl_b32 s75, s3, 18
    s_add_u32 s74, s74, s75
    s_add_u32 s74, s74, s42
    s_lshl_b32 s75, s3, 12
    s_add_u32 s75, s75, 124928
    v_lshlrev_b32 v222, 14, v5
    v_lshl_add_u32 v222, v4, 4, v222
    s_cmp_lt_u32 s2, 128
    s_cbranch_scc0 L_m_P246_ncpath
L_m_P246_cpath:
    ds_read_b64 v[160:161], v224 offset:0
    ds_read_b64 v[162:163], v224 offset:256
    ds_read_b64 v[164:165], v224 offset:1024
    ds_read_b64 v[166:167], v224 offset:1280
    ds_read_b64 v[168:169], v224 offset:2048
    ds_read_b64 v[170:171], v224 offset:2304
    v_mov_b32 v218, 0
    v_mov_b32 v219, 0
    ds_read_b64 v[172:173], v224 offset:3072
    ds_read_b64 v[174:175], v224 offset:3328
    s_waitcnt lgkmcnt(6)
    v_mfma_f32_32x32x16_bf16 v[192:207], v[16:19], v[160:163], 0
    s_xor_b32 s81, s77, 16384
    s_add_u32 s81, s81, s73
    buffer_load_dwordx4 v[80:83], v217, s[4:7], s81 offen offset:0 sc1
    v_and_b32 v6, v221, v160
    v_dot2c_f32_bf16 v218, v6, v6
    v_dot2c_f32_bf16 v219, v161, v161
    v_dot2c_f32_bf16 v218, v162, v162
    v_dot2c_f32_bf16 v219, v163, v163
    ds_read_b64 v[176:177], v225 offset:0
    ds_read_b64 v[178:179], v225 offset:256
    s_waitcnt lgkmcnt(6)
    v_mfma_f32_32x32x16_bf16 v[192:207], v[20:23], v[164:167], v[192:207]
    s_xor_b32 s81, s77, 16384
    s_add_u32 s81, s81, s73
    buffer_load_dwordx4 v[84:87], v217, s[4:7], s81 offen offset:1024 sc1
    s_add_u32 m0, s83, 0
    s_add_u32 s81, s82, 0
    buffer_load_dwordx4 v223, s[4:7], s81 offen sc1 lds
    v_dot2c_f32_bf16 v218, v164, v164
    v_dot2c_f32_bf16 v219, v165, v165
    v_dot2c_f32_bf16 v218, v166, v166
    v_dot2c_f32_bf16 v219, v167, v167
    ds_read_b64 v[180:181], v225 offset:1024
    ds_read_b64 v[182:183], v225 offset:1280
    s_waitcnt lgkmcnt(6)
    v_mfma_f32_32x32x16_bf16 v[192:207], v[24:27], v[168:171], v[192:207]
    s_xor_b32 s81, s77, 16384
    s_add_u32 s81, s81, s73
    buffer_load_dwordx4 v[88:91], v217, s[4:7], s81 offen offset:2048 sc1
    v_dot2c_f32_bf16 v218, v168, v168
    v_dot2c_f32_bf16 v219, v169, v169
    v_dot2c_f32_bf16 v218, v170, v170
    v_dot2c_f32_bf16 v219, v171, v171
    ds_read_b64 v[160:161], v225 offset:2048
    ds_read_b64 v[162:163], v225 offset:2304
    s_waitcnt lgkmcnt(6)
    v_mfma_f32_32x32x16_bf16 v[192:207], v[28:31], v[172:175], v[192:207]
    s_xor_b32 s81, s77, 16384
    s_add_u32 s81, s81, s73
    buffer_load_dwordx4 v[92:95], v217, s[4:7], s81 offen offset:3072 sc1
    s_add_u32 m0, s83, 1024
    s_add_u32 s81, s82, 65536
    buffer_load_dwordx4 v223, s[4:7], s81 offen sc1 lds
    v_dot2c_f32_bf16 v218, v172, v172
    v_dot2c_f32_bf16 v219, v173, v173
    v_dot2c_f32_bf16 v218, v174, v174
    v_dot2c_f32_bf16 v219, v175, v175
    ds_read_b64 v[164:165], v225 offset:3072
    ds_read_b64 v[166:167], v225 offset:3328
    s_waitcnt lgkmcnt(6)
    v_mfma_f32_32x32x16_bf16 v[192:207], v[32:35], v[176:179], v[192:207]
    s_xor_b32 s81, s77, 20480
    s_add_u32 s81, s81, s73
    buffer_load_dwordx4 v[96:99], v217, s[4:7], s81 offen offset:0 sc1
    ds_read_b64 v[168:169], v226 offset:0
    ds_read_b64 v[170:171], v226 offset:256
    s_waitcnt lgkmcnt(6)
    v_mfma_f32_32x32x16_bf16 v[192:207], v[36:39], v[180:183], v[192:207]
    s_xor_b32 s81, s77, 20480
    s_add_u32 s81, s81, s73
    buffer_load_dwordx4 v[100:103], v217, s[4:7], s81 offen offset:1024 sc1
    s_add_u32 m0, s83, 2048
    s_add_u32 s81, s82, 131072
    buffer_load_dwordx4 v223, s[4:7], s81 offen sc1 lds
    v_add_f32 v6, v218, v219
    v_mov_b32 v8, v6
    s_nop 1
    v_permlane32_swap_b32 v6, v8
    v_add_f32 v6, v6, v8
    ds_write_b32 v244, v6 offset:0
    ds_read_b64 v[172:173], v226 offset:1024
    ds_read_b64 v[174:175], v226 offset:1280
    s_waitcnt lgkmcnt(7)
    v_mfma_f32_32x32x16_bf16 v[192:207], v[40:43], v[160:163], v[192:207]
    s_xor_b32 s81, s77, 20480
    s_add_u32 s81, s81, s73
    buffer_load_dwordx4 v[104:107], v217, s[4:7], s81 offen offset:2048 sc1
    ds_read_b64 v[176:177], v226 offset:2048
    ds_read_b64 v[178:179], v226 offset:2304
    s_waitcnt lgkmcnt(7)
    v_mfma_f32_32x32x16_bf16 v[192:207], v[44:47], v[164:167], v[192:207]
    s_xor_b32 s81, s77, 20480
    s_add_u32 s81, s81, s73
    buffer_load_dwordx4 v[108:111], v217, s[4:7], s81 offen offset:3072 sc1
    s_add_u32 m0, s83, 3072
    s_add_u32 s81, s82, 196608
    buffer_load_dwordx4 v223, s[4:7], s81 offen sc1 lds
    ds_read_b64 v[180:181], v226 offset:3072
    ds_read_b64 v[182:183], v226 offset:3328
    s_waitcnt lgkmcnt(7)
    v_mfma_f32_32x32x16_bf16 v[192:207], v[48:51], v[168:171], v[192:207]
    s_xor_b32 s81, s77, 24576
    s_add_u32 s81, s81, s73
    buffer_load_dwordx4 v[112:115], v217, s[4:7], s81 offen offset:0 sc1
    ds_read_b64 v[160:161], v227 offset:0
    ds_read_b64 v[162:163], v227 offset:256
    s_waitcnt lgkmcnt(6)
    v_mfma_f32_32x32x16_bf16 v[192:207], v[52:55], v[172:175], v[192:207]
    s_xor_b32 s81, s77, 24576
    s_add_u32 s81, s81, s73
    buffer_load_dwordx4 v[116:119], v217, s[4:7], s81 offen offset:1024 sc1
    ds_read_b64 v[164:165], v227 offset:1024
    ds_read_b64 v[166:167], v227 offset:1280
    s_waitcnt lgkmcnt(6)
    v_mfma_f32_32x32x16_bf16 v[192:207], v[56:59], v[176:179], v[192:207]
    s_xor_b32 s81, s77, 24576
    s_add_u32 s81, s81, s73
    buffer_load_dwordx4 v[120:123], v217, s[4:7], s81 offen offset:2048 sc1
    ds_read_b64 v[168:169], v227 offset:2048
    ds_read_b64 v[170:171], v227 offset:2304
    s_waitcnt lgkmcnt(6)
    v_mfma_f32_32x32x16_bf16 v[192:207], v[60:63], v[180:183], v[192:207]
    s_xor_b32 s81, s77, 24576
    s_add_u32 s81, s81, s73
    buffer_load_dwordx4 v[124:127], v217, s[4:7], s81 offen offset:3072 sc1
    ds_read_b64 v[172:173], v227 offset:3072
    ds_read_b64 v[174:175], v227 offset:3328
    s_waitcnt lgkmcnt(6)
    v_mfma_f32_32x32x16_bf16 v[192:207], v[64:67], v[160:163], v[192:207]
    s_xor_b32 s81, s77, 28672
    s_add_u32 s81, s81, s73
    buffer_load_dwordx4 v[128:131], v217, s[4:7], s81 offen offset:0 sc1
    ds_read_b64 v[176:177], v228 offset:0
    ds_read_b64 v[178:179], v228 offset:256
    s_waitcnt lgkmcnt(6)
    v_mfma_f32_32x32x16_bf16 v[192:207], v[68:71], v[164:167], v[192:207]
    s_xor_b32 s81, s77, 28672
    s_add_u32 s81, s81, s73
    buffer_load_dwordx4 v[132:135], v217, s[4:7], s81 offen offset:1024 sc1
    ds_read_b64 v[180:181], v228 offset:1024
    ds_read_b64 v[182:183], v228 offset:1280
    s_waitcnt lgkmcnt(6)
    v_mfma_f32_32x32x16_bf16 v[192:207], v[72:75], v[168:171], v[192:207]
    s_xor_b32 s81, s77, 28672
    s_add_u32 s81, s81, s73
    buffer_load_dwordx4 v[136:139], v217, s[4:7], s81 offen offset:2048 sc1
    ds_read_b64 v[160:161], v228 offset:2048
    ds_read_b64 v[162:163], v228 offset:2304
    s_waitcnt lgkmcnt(6)
    v_mfma_f32_32x32x16_bf16 v[192:207], v[76:79], v[172:175], v[192:207]
    s_xor_b32 s81, s77, 28672
    s_add_u32 s81, s81, s73
    buffer_load_dwordx4 v[140:143], v217, s[4:7], s81 offen offset:3072 sc1
    ds_read_b64 v[164:165], v228 offset:3072
    ds_read_b64 v[166:167], v228 offset:3328
    s_waitcnt lgkmcnt(6)
    s_waitcnt vmcnt(19)
    v_mfma_f32_32x32x16_bf16 v[192:207], v[80:83], v[176:179], v[192:207]
    ds_read_b64 v[168:169], v229 offset:0
    ds_read_b64 v[170:171], v229 offset:256
    s_waitcnt lgkmcnt(6)
    s_waitcnt vmcnt(18)
    v_mfma_f32_32x32x16_bf16 v[192:207], v[84:87], v[180:183], v[192:207]
    ds_read_b64 v[172:173], v229 offset:1024
    ds_read_b64 v[174:175], v229 offset:1280
    s_waitcnt lgkmcnt(6)
    s_waitcnt vmcnt(16)
    v_mfma_f32_32x32x16_bf16 v[192:207], v[88:91], v[160:163], v[192:207]
    ds_read_b64 v[176:177], v229 offset:2048
    ds_read_b64 v[178:179], v229 offset:2304
    s_waitcnt lgkmcnt(6)
    s_waitcnt vmcnt(15)
    v_mfma_f32_32x32x16_bf16 v[192:207], v[92:95], v[164:167], v[192:207]
    ds_read_b64 v[180:181], v229 offset:3072
    ds_read_b64 v[182:183], v229 offset:3328
    s_waitcnt lgkmcnt(6)
    s_waitcnt vmcnt(13)
    v_mfma_f32_32x32x16_bf16 v[192:207], v[96:99], v[168:171], v[192:207]
    ds_read_b64 v[160:161], v230 offset:0
    ds_read_b64 v[162:163], v230 offset:256
    s_waitcnt lgkmcnt(6)
    s_waitcnt vmcnt(12)
    v_mfma_f32_32x32x16_bf16 v[192:207], v[100:103], v[172:175], v[192:207]
    ds_read_b64 v[164:165], v230 offset:1024
    ds_read_b64 v[166:167], v230 offset:1280
    s_waitcnt lgkmcnt(6)
    s_waitcnt vmcnt(10)
    v_mfma_f32_32x32x16_bf16 v[192:207], v[104:107], v[176:179], v[192:207]
    ds_read_b64 v[168:169], v230 offset:2048
    ds_read_b64 v[170:171], v230 offset:2304
    s_waitcnt lgkmcnt(6)
    s_waitcnt vmcnt(9)
    v_mfma_f32_32x32x16_bf16 v[192:207], v[108:111], v[180:183], v[192:207]
    ds_read_b64 v[172:173], v230 offset:3072
    ds_read_b64 v[174:175], v230 offset:3328
    s_waitcnt lgkmcnt(6)
    s_waitcnt vmcnt(7)
    v_mfma_f32_32x32x16_bf16 v[192:207], v[112:115], v[160:163], v[192:207]
    ds_read_b64 v[176:177], v231 offset:0
    ds_read_b64 v[178:179], v231 offset:256
    s_waitcnt lgkmcnt(6)
    s_waitcnt vmcnt(6)
    v_mfma_f32_32x32x16_bf16 v[192:207], v[116:119], v[164:167], v[192:207]
    ds_read_b64 v[180:181], v231 offset:1024
    ds_read_b64 v[182:183], v231 offset:1280
    s_waitcnt lgkmcnt(6)
    s_waitcnt vmcnt(5)
    v_mfma_f32_32x32x16_bf16 v[192:207], v[120:123], v[168:171], v[192:207]
    ds_read_b64 v[160:161], v231 offset:2048
    ds_read_b64 v[162:163], v231 offset:2304
    s_waitcnt lgkmcnt(6)
    s_waitcnt vmcnt(4)
    v_mfma_f32_32x32x16_bf16 v[192:207], v[124:127], v[172:175], v[192:207]
    ds_read_b64 v[164:165], v231 offset:3072
    ds_read_b64 v[166:167], v231 offset:3328
    s_waitcnt lgkmcnt(6)
    s_waitcnt vmcnt(3)
    v_mfma_f32_32x32x16_bf16 v[192:207], v[128:131], v[176:179], v[192:207]
    s_waitcnt lgkmcnt(4)
    s_waitcnt vmcnt(2)
    v_mfma_f32_32x32x16_bf16 v[192:207], v[132:135], v[180:183], v[192:207]
    s_waitcnt lgkmcnt(2)
    s_waitcnt vmcnt(1)
    v_mfma_f32_32x32x16_bf16 v[192:207], v[136:139], v[160:163], v[192:207]
    s_waitcnt lgkmcnt(0)
    s_waitcnt vmcnt(0)
    v_mfma_f32_32x32x16_bf16 v[192:207], v[140:143], v[164:167], v[192:207]
    s_waitcnt lgkmcnt(0)
    s_cmp_eq_u32 s68, 1
    s_nop 8
    s_cbranch_scc1 L_m_P246_one
    s_waitcnt vmcnt(0)
    s_barrier
    ds_read_b64 v[160:161], v224 offset:32768
    ds_read_b64 v[162:163], v224 offset:33024
    ds_read_b64 v[164:165], v224 offset:33792
    ds_read_b64 v[166:167], v224 offset:34048
    ds_read_b64 v[168:169], v224 offset:34816
    ds_read_b64 v[170:171], v224 offset:35072
    v_mov_b32 v218, 0
    v_mov_b32 v219, 0
    ds_read_b64 v[172:173], v224 offset:35840
    ds_read_b64 v[174:175], v224 offset:36096
    s_waitcnt lgkmcnt(6)
    v_mfma_f32_32x32x16_bf16 v[144:159], v[16:19], v[160:163], 0
    v_and_b32 v6, v221, v160
    v_dot2c_f32_bf16 v218, v6, v6
    v_dot2c_f32_bf16 v219, v161, v161
    v_dot2c_f32_bf16 v218, v162, v162
    v_dot2c_f32_bf16 v219, v163, v163
    ds_read_b128 v[236:239], v245 offset:0
    ds_read_b128 v[240:243], v245 offset:16
    s_add_u32 s69, s67, 0
    ds_read_b64 v[176:177], v225 offset:32768
    ds_read_b64 v[178:179], v225 offset:33024
    s_waitcnt lgkmcnt(8)
    v_mfma_f32_32x32x16_bf16 v[144:159], v[20:23], v[164:167], v[144:159]
    s_add_u32 m0, s83, 32768
    s_add_u32 s81, s82, 256
    buffer_load_dwordx4 v223, s[4:7], s81 offen sc1 lds
    v_dot2c_f32_bf16 v218, v164, v164
    v_dot2c_f32_bf16 v219, v165, v165
    v_dot2c_f32_bf16 v218, v166, v166
    v_dot2c_f32_bf16 v219, v167, v167
    s_mul_i32 s69, s69, 86
    s_add_u32 s69, s69, s66
    s_lshl_b32 s69, s69, 10
    ds_read_b64 v[180:181], v225 offset:33792
    ds_read_b64 v[182:183], v225 offset:34048
    s_waitcnt lgkmcnt(8)
    v_mfma_f32_32x32x16_bf16 v[144:159], v[24:27], v[168:171], v[144:159]
    v_dot2c_f32_bf16 v218, v168, v168
    v_dot2c_f32_bf16 v219, v169, v169
    v_dot2c_f32_bf16 v218, v170, v170
    v_dot2c_f32_bf16 v219, v171, v171
    s_add_u32 s69, s69, s44
    s_or_b32 s69, s69, s71
    s_waitcnt lgkmcnt(4)
    v_pk_add_f32 v[236:237], v[236:237], v[238:239]
    ds_read_b64 v[160:161], v225 offset:34816
    ds_read_b64 v[162:163], v225 offset:35072
    v_mfma_f32_32x32x16_bf16 v[144:159], v[28:31], v[172:175], v[144:159]
    s_add_u32 m0, s83, 33792
    s_add_u32 s81, s82, 65792
    buffer_load_dwordx4 v223, s[4:7], s81 offen sc1 lds
    v_dot2c_f32_bf16 v218, v172, v172
    v_dot2c_f32_bf16 v219, v173, v173
    v_dot2c_f32_bf16 v218, v174, v174
    v_dot2c_f32_bf16 v219, v175, v175
    v_pk_add_f32 v[240:241], v[240:241], v[242:243]
    v_pk_add_f32 v[236:237], v[236:237], v[240:241]
    v_add_f32 v236, v236, v237
    ds_read_b64 v[164:165], v225 offset:35840
    ds_read_b64 v[166:167], v225 offset:36096
    s_waitcnt lgkmcnt(6)
    v_mfma_f32_32x32x16_bf16 v[144:159], v[32:35], v[176:179], v[144:159]
    v_mov_b32 v237, 0x3727c5ac
    v_fma_f32 v236, v236, s60, v237
    v_rsq_f32 v216, v236
    s_nop 0
    v_mul_f32 v192, v192, v216
    ds_read_b64 v[168:169], v226 offset:32768
    ds_read_b64 v[170:171], v226 offset:33024
    s_waitcnt lgkmcnt(6)
    v_mfma_f32_32x32x16_bf16 v[144:159], v[36:39], v[180:183], v[144:159]
    s_add_u32 m0, s83, 34816
    s_add_u32 s81, s82, 131328
    buffer_load_dwordx4 v223, s[4:7], s81 offen sc1 lds
    v_add_f32 v6, v218, v219
    v_mov_b32 v8, v6
    s_nop 1
    v_permlane32_swap_b32 v6, v8
    v_add_f32 v6, v6, v8
    ds_write_b32 v244, v6 offset:1024
    v_mul_f32 v208, v192, v192
    v_fmaak_f32 v208, v208, v220, 0xc0135761
    v_mul_f32 v208, v208, v192
    ds_read_b64 v[172:173], v226 offset:33792
    ds_read_b64 v[174:175], v226 offset:34048
    s_waitcnt lgkmcnt(7)
    v_mfma_f32_32x32x16_bf16 v[144:159], v[40:43], v[160:163], v[144:159]
    v_mul_f32 v200, v200, v216
    v_exp_f32 v208, v208
    v_mul_f32 v193, v193, v216
    v_mul_f32 v209, v193, v193
    ds_read_b64 v[176:177], v226 offset:34816
    ds_read_b64 v[178:179], v226 offset:35072
    s_waitcnt lgkmcnt(7)
    v_mfma_f32_32x32x16_bf16 v[144:159], v[44:47], v[164:167], v[144:159]
    s_add_u32 m0, s83, 35840
    s_add_u32 s81, s82, 196864
    buffer_load_dwordx4 v223, s[4:7], s81 offen sc1 lds
    v_fmaak_f32 v209, v209, v220, 0xc0135761
    v_mul_f32 v209, v209, v193
    v_mul_f32 v201, v201, v216
    ds_read_b64 v[180:181], v226 offset:35840
    ds_read_b64 v[182:183], v226 offset:36096
    s_waitcnt lgkmcnt(7)
    v_mfma_f32_32x32x16_bf16 v[144:159], v[48:51], v[168:171], v[144:159]
    v_exp_f32 v209, v209
    v_mul_f32 v194, v194, v216
    v_mul_f32 v210, v194, v194
    v_fmaak_f32 v210, v210, v220, 0xc0135761
    ds_read_b64 v[160:161], v227 offset:32768
    ds_read_b64 v[162:163], v227 offset:33024
    s_waitcnt lgkmcnt(6)
    v_mfma_f32_32x32x16_bf16 v[144:159], v[52:55], v[172:175], v[144:159]
    v_mul_f32 v210, v210, v194
    v_mul_f32 v202, v202, v216
    v_exp_f32 v210, v210
    ds_read_b64 v[164:165], v227 offset:33792
    ds_read_b64 v[166:167], v227 offset:34048
    s_waitcnt lgkmcnt(6)
    v_mfma_f32_32x32x16_bf16 v[144:159], v[56:59], v[176:179], v[144:159]
    s_add_u32 m0, s75, 0
    s_nop 0
    buffer_load_dwordx4 v222, s[4:7], s74 offen sc1 lds
    s_add_u32 s74, s74, 65536
    v_mul_f32 v195, v195, v216
    v_mul_f32 v211, v195, v195
    v_fmaak_f32 v211, v211, v220, 0xc0135761
    v_mul_f32 v211, v211, v195
    ds_read_b64 v[168:169], v227 offset:34816
    ds_read_b64 v[170:171], v227 offset:35072
    s_waitcnt lgkmcnt(6)
    v_mfma_f32_32x32x16_bf16 v[144:159], v[60:63], v[180:183], v[144:159]
    v_mul_f32 v203, v203, v216
    v_exp_f32 v211, v211
    v_mul_f32 v196, v196, v216
    ds_read_b64 v[172:173], v227 offset:35840
    ds_read_b64 v[174:175], v227 offset:36096
    s_waitcnt lgkmcnt(6)
    v_mfma_f32_32x32x16_bf16 v[144:159], v[64:67], v[160:163], v[144:159]
    v_mul_f32 v212, v196, v196
    v_fmaak_f32 v212, v212, v220, 0xc0135761
    v_mul_f32 v212, v212, v196
    v_mul_f32 v204, v204, v216
    ds_read_b64 v[176:177], v228 offset:32768
    ds_read_b64 v[178:179], v228 offset:33024
    s_waitcnt lgkmcnt(6)
    v_mfma_f32_32x32x16_bf16 v[144:159], v[68:71], v[164:167], v[144:159]
    s_add_u32 m0, s75, 1024
    s_nop 0
    buffer_load_dwordx4 v222, s[4:7], s74 offen sc1 lds
    s_add_u32 s74, s74, 65536
    v_exp_f32 v212, v212
    v_mul_f32 v197, v197, v216
    v_mul_f32 v213, v197, v197
    ds_read_b64 v[180:181], v228 offset:33792
    ds_read_b64 v[182:183], v228 offset:34048
    s_waitcnt lgkmcnt(6)
    v_mfma_f32_32x32x16_bf16 v[144:159], v[72:75], v[168:171], v[144:159]
    v_fmaak_f32 v213, v213, v220, 0xc0135761
    v_mul_f32 v213, v213, v197
    v_mul_f32 v205, v205, v216
    v_exp_f32 v213, v213
    ds_read_b64 v[160:161], v228 offset:34816
    ds_read_b64 v[162:163], v228 offset:35072
    s_waitcnt lgkmcnt(6)
    v_mfma_f32_32x32x16_bf16 v[144:159], v[76:79], v[172:175], v[144:159]
    v_mul_f32 v198, v198, v216
    v_mul_f32 v214, v198, v198
    v_fmaak_f32 v214, v214, v220, 0xc0135761
    ds_read_b64 v[164:165], v228 offset:35840
    ds_read_b64 v[166:167], v228 offset:36096
    s_waitcnt lgkmcnt(6)
    v_mfma_f32_32x32x16_bf16 v[144:159], v[80:83], v[176:179], v[144:159]
    s_add_u32 m0, s75, 2048
    s_nop 0
    buffer_load_dwordx4 v222, s[4:7], s74 offen sc1 lds
    s_add_u32 s74, s74, 65536
    v_mul_f32 v214, v214, v198
    v_mul_f32 v206, v206, v216
    v_exp_f32 v214, v214
    ds_read_b64 v[168:169], v229 offset:32768
    ds_read_b64 v[170:171], v229 offset:33024
    s_waitcnt lgkmcnt(6)
    v_mfma_f32_32x32x16_bf16 v[144:159], v[84:87], v[180:183], v[144:159]
    v_mul_f32 v199, v199, v216
    v_mul_f32 v215, v199, v199
    v_fmaak_f32 v215, v215, v220, 0xc0135761
    v_mul_f32 v215, v215, v199
    ds_read_b64 v[172:173], v229 offset:33792
    ds_read_b64 v[174:175], v229 offset:34048
    s_waitcnt lgkmcnt(6)
    v_mfma_f32_32x32x16_bf16 v[144:159], v[88:91], v[160:163], v[144:159]
    v_mul_f32 v207, v207, v216
    v_exp_f32 v215, v215
    v_mul_f32 v192, v192, v200
    ds_read_b64 v[176:177], v229 offset:34816
    ds_read_b64 v[178:179], v229 offset:35072
    s_waitcnt lgkmcnt(6)
    v_mfma_f32_32x32x16_bf16 v[144:159], v[92:95], v[164:167], v[144:159]
    s_add_u32 m0, s75, 3072
    s_nop 0
    buffer_load_dwordx4 v222, s[4:7], s74 offen sc1 lds
    v_add_f32 v208, 1.0, v208
    v_rcp_f32 v208, v208
    v_mul_f32 v193, v193, v201
    v_add_f32 v209, 1.0, v209
    ds_read_b64 v[180:181], v229 offset:35840
    ds_read_b64 v[182:183], v229 offset:36096
    s_waitcnt lgkmcnt(6)
    v_mfma_f32_32x32x16_bf16 v[144:159], v[96:99], v[168:171], v[144:159]
    v_rcp_f32 v209, v209
    v_mul_f32 v194, v194, v202
    v_add_f32 v210, 1.0, v210
    ds_read_b64 v[160:161], v230 offset:32768
    ds_read_b64 v[162:163], v230 offset:33024
    s_waitcnt lgkmcnt(6)
    v_mfma_f32_32x32x16_bf16 v[144:159], v[100:103], v[172:175], v[144:159]
    v_rcp_f32 v210, v210
    v_mul_f32 v195, v195, v203
    v_add_f32 v211, 1.0, v211
    v_rcp_f32 v211, v211
    ds_read_b64 v[164:165], v230 offset:33792
    ds_read_b64 v[166:167], v230 offset:34048
    s_waitcnt lgkmcnt(6)
    v_mfma_f32_32x32x16_bf16 v[144:159], v[104:107], v[176:179], v[144:159]
    v_mul_f32 v196, v196, v204
    v_add_f32 v212, 1.0, v212
    v_rcp_f32 v212, v212
    ds_read_b64 v[168:169], v230 offset:34816
    ds_read_b64 v[170:171], v230 offset:35072
    s_waitcnt lgkmcnt(6)
    v_mfma_f32_32x32x16_bf16 v[144:159], v[108:111], v[180:183], v[144:159]
    v_mul_f32 v197, v197, v205
    v_add_f32 v213, 1.0, v213
    v_rcp_f32 v213, v213
    v_mul_f32 v198, v198, v206
    ds_read_b64 v[172:173], v230 offset:35840
    ds_read_b64 v[174:175], v230 offset:36096
    s_waitcnt lgkmcnt(6)
    v_mfma_f32_32x32x16_bf16 v[144:159], v[112:115], v[160:163], v[144:159]
    v_add_f32 v214, 1.0, v214
    v_rcp_f32 v214, v214
    v_mul_f32 v199, v199, v207
    ds_read_b64 v[176:177], v231 offset:32768
    ds_read_b64 v[178:179], v231 offset:33024
    s_waitcnt lgkmcnt(6)
    v_mfma_f32_32x32x16_bf16 v[144:159], v[116:119], v[164:167], v[144:159]
    v_add_f32 v215, 1.0, v215
    v_rcp_f32 v215, v215
    v_mul_f32 v192, v192, v208
    v_mul_f32 v193, v193, v209
    ds_read_b64 v[180:181], v231 offset:33792
    ds_read_b64 v[182:183], v231 offset:34048
    s_waitcnt lgkmcnt(6)
    v_mfma_f32_32x32x16_bf16 v[144:159], v[120:123], v[168:171], v[144:159]
    v_mul_f32 v194, v194, v210
    v_mul_f32 v195, v195, v211
    v_mul_f32 v196, v196, v212
    ds_read_b64 v[160:161], v231 offset:34816
    ds_read_b64 v[162:163], v231 offset:35072
    s_waitcnt lgkmcnt(6)
    v_mfma_f32_32x32x16_bf16 v[144:159], v[124:127], v[172:175], v[144:159]
    v_mul_f32 v197, v197, v213
    v_mul_f32 v198, v198, v214
    v_mul_f32 v199, v199, v215
    v_cvt_pk_bf16_f32 v232, v192, v193
    ds_read_b64 v[164:165], v231 offset:35840
    ds_read_b64 v[166:167], v231 offset:36096
    s_waitcnt lgkmcnt(6)
    v_mfma_f32_32x32x16_bf16 v[144:159], v[128:131], v[176:179], v[144:159]
    v_cvt_pk_bf16_f32 v233, v194, v195
    v_cvt_pk_bf16_f32 v234, v196, v197
    v_cvt_pk_bf16_f32 v235, v198, v199
    s_waitcnt lgkmcnt(4)
    v_mfma_f32_32x32x16_bf16 v[144:159], v[132:135], v[180:183], v[144:159]
    v_lshlrev_b32 v7, 4, v1
    v_permlane32_swap_b32 v232, v234
    v_permlane32_swap_b32 v233, v235
    buffer_store_dwordx4 v[232:235], v7, s[4:7], s69 offen sc1
    s_waitcnt lgkmcnt(2)
    v_mfma_f32_32x32x16_bf16 v[144:159], v[136:139], v[160:163], v[144:159]
    s_waitcnt lgkmcnt(0)
    v_mfma_f32_32x32x16_bf16 v[144:159], v[140:143], v[164:167], v[144:159]
    s_waitcnt lgkmcnt(0)
    s_nop 9
    s_branch L_m_P246_join
L_m_P246_ncpath:
    ds_read_b64 v[160:161], v224 offset:0
    ds_read_b64 v[162:163], v224 offset:256
    ds_read_b64 v[164:165], v224 offset:1024
    ds_read_b64 v[166:167], v224 offset:1280
    ds_read_b64 v[168:169], v224 offset:2048
    ds_read_b64 v[170:171], v224 offset:2304
    v_mov_b32 v218, 0
    v_mov_b32 v219, 0
    ds_read_b64 v[172:173], v224 offset:3072
    ds_read_b64 v[174:175], v224 offset:3328
    s_waitcnt lgkmcnt(6)
    v_mfma_f32_32x32x16_bf16 v[192:207], v[16:19], v[160:163], 0
    s_add_u32 m0, s83, 0
    s_add_u32 s81, s82, 0
    buffer_load_dwordx4 v223, s[4:7], s81 offen sc1 lds
    v_and_b32 v6, v221, v160
    v_dot2c_f32_bf16 v218, v6, v6
    v_dot2c_f32_bf16 v219, v161, v161
    v_dot2c_f32_bf16 v218, v162, v162
    v_dot2c_f32_bf16 v219, v163, v163
    ds_read_b64 v[176:177], v225 offset:0
    ds_read_b64 v[178:179], v225 offset:256
    s_waitcnt lgkmcnt(6)
    v_mfma_f32_32x32x16_bf16 v[192:207], v[20:23], v[164:167], v[192:207]
    v_dot2c_f32_bf16 v218, v164, v164
    v_dot2c_f32_bf16 v219, v165, v165
    v_dot2c_f32_bf16 v218, v166, v166
    v_dot2c_f32_bf16 v219, v167, v167
    ds_read_b64 v[180:181], v225 offset:1024
    ds_read_b64 v[182:183], v225 offset:1280
    s_waitcnt lgkmcnt(6)
    v_mfma_f32_32x32x16_bf16 v[192:207], v[24:27], v[168:171], v[192:207]
    s_add_u32 m0, s83, 1024
    s_add_u32 s81, s82, 65536
    buffer_load_dwordx4 v223, s[4:7], s81 offen sc1 lds
    v_dot2c_f32_bf16 v218, v168, v168
    v_dot2c_f32_bf16 v219, v169, v169
    v_dot2c_f32_bf16 v218, v170, v170
    v_dot2c_f32_bf16 v219, v171, v171
    ds_read_b64 v[160:161], v225 offset:2048
    ds_read_b64 v[162:163], v225 offset:2304
    s_waitcnt lgkmcnt(6)
    v_mfma_f32_32x32x16_bf16 v[192:207], v[28:31], v[172:175], v[192:207]
    v_dot2c_f32_bf16 v218, v172, v172
    v_dot2c_f32_bf16 v219, v173, v173
    v_dot2c_f32_bf16 v218, v174, v174
    v_dot2c_f32_bf16 v219, v175, v175
    ds_read_b64 v[164:165], v225 offset:3072
    ds_read_b64 v[166:167], v225 offset:3328
    s_waitcnt lgkmcnt(6)
    v_mfma_f32_32x32x16_bf16 v[192:207], v[32:35], v[176:179], v[192:207]
    s_add_u32 m0, s83, 2048
    s_add_u32 s81, s82, 131072
    buffer_load_dwordx4 v223, s[4:7], s81 offen sc1 lds
    ds_read_b64 v[168:169], v226 offset:0
    ds_read_b64 v[170:171], v226 offset:256
    s_waitcnt lgkmcnt(6)
    v_mfma_f32_32x32x16_bf16 v[192:207], v[36:39], v[180:183], v[192:207]
    v_add_f32 v6, v218, v219
    v_mov_b32 v8, v6
    s_nop 1
    v_permlane32_swap_b32 v6, v8
    v_add_f32 v6, v6, v8
    ds_write_b32 v244, v6 offset:0
    ds_read_b64 v[172:173], v226 offset:1024
    ds_read_b64 v[174:175], v226 offset:1280
    s_waitcnt lgkmcnt(7)
    v_mfma_f32_32x32x16_bf16 v[192:207], v[40:43], v[160:163], v[192:207]
    s_add_u32 m0, s83, 3072
    s_add_u32 s81, s82, 196608
    buffer_load_dwordx4 v223, s[4:7], s81 offen sc1 lds
    ds_read_b64 v[176:177], v226 offset:2048
    ds_read_b64 v[178:179], v226 offset:2304
    s_waitcnt lgkmcnt(7)
    v_mfma_f32_32x32x16_bf16 v[192:207], v[44:47], v[164:167], v[192:207]
    ds_read_b64 v[180:181], v226 offset:3072
    ds_read_b64 v[182:183], v226 offset:3328
    s_waitcnt lgkmcnt(7)
    v_mfma_f32_32x32x16_bf16 v[192:207], v[48:51], v[168:171], v[192:207]
    ds_read_b64 v[160:161], v227 offset:0
    ds_read_b64 v[162:163], v227 offset:256
    s_waitcnt lgkmcnt(6)
    v_mfma_f32_32x32x16_bf16 v[192:207], v[52:55], v[172:175], v[192:207]
    s_add_u32 m0, s83, 32768
    s_add_u32 s81, s82, 256
    buffer_load_dwordx4 v223, s[4:7], s81 offen sc1 lds
    ds_read_b64 v[164:165], v227 offset:1024
    ds_read_b64 v[166:167], v227 offset:1280
    s_waitcnt lgkmcnt(6)
    v_mfma_f32_32x32x16_bf16 v[192:207], v[56:59], v[176:179], v[192:207]
    ds_read_b64 v[168:169], v227 offset:2048
    ds_read_b64 v[170:171], v227 offset:2304
    s_waitcnt lgkmcnt(6)
    v_mfma_f32_32x32x16_bf16 v[192:207], v[60:63], v[180:183], v[192:207]
    ds_read_b64 v[172:173], v227 offset:3072
    ds_read_b64 v[174:175], v227 offset:3328
    s_waitcnt lgkmcnt(6)
    v_mfma_f32_32x32x16_bf16 v[192:207], v[64:67], v[160:163], v[192:207]
    s_add_u32 m0, s83, 33792
    s_add_u32 s81, s82, 65792
    buffer_load_dwordx4 v223, s[4:7], s81 offen sc1 lds
    ds_read_b64 v[176:177], v228 offset:0
    ds_read_b64 v[178:179], v228 offset:256
    s_waitcnt lgkmcnt(6)
    v_mfma_f32_32x32x16_bf16 v[192:207], v[68:71], v[164:167], v[192:207]
    ds_read_b64 v[180:181], v228 offset:1024
    ds_read_b64 v[182:183], v228 offset:1280
    s_waitcnt lgkmcnt(6)
    v_mfma_f32_32x32x16_bf16 v[192:207], v[72:75], v[168:171], v[192:207]
    ds_read_b64 v[160:161], v228 offset:2048
    ds_read_b64 v[162:163], v228 offset:2304
    s_waitcnt lgkmcnt(6)
    v_mfma_f32_32x32x16_bf16 v[192:207], v[76:79], v[172:175], v[192:207]
    s_add_u32 m0, s83, 34816
    s_add_u32 s81, s82, 131328
    buffer_load_dwordx4 v223, s[4:7], s81 offen sc1 lds
    ds_read_b64 v[164:165], v228 offset:3072
    ds_read_b64 v[166:167], v228 offset:3328
    s_waitcnt lgkmcnt(6)
    v_mfma_f32_32x32x16_bf16 v[192:207], v[80:83], v[176:179], v[192:207]
    ds_read_b64 v[168:169], v229 offset:0
    ds_read_b64 v[170:171], v229 offset:256
    s_waitcnt lgkmcnt(6)
    v_mfma_f32_32x32x16_bf16 v[192:207], v[84:87], v[180:183], v[192:207]
    ds_read_b64 v[172:173], v229 offset:1024
    ds_read_b64 v[174:175], v229 offset:1280
    s_waitcnt lgkmcnt(6)
    v_mfma_f32_32x32x16_bf16 v[192:207], v[88:91], v[160:163], v[192:207]
    s_add_u32 m0, s83, 35840
    s_add_u32 s81, s82, 196864
    buffer_load_dwordx4 v223, s[4:7], s81 offen sc1 lds
    ds_read_b64 v[176:177], v229 offset:2048
    ds_read_b64 v[178:179], v229 offset:2304
    s_waitcnt lgkmcnt(6)
    v_mfma_f32_32x32x16_bf16 v[192:207], v[92:95], v[164:167], v[192:207]
    ds_read_b64 v[180:181], v229 offset:3072
    ds_read_b64 v[182:183], v229 offset:3328
    s_waitcnt lgkmcnt(6)
    v_mfma_f32_32x32x16_bf16 v[192:207], v[96:99], v[168:171], v[192:207]
    ds_read_b64 v[160:161], v230 offset:0
    ds_read_b64 v[162:163], v230 offset:256
    s_waitcnt lgkmcnt(6)
    v_mfma_f32_32x32x16_bf16 v[192:207], v[100:103], v[172:175], v[192:207]
    ds_read_b64 v[164:165], v230 offset:1024
    ds_read_b64 v[166:167], v230 offset:1280
    s_waitcnt lgkmcnt(6)
    v_mfma_f32_32x32x16_bf16 v[192:207], v[104:107], v[176:179], v[192:207]
    ds_read_b64 v[168:169], v230 offset:2048
    ds_read_b64 v[170:171], v230 offset:2304
    s_waitcnt lgkmcnt(6)
    v_mfma_f32_32x32x16_bf16 v[192:207], v[108:111], v[180:183], v[192:207]
    ds_read_b64 v[172:173], v230 offset:3072
    ds_read_b64 v[174:175], v230 offset:3328
    s_waitcnt lgkmcnt(6)
    v_mfma_f32_32x32x16_bf16 v[192:207], v[112:115], v[160:163], v[192:207]
    ds_read_b64 v[176:177], v231 offset:0
    ds_read_b64 v[178:179], v231 offset:256
    s_waitcnt lgkmcnt(6)
    v_mfma_f32_32x32x16_bf16 v[192:207], v[116:119], v[164:167], v[192:207]
    ds_read_b64 v[180:181], v231 offset:1024
    ds_read_b64 v[182:183], v231 offset:1280
    s_waitcnt lgkmcnt(6)
    v_mfma_f32_32x32x16_bf16 v[192:207], v[120:123], v[168:171], v[192:207]
    ds_read_b64 v[160:161], v231 offset:2048
    ds_read_b64 v[162:163], v231 offset:2304
    s_waitcnt lgkmcnt(6)
    v_mfma_f32_32x32x16_bf16 v[192:207], v[124:127], v[172:175], v[192:207]
    ds_read_b64 v[164:165], v231 offset:3072
    ds_read_b64 v[166:167], v231 offset:3328
    s_waitcnt lgkmcnt(6)
    v_mfma_f32_32x32x16_bf16 v[192:207], v[128:131], v[176:179], v[192:207]
    s_waitcnt lgkmcnt(4)
    v_mfma_f32_32x32x16_bf16 v[192:207], v[132:135], v[180:183], v[192:207]
    s_waitcnt lgkmcnt(2)
    v_mfma_f32_32x32x16_bf16 v[192:207], v[136:139], v[160:163], v[192:207]
    s_waitcnt lgkmcnt(0)
    v_mfma_f32_32x32x16_bf16 v[192:207], v[140:143], v[164:167], v[192:207]
    s_waitcnt lgkmcnt(0)
    s_cmp_eq_u32 s68, 1
    s_nop 8
    s_cbranch_scc1 L_m_P246_one
    s_waitcnt vmcnt(0)
    s_barrier
    ds_read_b64 v[160:161], v224 offset:32768
    ds_read_b64 v[162:163], v224 offset:33024
    ds_read_b64 v[164:165], v224 offset:33792
    ds_read_b64 v[166:167], v224 offset:34048
    ds_read_b64 v[168:169], v224 offset:34816
    ds_read_b64 v[170:171], v224 offset:35072
    v_mov_b32 v218, 0
    v_mov_b32 v219, 0
    ds_read_b64 v[172:173], v224 offset:35840
    ds_read_b64 v[174:175], v224 offset:36096
    s_waitcnt lgkmcnt(6)
    v_mfma_f32_32x32x16_bf16 v[144:159], v[16:19], v[160:163], 0
    v_and_b32 v6, v221, v160
    v_dot2c_f32_bf16 v218, v6, v6
    v_dot2c_f32_bf16 v219, v161, v161
    v_dot2c_f32_bf16 v218, v162, v162
    v_dot2c_f32_bf16 v219, v163, v163
    ds_read_b128 v[236:239], v245 offset:0
    ds_read_b128 v[240:243], v245 offset:16
    s_add_u32 s69, s67, 0
    ds_read_b64 v[176:177], v225 offset:32768
    ds_read_b64 v[178:179], v225 offset:33024
    s_waitcnt lgkmcnt(8)
    v_mfma_f32_32x32x16_bf16 v[144:159], v[20:23], v[164:167], v[144:159]
    v_dot2c_f32_bf16 v218, v164, v164
    v_dot2c_f32_bf16 v219, v165, v165
    v_dot2c_f32_bf16 v218, v166, v166
    v_dot2c_f32_bf16 v219, v167, v167
    s_mul_i32 s69, s69, 86
    s_add_u32 s69, s69, s66
    s_lshl_b32 s69, s69, 10
    ds_read_b64 v[180:181], v225 offset:33792
    ds_read_b64 v[182:183], v225 offset:34048
    s_waitcnt lgkmcnt(8)
    v_mfma_f32_32x32x16_bf16 v[144:159], v[24:27], v[168:171], v[144:159]
    v_dot2c_f32_bf16 v218, v168, v168
    v_dot2c_f32_bf16 v219, v169, v169
    v_dot2c_f32_bf16 v218, v170, v170
    v_dot2c_f32_bf16 v219, v171, v171
    s_add_u32 s69, s69, s44
    s_or_b32 s69, s69, s71
    s_waitcnt lgkmcnt(4)
    v_pk_add_f32 v[236:237], v[236:237], v[238:239]
    ds_read_b64 v[160:161], v225 offset:34816
    ds_read_b64 v[162:163], v225 offset:35072
    v_mfma_f32_32x32x16_bf16 v[144:159], v[28:31], v[172:175], v[144:159]
    v_dot2c_f32_bf16 v218, v172, v172
    v_dot2c_f32_bf16 v219, v173, v173
    v_dot2c_f32_bf16 v218, v174, v174
    v_dot2c_f32_bf16 v219, v175, v175
    v_pk_add_f32 v[240:241], v[240:241], v[242:243]
    v_pk_add_f32 v[236:237], v[236:237], v[240:241]
    v_add_f32 v236, v236, v237
    ds_read_b64 v[164:165], v225 offset:35840
    ds_read_b64 v[166:167], v225 offset:36096
    s_waitcnt lgkmcnt(6)
    v_mfma_f32_32x32x16_bf16 v[144:159], v[32:35], v[176:179], v[144:159]
    v_mov_b32 v237, 0x3727c5ac
    v_fma_f32 v236, v236, s60, v237
    v_rsq_f32 v216, v236
    s_nop 0
    v_mul_f32 v192, v192, v216
    ds_read_b64 v[168:169], v226 offset:32768
    ds_read_b64 v[170:171], v226 offset:33024
    s_waitcnt lgkmcnt(6)
    v_mfma_f32_32x32x16_bf16 v[144:159], v[36:39], v[180:183], v[144:159]
    v_add_f32 v6, v218, v219
    v_mov_b32 v8, v6
    s_nop 1
    v_permlane32_swap_b32 v6, v8
    v_add_f32 v6, v6, v8
    ds_write_b32 v244, v6 offset:1024
    v_mul_f32 v208, v192, v192
    v_fmaak_f32 v208, v208, v220, 0xc0135761
    v_mul_f32 v208, v208, v192
    ds_read_b64 v[172:173], v226 offset:33792
    ds_read_b64 v[174:175], v226 offset:34048
    s_waitcnt lgkmcnt(7)
    v_mfma_f32_32x32x16_bf16 v[144:159], v[40:43], v[160:163], v[144:159]
    v_mul_f32 v200, v200, v216
    v_exp_f32 v208, v208
    v_mul_f32 v193, v193, v216
    v_mul_f32 v209, v193, v193
    ds_read_b64 v[176:177], v226 offset:34816
    ds_read_b64 v[178:179], v226 offset:35072
    s_waitcnt lgkmcnt(7)
    v_mfma_f32_32x32x16_bf16 v[144:159], v[44:47], v[164:167], v[144:159]
    v_fmaak_f32 v209, v209, v220, 0xc0135761
    v_mul_f32 v209, v209, v193
    v_mul_f32 v201, v201, v216
    ds_read_b64 v[180:181], v226 offset:35840
    ds_read_b64 v[182:183], v226 offset:36096
    s_waitcnt lgkmcnt(7)
    v_mfma_f32_32x32x16_bf16 v[144:159], v[48:51], v[168:171], v[144:159]
    v_exp_f32 v209, v209
    v_mul_f32 v194, v194, v216
    v_mul_f32 v210, v194, v194
    v_fmaak_f32 v210, v210, v220, 0xc0135761
    ds_read_b64 v[160:161], v227 offset:32768
    ds_read_b64 v[162:163], v227 offset:33024
    s_waitcnt lgkmcnt(6)
    v_mfma_f32_32x32x16_bf16 v[144:159], v[52:55], v[172:175], v[144:159]
    v_mul_f32 v210, v210, v194
    v_mul_f32 v202, v202, v216
    v_exp_f32 v210, v210
    ds_read_b64 v[164:165], v227 offset:33792
    ds_read_b64 v[166:167], v227 offset:34048
    s_waitcnt lgkmcnt(6)
    v_mfma_f32_32x32x16_bf16 v[144:159], v[56:59], v[176:179], v[144:159]
    s_add_u32 m0, s75, 0
    s_nop 0
    buffer_load_dwordx4 v222, s[4:7], s74 offen sc1 lds
    s_add_u32 s74, s74, 65536
    v_mul_f32 v195, v195, v216
    v_mul_f32 v211, v195, v195
    v_fmaak_f32 v211, v211, v220, 0xc0135761
    v_mul_f32 v211, v211, v195
    ds_read_b64 v[168:169], v227 offset:34816
    ds_read_b64 v[170:171], v227 offset:35072
    s_waitcnt lgkmcnt(6)
    v_mfma_f32_32x32x16_bf16 v[144:159], v[60:63], v[180:183], v[144:159]
    v_mul_f32 v203, v203, v216
    v_exp_f32 v211, v211
    v_mul_f32 v196, v196, v216
    ds_read_b64 v[172:173], v227 offset:35840
    ds_read_b64 v[174:175], v227 offset:36096
    s_waitcnt lgkmcnt(6)
    v_mfma_f32_32x32x16_bf16 v[144:159], v[64:67], v[160:163], v[144:159]
    v_mul_f32 v212, v196, v196
    v_fmaak_f32 v212, v212, v220, 0xc0135761
    v_mul_f32 v212, v212, v196
    v_mul_f32 v204, v204, v216
    ds_read_b64 v[176:177], v228 offset:32768
    ds_read_b64 v[178:179], v228 offset:33024
    s_waitcnt lgkmcnt(6)
    v_mfma_f32_32x32x16_bf16 v[144:159], v[68:71], v[164:167], v[144:159]
    s_add_u32 m0, s75, 1024
    s_nop 0
    buffer_load_dwordx4 v222, s[4:7], s74 offen sc1 lds
    s_add_u32 s74, s74, 65536
    v_exp_f32 v212, v212
    v_mul_f32 v197, v197, v216
    v_mul_f32 v213, v197, v197
    ds_read_b64 v[180:181], v228 offset:33792
    ds_read_b64 v[182:183], v228 offset:34048
    s_waitcnt lgkmcnt(6)
    v_mfma_f32_32x32x16_bf16 v[144:159], v[72:75], v[168:171], v[144:159]
    v_fmaak_f32 v213, v213, v220, 0xc0135761
    v_mul_f32 v213, v213, v197
    v_mul_f32 v205, v205, v216
    v_exp_f32 v213, v213
    ds_read_b64 v[160:161], v228 offset:34816
    ds_read_b64 v[162:163], v228 offset:35072
    s_waitcnt lgkmcnt(6)
    v_mfma_f32_32x32x16_bf16 v[144:159], v[76:79], v[172:175], v[144:159]
    v_mul_f32 v198, v198, v216
    v_mul_f32 v214, v198, v198
    v_fmaak_f32 v214, v214, v220, 0xc0135761
    ds_read_b64 v[164:165], v228 offset:35840
    ds_read_b64 v[166:167], v228 offset:36096
    s_waitcnt lgkmcnt(6)
    v_mfma_f32_32x32x16_bf16 v[144:159], v[80:83], v[176:179], v[144:159]
    s_add_u32 m0, s75, 2048
    s_nop 0
    buffer_load_dwordx4 v222, s[4:7], s74 offen sc1 lds
    s_add_u32 s74, s74, 65536
    v_mul_f32 v214, v214, v198
    v_mul_f32 v206, v206, v216
    v_exp_f32 v214, v214
    ds_read_b64 v[168:169], v229 offset:32768
    ds_read_b64 v[170:171], v229 offset:33024
    s_waitcnt lgkmcnt(6)
    v_mfma_f32_32x32x16_bf16 v[144:159], v[84:87], v[180:183], v[144:159]
    v_mul_f32 v199, v199, v216
    v_mul_f32 v215, v199, v199
    v_fmaak_f32 v215, v215, v220, 0xc0135761
    v_mul_f32 v215, v215, v199
    ds_read_b64 v[172:173], v229 offset:33792
    ds_read_b64 v[174:175], v229 offset:34048
    s_waitcnt lgkmcnt(6)
    v_mfma_f32_32x32x16_bf16 v[144:159], v[88:91], v[160:163], v[144:159]
    v_mul_f32 v207, v207, v216
    v_exp_f32 v215, v215
    v_mul_f32 v192, v192, v200
    ds_read_b64 v[176:177], v229 offset:34816
    ds_read_b64 v[178:179], v229 offset:35072
    s_waitcnt lgkmcnt(6)
    v_mfma_f32_32x32x16_bf16 v[144:159], v[92:95], v[164:167], v[144:159]
    s_add_u32 m0, s75, 3072
    s_nop 0
    buffer_load_dwordx4 v222, s[4:7], s74 offen sc1 lds
    v_add_f32 v208, 1.0, v208
    v_rcp_f32 v208, v208
    v_mul_f32 v193, v193, v201
    v_add_f32 v209, 1.0, v209
    ds_read_b64 v[180:181], v229 offset:35840
    ds_read_b64 v[182:183], v229 offset:36096
    s_waitcnt lgkmcnt(6)
    v_mfma_f32_32x32x16_bf16 v[144:159], v[96:99], v[168:171], v[144:159]
    v_rcp_f32 v209, v209
    v_mul_f32 v194, v194, v202
    v_add_f32 v210, 1.0, v210
    ds_read_b64 v[160:161], v230 offset:32768
    ds_read_b64 v[162:163], v230 offset:33024
    s_waitcnt lgkmcnt(6)
    v_mfma_f32_32x32x16_bf16 v[144:159], v[100:103], v[172:175], v[144:159]
    v_rcp_f32 v210, v210
    v_mul_f32 v195, v195, v203
    v_add_f32 v211, 1.0, v211
    v_rcp_f32 v211, v211
    ds_read_b64 v[164:165], v230 offset:33792
    ds_read_b64 v[166:167], v230 offset:34048
    s_waitcnt lgkmcnt(6)
    v_mfma_f32_32x32x16_bf16 v[144:159], v[104:107], v[176:179], v[144:159]
    v_mul_f32 v196, v196, v204
    v_add_f32 v212, 1.0, v212
    v_rcp_f32 v212, v212
    ds_read_b64 v[168:169], v230 offset:34816
    ds_read_b64 v[170:171], v230 offset:35072
    s_waitcnt lgkmcnt(6)
    v_mfma_f32_32x32x16_bf16 v[144:159], v[108:111], v[180:183], v[144:159]
    v_mul_f32 v197, v197, v205
    v_add_f32 v213, 1.0, v213
    v_rcp_f32 v213, v213
    v_mul_f32 v198, v198, v206
    ds_read_b64 v[172:173], v230 offset:35840
    ds_read_b64 v[174:175], v230 offset:36096
    s_waitcnt lgkmcnt(6)
    v_mfma_f32_32x32x16_bf16 v[144:159], v[112:115], v[160:163], v[144:159]
    v_add_f32 v214, 1.0, v214
    v_rcp_f32 v214, v214
    v_mul_f32 v199, v199, v207
    ds_read_b64 v[176:177], v231 offset:32768
    ds_read_b64 v[178:179], v231 offset:33024
    s_waitcnt lgkmcnt(6)
    v_mfma_f32_32x32x16_bf16 v[144:159], v[116:119], v[164:167], v[144:159]
    v_add_f32 v215, 1.0, v215
    v_rcp_f32 v215, v215
    v_mul_f32 v192, v192, v208
    v_mul_f32 v193, v193, v209
    ds_read_b64 v[180:181], v231 offset:33792
    ds_read_b64 v[182:183], v231 offset:34048
    s_waitcnt lgkmcnt(6)
    v_mfma_f32_32x32x16_bf16 v[144:159], v[120:123], v[168:171], v[144:159]
    v_mul_f32 v194, v194, v210
    v_mul_f32 v195, v195, v211
    v_mul_f32 v196, v196, v212
    ds_read_b64 v[160:161], v231 offset:34816
    ds_read_b64 v[162:163], v231 offset:35072
    s_waitcnt lgkmcnt(6)
    v_mfma_f32_32x32x16_bf16 v[144:159], v[124:127], v[172:175], v[144:159]
    v_mul_f32 v197, v197, v213
    v_mul_f32 v198, v198, v214
    v_mul_f32 v199, v199, v215
    v_cvt_pk_bf16_f32 v232, v192, v193
    ds_read_b64 v[164:165], v231 offset:35840
    ds_read_b64 v[166:167], v231 offset:36096
    s_waitcnt lgkmcnt(6)
    v_mfma_f32_32x32x16_bf16 v[144:159], v[128:131], v[176:179], v[144:159]
    v_cvt_pk_bf16_f32 v233, v194, v195
    v_cvt_pk_bf16_f32 v234, v196, v197
    v_cvt_pk_bf16_f32 v235, v198, v199
    s_waitcnt lgkmcnt(4)
    v_mfma_f32_32x32x16_bf16 v[144:159], v[132:135], v[180:183], v[144:159]
    v_lshlrev_b32 v7, 4, v1
    v_permlane32_swap_b32 v232, v234
    v_permlane32_swap_b32 v233, v235
    buffer_store_dwordx4 v[232:235], v7, s[4:7], s69 offen sc1
    s_waitcnt lgkmcnt(2)
    v_mfma_f32_32x32x16_bf16 v[144:159], v[136:139], v[160:163], v[144:159]
    s_waitcnt lgkmcnt(0)
    v_mfma_f32_32x32x16_bf16 v[144:159], v[140:143], v[164:167], v[144:159]
    s_waitcnt lgkmcnt(0)
L_m_P246_join:
    s_waitcnt vmcnt(5)
    s_barrier
    v_add_u32 v224, 0x10000, v224
    v_add_u32 v225, 0x10000, v225
    v_add_u32 v226, 0x10000, v226
    v_add_u32 v227, 0x10000, v227
    v_add_u32 v228, 0x10000, v228
    v_add_u32 v229, 0x10000, v229
    v_add_u32 v230, 0x10000, v230
    v_add_u32 v231, 0x10000, v231
    s_and_b32 s48, s2, 7
    s_lshr_b32 s53, s2, 5
    s_lshl_b32 s53, s53, 3
    s_add_u32 s48, s48, s53
    s_bfe_u32 s49, s2, 0x20003
    s_and_b32 s50, s3, 3
    s_lshr_b32 s51, s3, 2
    s_lshl_b32 s52, s49, 2
    s_add_u32 s52, s52, s50
    s_mul_i32 s53, s52, 86
    s_mul_i32 s54, s51, 43
    s_add_u32 s53, s53, s54
    s_lshl_b32 s53, s53, 10
    s_cmp_eq_u32 s93, 0
    s_cselect_b32 s70, 0, 2097152
    s_add_u32 s70, s70, 24117248
    s_add_u32 s70, s70, s53
    v_lshlrev_b32 v222, 4, v1
    ds_read_b64 v[160:161], v224 offset:0
    ds_read_b64 v[162:163], v224 offset:256
    ds_read_b64 v[164:165], v224 offset:1024
    ds_read_b64 v[166:167], v224 offset:1280
    ds_read_b64 v[168:169], v224 offset:2048
    ds_read_b64 v[170:171], v224 offset:2304
    v_mov_b32 v218, 0
    v_mov_b32 v219, 0
    ds_read_b64 v[172:173], v224 offset:3072
    ds_read_b64 v[174:175], v224 offset:3328
    s_waitcnt lgkmcnt(6)
    v_mfma_f32_32x32x16_bf16 v[192:207], v[16:19], v[160:163], 0
    v_and_b32 v6, v221, v160
    v_dot2c_f32_bf16 v218, v6, v6
    v_dot2c_f32_bf16 v219, v161, v161
    v_dot2c_f32_bf16 v218, v162, v162
    v_dot2c_f32_bf16 v219, v163, v163
    ds_read_b128 v[236:239], v245 offset:1024
    ds_read_b128 v[240:243], v245 offset:1040
    s_add_u32 s69, s67, 1
    ds_read_b64 v[176:177], v225 offset:0
    ds_read_b64 v[178:179], v225 offset:256
    s_waitcnt lgkmcnt(8)
    v_mfma_f32_32x32x16_bf16 v[192:207], v[20:23], v[164:167], v[192:207]
    buffer_load_dwordx4 v[16:19], v222, s[4:7], s70 offen offset:0 sc1
    v_dot2c_f32_bf16 v218, v164, v164
    v_dot2c_f32_bf16 v219, v165, v165
    v_dot2c_f32_bf16 v218, v166, v166
    v_dot2c_f32_bf16 v219, v167, v167
    s_mul_i32 s69, s69, 86
    s_add_u32 s69, s69, s66
    s_lshl_b32 s69, s69, 10
    ds_read_b64 v[180:181], v225 offset:1024
    ds_read_b64 v[182:183], v225 offset:1280
    s_waitcnt lgkmcnt(8)
    v_mfma_f32_32x32x16_bf16 v[192:207], v[24:27], v[168:171], v[192:207]
    v_dot2c_f32_bf16 v218, v168, v168
    v_dot2c_f32_bf16 v219, v169, v169
    v_dot2c_f32_bf16 v218, v170, v170
    v_dot2c_f32_bf16 v219, v171, v171
    s_add_u32 s69, s69, s44
    s_or_b32 s69, s69, s71
    s_waitcnt lgkmcnt(4)
    v_pk_add_f32 v[236:237], v[236:237], v[238:239]
    ds_read_b64 v[160:161], v225 offset:2048
    ds_read_b64 v[162:163], v225 offset:2304
    v_mfma_f32_32x32x16_bf16 v[192:207], v[28:31], v[172:175], v[192:207]
    buffer_load_dwordx4 v[20:23], v222, s[4:7], s70 offen offset:1024 sc1
    v_dot2c_f32_bf16 v218, v172, v172
    v_dot2c_f32_bf16 v219, v173, v173
    v_dot2c_f32_bf16 v218, v174, v174
    v_dot2c_f32_bf16 v219, v175, v175
    v_pk_add_f32 v[240:241], v[240:241], v[242:243]
    v_pk_add_f32 v[236:237], v[236:237], v[240:241]
    v_add_f32 v236, v236, v237
    ds_read_b64 v[164:165], v225 offset:3072
    ds_read_b64 v[166:167], v225 offset:3328
    s_waitcnt lgkmcnt(6)
    v_mfma_f32_32x32x16_bf16 v[192:207], v[32:35], v[176:179], v[192:207]
    buffer_load_dwordx4 v[24:27], v222, s[4:7], s70 offen offset:2048 sc1
    v_mov_b32 v237, 0x3727c5ac
    v_fma_f32 v236, v236, s60, v237
    v_rsq_f32 v216, v236
    s_nop 0
    v_mul_f32 v144, v144, v216
    ds_read_b64 v[168:169], v226 offset:0
    ds_read_b64 v[170:171], v226 offset:256
    s_waitcnt lgkmcnt(6)
    v_mfma_f32_32x32x16_bf16 v[192:207], v[36:39], v[180:183], v[192:207]
    v_add_f32 v6, v218, v219
    v_mov_b32 v8, v6
    s_nop 1
    v_permlane32_swap_b32 v6, v8
    v_add_f32 v6, v6, v8
    ds_write_b32 v244, v6 offset:0
    v_mul_f32 v208, v144, v144
    v_fmaak_f32 v208, v208, v220, 0xc0135761
    v_mul_f32 v208, v208, v144
    ds_read_b64 v[172:173], v226 offset:1024
    ds_read_b64 v[174:175], v226 offset:1280
    s_waitcnt lgkmcnt(7)
    v_mfma_f32_32x32x16_bf16 v[192:207], v[40:43], v[160:163], v[192:207]
    buffer_load_dwordx4 v[28:31], v222, s[4:7], s70 offen offset:3072 sc1
    s_add_u32 s70, s70, 4096
    v_mul_f32 v152, v152, v216
    v_exp_f32 v208, v208
    v_mul_f32 v145, v145, v216
    v_mul_f32 v209, v145, v145
    ds_read_b64 v[176:177], v226 offset:2048
    ds_read_b64 v[178:179], v226 offset:2304
    s_waitcnt lgkmcnt(7)
    v_mfma_f32_32x32x16_bf16 v[192:207], v[44:47], v[164:167], v[192:207]
    buffer_load_dwordx4 v[32:35], v222, s[4:7], s70 offen offset:0 sc1
    v_fmaak_f32 v209, v209, v220, 0xc0135761
    v_mul_f32 v209, v209, v145
    v_mul_f32 v153, v153, v216
    ds_read_b64 v[180:181], v226 offset:3072
    ds_read_b64 v[182:183], v226 offset:3328
    s_waitcnt lgkmcnt(7)
    v_mfma_f32_32x32x16_bf16 v[192:207], v[48:51], v[168:171], v[192:207]
    v_exp_f32 v209, v209
    v_mul_f32 v146, v146, v216
    v_mul_f32 v210, v146, v146
    v_fmaak_f32 v210, v210, v220, 0xc0135761
    ds_read_b64 v[160:161], v227 offset:0
    ds_read_b64 v[162:163], v227 offset:256
    s_waitcnt lgkmcnt(6)
    v_mfma_f32_32x32x16_bf16 v[192:207], v[52:55], v[172:175], v[192:207]
    buffer_load_dwordx4 v[36:39], v222, s[4:7], s70 offen offset:1024 sc1
    v_mul_f32 v210, v210, v146
    v_mul_f32 v154, v154, v216
    v_exp_f32 v210, v210
    ds_read_b64 v[164:165], v227 offset:1024
    ds_read_b64 v[166:167], v227 offset:1280
    s_waitcnt lgkmcnt(6)
    v_mfma_f32_32x32x16_bf16 v[192:207], v[56:59], v[176:179], v[192:207]
    v_mul_f32 v147, v147, v216
    v_mul_f32 v211, v147, v147
    v_fmaak_f32 v211, v211, v220, 0xc0135761
    v_mul_f32 v211, v211, v147
    ds_read_b64 v[168:169], v227 offset:2048
    ds_read_b64 v[170:171], v227 offset:2304
    s_waitcnt lgkmcnt(6)
    v_mfma_f32_32x32x16_bf16 v[192:207], v[60:63], v[180:183], v[192:207]
    buffer_load_dwordx4 v[40:43], v222, s[4:7], s70 offen offset:2048 sc1
    v_mul_f32 v155, v155, v216
    v_exp_f32 v211, v211
    v_mul_f32 v148, v148, v216
    ds_read_b64 v[172:173], v227 offset:3072
    ds_read_b64 v[174:175], v227 offset:3328
    s_waitcnt lgkmcnt(6)
    v_mfma_f32_32x32x16_bf16 v[192:207], v[64:67], v[160:163], v[192:207]
    buffer_load_dwordx4 v[44:47], v222, s[4:7], s70 offen offset:3072 sc1
    s_add_u32 s70, s70, 4096
    v_mul_f32 v212, v148, v148
    v_fmaak_f32 v212, v212, v220, 0xc0135761
    v_mul_f32 v212, v212, v148
    v_mul_f32 v156, v156, v216
    ds_read_b64 v[176:177], v228 offset:0
    ds_read_b64 v[178:179], v228 offset:256
    s_waitcnt lgkmcnt(6)
    v_mfma_f32_32x32x16_bf16 v[192:207], v[68:71], v[164:167], v[192:207]
    v_exp_f32 v212, v212
    v_mul_f32 v149, v149, v216
    v_mul_f32 v213, v149, v149
    ds_read_b64 v[180:181], v228 offset:1024
    ds_read_b64 v[182:183], v228 offset:1280
    s_waitcnt lgkmcnt(6)
    v_mfma_f32_32x32x16_bf16 v[192:207], v[72:75], v[168:171], v[192:207]
    buffer_load_dwordx4 v[48:51], v222, s[4:7], s70 offen offset:0 sc1
    v_fmaak_f32 v213, v213, v220, 0xc0135761
    v_mul_f32 v213, v213, v149
    v_mul_f32 v157, v157, v216
    v_exp_f32 v213, v213
    ds_read_b64 v[160:161], v228 offset:2048
    ds_read_b64 v[162:163], v228 offset:2304
    s_waitcnt lgkmcnt(6)
    v_mfma_f32_32x32x16_bf16 v[192:207], v[76:79], v[172:175], v[192:207]
    buffer_load_dwordx4 v[52:55], v222, s[4:7], s70 offen offset:1024 sc1
    v_mul_f32 v150, v150, v216
    v_mul_f32 v214, v150, v150
    v_fmaak_f32 v214, v214, v220, 0xc0135761
    ds_read_b64 v[164:165], v228 offset:3072
    ds_read_b64 v[166:167], v228 offset:3328
    s_waitcnt lgkmcnt(6)
    v_mfma_f32_32x32x16_bf16 v[192:207], v[80:83], v[176:179], v[192:207]
    v_mul_f32 v214, v214, v150
    v_mul_f32 v158, v158, v216
    v_exp_f32 v214, v214
    ds_read_b64 v[168:169], v229 offset:0
    ds_read_b64 v[170:171], v229 offset:256
    s_waitcnt lgkmcnt(6)
    v_mfma_f32_32x32x16_bf16 v[192:207], v[84:87], v[180:183], v[192:207]
    buffer_load_dwordx4 v[56:59], v222, s[4:7], s70 offen offset:2048 sc1
    v_mul_f32 v151, v151, v216
    v_mul_f32 v215, v151, v151
    v_fmaak_f32 v215, v215, v220, 0xc0135761
    v_mul_f32 v215, v215, v151
    ds_read_b64 v[172:173], v229 offset:1024
    ds_read_b64 v[174:175], v229 offset:1280
    s_waitcnt lgkmcnt(6)
    v_mfma_f32_32x32x16_bf16 v[192:207], v[88:91], v[160:163], v[192:207]
    v_mul_f32 v159, v159, v216
    v_exp_f32 v215, v215
    v_mul_f32 v144, v144, v152
    ds_read_b64 v[176:177], v229 offset:2048
    ds_read_b64 v[178:179], v229 offset:2304
    s_waitcnt lgkmcnt(6)
    v_mfma_f32_32x32x16_bf16 v[192:207], v[92:95], v[164:167], v[192:207]
    buffer_load_dwordx4 v[60:63], v222, s[4:7], s70 offen offset:3072 sc1
    s_add_u32 s70, s70, 4096
    v_add_f32 v208, 1.0, v208
    v_rcp_f32 v208, v208
    v_mul_f32 v145, v145, v153
    v_add_f32 v209, 1.0, v209
    ds_read_b64 v[180:181], v229 offset:3072
    ds_read_b64 v[182:183], v229 offset:3328
    s_waitcnt lgkmcnt(6)
    v_mfma_f32_32x32x16_bf16 v[192:207], v[96:99], v[168:171], v[192:207]
    buffer_load_dwordx4 v[64:67], v222, s[4:7], s70 offen offset:0 sc1
    v_rcp_f32 v209, v209
    v_mul_f32 v146, v146, v154
    v_add_f32 v210, 1.0, v210
    ds_read_b64 v[160:161], v230 offset:0
    ds_read_b64 v[162:163], v230 offset:256
    s_waitcnt lgkmcnt(6)
    v_mfma_f32_32x32x16_bf16 v[192:207], v[100:103], v[172:175], v[192:207]
    v_rcp_f32 v210, v210
    v_mul_f32 v147, v147, v155
    v_add_f32 v211, 1.0, v211
    v_rcp_f32 v211, v211
    ds_read_b64 v[164:165], v230 offset:1024
    ds_read_b64 v[166:167], v230 offset:1280
    s_waitcnt lgkmcnt(6)
    v_mfma_f32_32x32x16_bf16 v[192:207], v[104:107], v[176:179], v[192:207]
    buffer_load_dwordx4 v[68:71], v222, s[4:7], s70 offen offset:1024 sc1
    v_mul_f32 v148, v148, v156
    v_add_f32 v212, 1.0, v212
    v_rcp_f32 v212, v212
    ds_read_b64 v[168:169], v230 offset:2048
    ds_read_b64 v[170:171], v230 offset:2304
    s_waitcnt lgkmcnt(6)
    v_mfma_f32_32x32x16_bf16 v[192:207], v[108:111], v[180:183], v[192:207]
    buffer_load_dwordx4 v[72:75], v222, s[4:7], s70 offen offset:2048 sc1
    v_mul_f32 v149, v149, v157
    v_add_f32 v213, 1.0, v213
    v_rcp_f32 v213, v213
    v_mul_f32 v150, v150, v158
    ds_read_b64 v[172:173], v230 offset:3072
    ds_read_b64 v[174:175], v230 offset:3328
    s_waitcnt lgkmcnt(6)
    v_mfma_f32_32x32x16_bf16 v[192:207], v[112:115], v[160:163], v[192:207]
    v_add_f32 v214, 1.0, v214
    v_rcp_f32 v214, v214
    v_mul_f32 v151, v151, v159
    ds_read_b64 v[176:177], v231 offset:0
    ds_read_b64 v[178:179], v231 offset:256
    s_waitcnt lgkmcnt(6)
    v_mfma_f32_32x32x16_bf16 v[192:207], v[116:119], v[164:167], v[192:207]
    buffer_load_dwordx4 v[76:79], v222, s[4:7], s70 offen offset:3072 sc1
    s_add_u32 s70, s70, 4096
    v_add_f32 v215, 1.0, v215
    v_rcp_f32 v215, v215
    v_mul_f32 v144, v144, v208
    v_mul_f32 v145, v145, v209
    ds_read_b64 v[180:181], v231 offset:1024
    ds_read_b64 v[182:183], v231 offset:1280
    s_waitcnt lgkmcnt(6)
    v_mfma_f32_32x32x16_bf16 v[192:207], v[120:123], v[168:171], v[192:207]
    v_mul_f32 v146, v146, v210
    v_mul_f32 v147, v147, v211
    v_mul_f32 v148, v148, v212
    ds_read_b64 v[160:161], v231 offset:2048
    ds_read_b64 v[162:163], v231 offset:2304
    s_waitcnt lgkmcnt(6)
    v_mfma_f32_32x32x16_bf16 v[192:207], v[124:127], v[172:175], v[192:207]
    buffer_load_dwordx4 v[80:83], v222, s[4:7], s70 offen offset:0 sc1
    v_mul_f32 v149, v149, v213
    v_mul_f32 v150, v150, v214
    v_mul_f32 v151, v151, v215
    v_cvt_pk_bf16_f32 v232, v144, v145
    ds_read_b64 v[164:165], v231 offset:3072
    ds_read_b64 v[166:167], v231 offset:3328
    s_waitcnt lgkmcnt(6)
    v_mfma_f32_32x32x16_bf16 v[192:207], v[128:131], v[176:179], v[192:207]
    buffer_load_dwordx4 v[84:87], v222, s[4:7], s70 offen offset:1024 sc1
    v_cvt_pk_bf16_f32 v233, v146, v147
    v_cvt_pk_bf16_f32 v234, v148, v149
    v_cvt_pk_bf16_f32 v235, v150, v151
    s_waitcnt lgkmcnt(4)
    v_mfma_f32_32x32x16_bf16 v[192:207], v[132:135], v[180:183], v[192:207]
    v_lshlrev_b32 v7, 4, v1
    v_permlane32_swap_b32 v232, v234
    v_permlane32_swap_b32 v233, v235
    buffer_store_dwordx4 v[232:235], v7, s[4:7], s69 offen sc1
    s_waitcnt lgkmcnt(2)
    v_mfma_f32_32x32x16_bf16 v[192:207], v[136:139], v[160:163], v[192:207]
    buffer_load_dwordx4 v[88:91], v222, s[4:7], s70 offen offset:2048 sc1
    s_waitcnt lgkmcnt(0)
    v_mfma_f32_32x32x16_bf16 v[192:207], v[140:143], v[164:167], v[192:207]
    buffer_load_dwordx4 v[92:95], v222, s[4:7], s70 offen offset:3072 sc1
    s_add_u32 s70, s70, 4096
    s_waitcnt lgkmcnt(0)
    s_barrier
    s_add_u32 s67, s67, 2
    s_mov_b32 s72, 1
    s_nop 4
    s_branch L_m_P246_fin
L_m_P246_one:
    s_barrier
L_m_P246_fin:
    ds_read_b128 v[236:239], v245 offset:0
    ds_read_b128 v[240:243], v245 offset:16
    s_add_u32 s69, s67, 0
    s_mul_i32 s69, s69, 86
    s_add_u32 s69, s69, s66
    s_lshl_b32 s69, s69, 10
    s_add_u32 s69, s69, s44
    s_or_b32 s69, s69, s71
    s_waitcnt lgkmcnt(0)
    v_pk_add_f32 v[236:237], v[236:237], v[238:239]
    v_pk_add_f32 v[240:241], v[240:241], v[242:243]
    v_pk_add_f32 v[236:237], v[236:237], v[240:241]
    v_add_f32 v236, v236, v237
    v_mov_b32 v237, 0x3727c5ac
    v_fma_f32 v236, v236, s60, v237
    v_rsq_f32 v216, v236
    s_nop 0
    v_mul_f32 v192, v192, v216
    v_mul_f32 v208, v192, v192
    v_fmaak_f32 v208, v208, v220, 0xc0135761
    v_mul_f32 v208, v208, v192
    v_mul_f32 v200, v200, v216
    v_exp_f32 v208, v208
    v_mul_f32 v193, v193, v216
    v_mul_f32 v209, v193, v193
    v_fmaak_f32 v209, v209, v220, 0xc0135761
    v_mul_f32 v209, v209, v193
    v_mul_f32 v201, v201, v216
    v_exp_f32 v209, v209
    v_mul_f32 v194, v194, v216
    v_mul_f32 v210, v194, v194
    v_fmaak_f32 v210, v210, v220, 0xc0135761
    v_mul_f32 v210, v210, v194
    v_mul_f32 v202, v202, v216
    v_exp_f32 v210, v210
    v_mul_f32 v195, v195, v216
    v_mul_f32 v211, v195, v195
    v_fmaak_f32 v211, v211, v220, 0xc0135761
    v_mul_f32 v211, v211, v195
    v_mul_f32 v203, v203, v216
    v_exp_f32 v211, v211
    v_mul_f32 v196, v196, v216
    v_mul_f32 v212, v196, v196
    v_fmaak_f32 v212, v212, v220, 0xc0135761
    v_mul_f32 v212, v212, v196
    v_mul_f32 v204, v204, v216
    v_exp_f32 v212, v212
    v_mul_f32 v197, v197, v216
    v_mul_f32 v213, v197, v197
    v_fmaak_f32 v213, v213, v220, 0xc0135761
    v_mul_f32 v213, v213, v197
    v_mul_f32 v205, v205, v216
    v_exp_f32 v213, v213
    v_mul_f32 v198, v198, v216
    v_mul_f32 v214, v198, v198
    v_fmaak_f32 v214, v214, v220, 0xc0135761
    v_mul_f32 v214, v214, v198
    v_mul_f32 v206, v206, v216
    v_exp_f32 v214, v214
    v_mul_f32 v199, v199, v216
    v_mul_f32 v215, v199, v199
    v_fmaak_f32 v215, v215, v220, 0xc0135761
    v_mul_f32 v215, v215, v199
    v_mul_f32 v207, v207, v216
    v_exp_f32 v215, v215
    v_mul_f32 v192, v192, v200
    v_add_f32 v208, 1.0, v208
    v_rcp_f32 v208, v208
    v_mul_f32 v193, v193, v201
    v_add_f32 v209, 1.0, v209
    v_rcp_f32 v209, v209
    v_mul_f32 v194, v194, v202
    v_add_f32 v210, 1.0, v210
    v_rcp_f32 v210, v210
    v_mul_f32 v195, v195, v203
    v_add_f32 v211, 1.0, v211
    v_rcp_f32 v211, v211
    v_mul_f32 v196, v196, v204
    v_add_f32 v212, 1.0, v212
    v_rcp_f32 v212, v212
    v_mul_f32 v197, v197, v205
    v_add_f32 v213, 1.0, v213
    v_rcp_f32 v213, v213
    v_mul_f32 v198, v198, v206
    v_add_f32 v214, 1.0, v214
    v_rcp_f32 v214, v214
    v_mul_f32 v199, v199, v207
    v_add_f32 v215, 1.0, v215
    v_rcp_f32 v215, v215
    v_mul_f32 v192, v192, v208
    v_mul_f32 v193, v193, v209
    v_mul_f32 v194, v194, v210
    v_mul_f32 v195, v195, v211
    v_mul_f32 v196, v196, v212
    v_mul_f32 v197, v197, v213
    v_mul_f32 v198, v198, v214
    v_mul_f32 v199, v199, v215
    v_cvt_pk_bf16_f32 v232, v192, v193
    v_cvt_pk_bf16_f32 v233, v194, v195
    v_cvt_pk_bf16_f32 v234, v196, v197
    v_cvt_pk_bf16_f32 v235, v198, v199
    v_lshlrev_b32 v7, 4, v1
    v_permlane32_swap_b32 v232, v234
    v_permlane32_swap_b32 v233, v235
    buffer_store_dwordx4 v[232:235], v7, s[4:7], s69 offen sc1
L_m_P246_idle:
    s_cmp_eq_u32 s72, 1
    s_cbranch_scc1 L_m_GT47_h
    s_and_b32 s48, s2, 7
    s_lshr_b32 s53, s2, 5
    s_lshl_b32 s53, s53, 3
    s_add_u32 s48, s48, s53
    s_bfe_u32 s49, s2, 0x20003
    s_and_b32 s50, s3, 3
    s_lshr_b32 s51, s3, 2
    s_lshl_b32 s52, s49, 2
    s_add_u32 s52, s52, s50
    s_mul_i32 s53, s52, 86
    s_mul_i32 s54, s51, 43
    s_add_u32 s53, s53, s54
    s_lshl_b32 s53, s53, 10
    s_cmp_eq_u32 s93, 0
    s_cselect_b32 s70, 0, 2097152
    s_add_u32 s70, s70, 24117248
    s_add_u32 s70, s70, s53
L_m_GT47_h:
    s_cmp_eq_u32 s93, 0
    s_cbranch_scc1 L_m_GT47_p
    s_lshl_b32 s53, s52, 5
    v_add_u32 v6, s53, v2
    v_cvt_f32_u32 v7, v6
    v_mul_f32 v7, 0x3b000000, v7
    s_lshl_b32 s53, s51, 7
    s_sub_u32 s53, s53, 8
    v_lshl_add_u32 v14, v3, 2, s53
    v_cvt_f32_i32 v14, v14
    v_mul_f32 v14, v7, v14
    v_mul_f32 v253, 0x41000000, v7
    v_fract_f32 v254, v253
    v_cos_f32 v252, v254
    v_mov_b32 v254, v14
    v_add_f32 v252, v252, v252
    v_fract_f32 v236, v254
    v_add_f32 v244, v254, v253
    v_fract_f32 v244, v244
    v_add_f32 v255, 0x3e800000, v254
    v_fract_f32 v237, v255
    v_add_f32 v245, v255, v253
    v_fract_f32 v245, v245
    v_add_f32 v254, v254, v7
    v_fract_f32 v238, v254
    v_add_f32 v246, v254, v253
    v_fract_f32 v246, v246
    v_add_f32 v255, 0x3e800000, v254
    v_fract_f32 v239, v255
    v_add_f32 v247, v255, v253
    v_fract_f32 v247, v247
    v_add_f32 v254, v254, v7
    v_fract_f32 v240, v254
    v_add_f32 v248, v254, v253
    v_fract_f32 v248, v248
    v_add_f32 v255, 0x3e800000, v254
    v_fract_f32 v241, v255
    v_add_f32 v249, v255, v253
    v_fract_f32 v249, v249
    v_add_f32 v254, v254, v7
    v_fract_f32 v242, v254
    v_add_f32 v250, v254, v253
    v_fract_f32 v250, v250
    v_add_f32 v255, 0x3e800000, v254
    v_fract_f32 v243, v255
    v_add_f32 v251, v255, v253
    v_fract_f32 v251, v251
    v_cos_f32 v236, v236
    v_cos_f32 v244, v244
    v_cos_f32 v237, v237
    v_cos_f32 v245, v245
    v_cos_f32 v238, v238
    v_cos_f32 v246, v246
    v_cos_f32 v239, v239
    v_cos_f32 v247, v247
    v_cos_f32 v240, v240
    v_cos_f32 v248, v248
    v_cos_f32 v241, v241
    v_cos_f32 v249, v249
    v_cos_f32 v242, v242
    v_cos_f32 v250, v250
    v_cos_f32 v243, v243
    v_cos_f32 v251, v251
    v_mul_f32 v236, 0x3d800000, v236
    v_mul_f32 v244, 0x3d800000, v244
    v_mul_f32 v237, 0x3d800000, v237
    v_mul_f32 v245, 0x3d800000, v245
    v_mul_f32 v238, 0x3d800000, v238
    v_mul_f32 v246, 0x3d800000, v246
    v_mul_f32 v239, 0x3d800000, v239
    v_mul_f32 v247, 0x3d800000, v247
    v_mul_f32 v240, 0x3d800000, v240
    v_mul_f32 v248, 0x3d800000, v248
    v_mul_f32 v241, 0x3d800000, v241
    v_mul_f32 v249, 0x3d800000, v249
    v_mul_f32 v242, 0x3d800000, v242
    v_mul_f32 v250, 0x3d800000, v250
    v_mul_f32 v243, 0x3d800000, v243
    v_mul_f32 v251, 0x3d800000, v251
L_m_GT47_p:
    s_cmp_eq_u32 s76, 1
    s_cbranch_scc1 L_m_DP48
    s_waitcnt vmcnt(0)
    s_barrier
    s_cmp_eq_u32 s3, 0
    s_cbranch_scc0 L_m_PUB49
    s_add_u32 s91, s92, 1
    s_lshl_b32 s90, s2, 7
    s_add_u32 s90, s90, 31457280
    v_mov_b32 v8, s91
    v_mov_b32 v9, 0
    s_mov_b64 exec, 1
    buffer_store_dword v8, v9, s[4:7], s90 offen sc0 sc1
    s_mov_b64 exec, -1
L_m_PUB49:
    s_barrier
L_m_DP48:
    s_cmp_eq_u32 s93, 0
    s_nop 0
    s_cbranch_scc1 L_m_GX50_0
    s_cmp_eq_u32 s72, 1
    s_cbranch_scc1 L_m_GX50_e
    v_lshlrev_b32 v6, 14, v5
    v_lshl_add_u32 v6, v4, 4, v6
    s_lshl_b32 s62, s3, 18
    s_lshl_b32 s61, s48, 8
    s_add_u32 s62, s62, s61
    s_add_u32 s62, s62, s42
    s_lshl_b32 s61, s3, 12
    s_add_u32 s61, s61, 124928
    s_mov_b32 m0, s61
    s_nop 0
    buffer_load_dwordx4 v6, s[4:7], s62 offen sc1 lds
    s_add_u32 s61, s61, 1024
    s_add_u32 s62, s62, 65536
    s_mov_b32 m0, s61
    s_nop 0
    buffer_load_dwordx4 v6, s[4:7], s62 offen sc1 lds
    s_add_u32 s61, s61, 1024
    s_add_u32 s62, s62, 65536
    s_mov_b32 m0, s61
    s_nop 0
    buffer_load_dwordx4 v6, s[4:7], s62 offen sc1 lds
    s_add_u32 s61, s61, 1024
    s_add_u32 s62, s62, 65536
    s_mov_b32 m0, s61
    s_nop 0
    buffer_load_dwordx4 v6, s[4:7], s62 offen sc1 lds
    s_branch L_m_GX50_e
L_m_GX50_0:
    v_lshlrev_b32 v7, 14, v3
    v_lshl_add_u32 v7, v2, 3, v7
    s_lshl_b32 s56, s52, 1
    s_add_u32 s56, s56, s51
    s_lshl_b32 s56, s56, 16
    s_lshl_b32 s57, s48, 8
    s_add_u32 s56, s56, s57
    s_add_u32 s56, s56, s42
    buffer_load_dwordx2 v[224:225], v7, s[4:7], s56 offen sc1
    s_add_u32 s56, s56, 32768
    buffer_load_dwordx2 v[226:227], v7, s[4:7], s56 offen sc1
L_m_GX50_e:
    s_cmp_eq_u32 s72, 1
    s_cbranch_scc1 L_m_GT47_fin
    v_lshlrev_b32 v6, 4, v1
    buffer_load_dwordx4 v[16:19], v6, s[4:7], s70 offen offset:0 sc1
    buffer_load_dwordx4 v[20:23], v6, s[4:7], s70 offen offset:1024 sc1
    buffer_load_dwordx4 v[24:27], v6, s[4:7], s70 offen offset:2048 sc1
    buffer_load_dwordx4 v[28:31], v6, s[4:7], s70 offen offset:3072 sc1
    s_add_u32 s70, s70, 4096
    buffer_load_dwordx4 v[32:35], v6, s[4:7], s70 offen offset:0 sc1
    buffer_load_dwordx4 v[36:39], v6, s[4:7], s70 offen offset:1024 sc1
    buffer_load_dwordx4 v[40:43], v6, s[4:7], s70 offen offset:2048 sc1
    buffer_load_dwordx4 v[44:47], v6, s[4:7], s70 offen offset:3072 sc1
    s_add_u32 s70, s70, 4096
    buffer_load_dwordx4 v[48:51], v6, s[4:7], s70 offen offset:0 sc1
    buffer_load_dwordx4 v[52:55], v6, s[4:7], s70 offen offset:1024 sc1
    buffer_load_dwordx4 v[56:59], v6, s[4:7], s70 offen offset:2048 sc1
    buffer_load_dwordx4 v[60:63], v6, s[4:7], s70 offen offset:3072 sc1
    s_add_u32 s70, s70, 4096
    buffer_load_dwordx4 v[64:67], v6, s[4:7], s70 offen offset:0 sc1
    buffer_load_dwordx4 v[68:71], v6, s[4:7], s70 offen offset:1024 sc1
    buffer_load_dwordx4 v[72:75], v6, s[4:7], s70 offen offset:2048 sc1
    buffer_load_dwordx4 v[76:79], v6, s[4:7], s70 offen offset:3072 sc1
    s_add_u32 s70, s70, 4096
    s_waitcnt vmcnt(15)
    buffer_load_dwordx4 v[80:83], v6, s[4:7], s70 offen offset:0 sc1
    s_waitcnt vmcnt(15)
    buffer_load_dwordx4 v[84:87], v6, s[4:7], s70 offen offset:1024 sc1
    s_waitcnt vmcnt(15)
    buffer_load_dwordx4 v[88:91], v6, s[4:7], s70 offen offset:2048 sc1
    s_waitcnt vmcnt(15)
    buffer_load_dwordx4 v[92:95], v6, s[4:7], s70 offen offset:3072 sc1
    s_add_u32 s70, s70, 4096
L_m_GT47_fin:
    s_cmp_eq_u32 s93, 0
    s_cbranch_scc0 L_m_GT47_end
    v_lshlrev_b32 v6, 4, v1
    buffer_load_dwordx4 v[96:99], v6, s[4:7], s70 offen offset:0 sc1
    buffer_load_dwordx4 v[100:103], v6, s[4:7], s70 offen offset:1024 sc1
    buffer_load_dwordx4 v[104:107], v6, s[4:7], s70 offen offset:2048 sc1
    buffer_load_dwordx4 v[108:111], v6, s[4:7], s70 offen offset:3072 sc1
    s_add_u32 s70, s70, 4096
    buffer_load_dwordx4 v[112:115], v6, s[4:7], s70 offen offset:0 sc1
    buffer_load_dwordx4 v[116:119], v6, s[4:7], s70 offen offset:1024 sc1
    buffer_load_dwordx4 v[120:123], v6, s[4:7], s70 offen offset:2048 sc1
    buffer_load_dwordx4 v[124:127], v6, s[4:7], s70 offen offset:3072 sc1
    s_add_u32 s70, s70, 4096
    buffer_load_dwordx4 v[128:131], v6, s[4:7], s70 offen offset:0 sc1
    buffer_load_dwordx4 v[132:135], v6, s[4:7], s70 offen offset:1024 sc1
    buffer_load_dwordx4 v[136:139], v6, s[4:7], s70 offen offset:2048 sc1
    buffer_load_dwordx4 v[140:143], v6, s[4:7], s70 offen offset:3072 sc1
    s_add_u32 s70, s70, 4096
    buffer_load_dwordx4 v[144:147], v6, s[4:7], s70 offen offset:0 sc1
    buffer_load_dwordx4 v[148:151], v6, s[4:7], s70 offen offset:1024 sc1
    buffer_load_dwordx4 v[152:155], v6, s[4:7], s70 offen offset:2048 sc1
    buffer_load_dwordx4 v[156:159], v6, s[4:7], s70 offen offset:3072 sc1
    s_add_u32 s70, s70, 4096
L_m_GT47_end:
    s_cmp_eq_u32 s93, 0
    s_cbranch_scc0 L_P6
    s_mul_i32 s88, s48, 21846
    s_lshr_b32 s88, s88, 16
    s_cmp_eq_u32 s3, 0
    s_cbranch_scc0 L_m_W51_skip
    s_add_u32 s91, s92, 1
    s_cmp_ge_u32 s88, 11
    s_cselect_b32 s86, 1, 0
    s_mul_i32 s87, s86, 11
    s_sub_u32 s87, s88, s87
    v_min_u32 v12, 10, v1
    v_mul_u32_u24 v13, 86, v12
    v_lshrrev_b32 v13, 8, v13
    v_mul_u32_u24 v14, 3, v13
    v_sub_u32 v14, v12, v14
    s_mul_i32 s85, s87, 3
    v_add_u32 v14, s85, v14
    v_lshlrev_b32 v15, 3, v14
    v_lshl_add_u32 v15, v13, 1, v15
    v_add_u32 v8, 22, v13
    v_lshlrev_b32 v8, 3, v8
    v_add_u32 v8, 6, v8
    v_cmp_eq_u32 vcc, 32, v14
    s_nop 1
    v_cndmask_b32 v15, v15, v8, vcc
    s_lshl_b32 s85, s87, 1
    v_add_u32 v8, s85, v12
    v_add_u32 v8, -9, v8
    v_lshlrev_b32 v8, 3, v8
    v_add_u32 v8, 6, v8
    v_cmp_le_u32 vcc, 9, v12
    s_nop 1
    v_cndmask_b32 v15, v15, v8, vcc
    v_add_u32 v12, s86, v15
    v_mov_b32 v13, 255
    v_cmp_eq_u32 vcc, 11, v1
    s_nop 1
    v_cndmask_b32 v12, v12, v13, vcc
    v_lshlrev_b32 v12, 7, v12
    s_add_u32 s87, s40, 4
    v_mov_b32 v13, s91
    v_mov_b32 v14, s87
    v_cndmask_b32 v13, v13, v14, vcc
    s_mov_b32 s90, 31457280
    s_mov_b32 s89, 0x40000
    v_mov_b32 v11, v13
L_m_W51_loop:
    buffer_load_dword v232, v12, s[4:7], s90 offen sc1
    s_waitcnt vmcnt(0)
    v_sub_u32 v8, v232, v11
    v_cmp_gt_u32 vcc, 16, v8
    s_cmp_eq_u64 vcc, exec
    s_nop 2
    s_cbranch_scc1 L_m_W51_skip
    s_sleep 1
    s_sub_u32 s89, s89, 1
    s_cmp_lg_u32 s89, 0
    s_cbranch_scc1 L_m_W51_loop
L_m_W51_skip:
    s_barrier
    s_mul_i32 s53, s48, 86
    s_mul_i32 s54, s51, 43
    s_add_u32 s53, s53, s54
    s_add_u32 s53, s53, s50
    s_lshl_b32 s53, s53, 10
    s_add_u32 s53, s53, s44
    s_add_u32 s54, s54, s50
    s_lshl_b32 s54, s54, 10
    v_lshlrev_b32 v6, 4, v1
    s_cmp_eq_u32 s50, 3
    s_cselect_b32 s55, 1024, 0
    s_add_u32 m0, s54, 0
    s_add_u32 s56, s53, 0
    buffer_load_dwordx4 v6, s[4:7], s56 offen sc1 lds
    s_add_u32 m0, s54, 4096
    s_add_u32 s56, s53, 4096
    buffer_load_dwordx4 v6, s[4:7], s56 offen sc1 lds
    s_add_u32 m0, s54, 8192
    s_add_u32 s56, s53, 8192
    buffer_load_dwordx4 v6, s[4:7], s56 offen sc1 lds
    s_add_u32 m0, s54, 12288
    s_add_u32 s56, s53, 12288
    buffer_load_dwordx4 v6, s[4:7], s56 offen sc1 lds
    s_mul_i32 s57, s51, 44032
    v_lshl_add_u32 v15, v1, 4, s57
    s_waitcnt vmcnt(0)
    s_barrier
    ds_read_b128 v[208:211], v15 offset:0
    ds_read_b128 v[212:215], v15 offset:1024
    ds_read_b128 v[216:219], v15 offset:2048
    ds_read_b128 v[220:223], v15 offset:3072
    s_waitcnt lgkmcnt(3)
    v_mfma_f32_32x32x16_bf16 v[192:207], v[16:19], v[208:211], 0
    s_add_u32 m0, s54, 16384
    s_add_u32 s56, s53, 16384
    buffer_load_dwordx4 v6, s[4:7], s56 offen sc1 lds
    ds_read_b128 v[208:211], v15 offset:4096
    s_waitcnt lgkmcnt(3)
    v_mfma_f32_32x32x16_bf16 v[192:207], v[20:23], v[212:215], v[192:207]
    s_add_u32 m0, s54, 20480
    s_add_u32 s56, s53, 20480
    buffer_load_dwordx4 v6, s[4:7], s56 offen sc1 lds
    ds_read_b128 v[212:215], v15 offset:5120
    s_waitcnt lgkmcnt(3)
    v_mfma_f32_32x32x16_bf16 v[192:207], v[24:27], v[216:219], v[192:207]
    s_add_u32 m0, s54, 24576
    s_add_u32 s56, s53, 24576
    buffer_load_dwordx4 v6, s[4:7], s56 offen sc1 lds
    ds_read_b128 v[216:219], v15 offset:6144
    s_waitcnt lgkmcnt(3)
    v_mfma_f32_32x32x16_bf16 v[192:207], v[28:31], v[220:223], v[192:207]
    s_add_u32 m0, s54, 28672
    s_add_u32 s56, s53, 28672
    buffer_load_dwordx4 v6, s[4:7], s56 offen sc1 lds
    ds_read_b128 v[220:223], v15 offset:7168
    s_waitcnt lgkmcnt(3)
    v_mfma_f32_32x32x16_bf16 v[192:207], v[32:35], v[208:211], v[192:207]
    s_add_u32 m0, s54, 32768
    s_add_u32 s56, s53, 32768
    buffer_load_dwordx4 v6, s[4:7], s56 offen sc1 lds
    ds_read_b128 v[208:211], v15 offset:8192
    s_waitcnt lgkmcnt(3)
    v_mfma_f32_32x32x16_bf16 v[192:207], v[36:39], v[212:215], v[192:207]
    s_add_u32 m0, s54, 36864
    s_add_u32 s56, s53, 36864
    buffer_load_dwordx4 v6, s[4:7], s56 offen sc1 lds
    ds_read_b128 v[212:215], v15 offset:9216
    s_waitcnt lgkmcnt(3)
    v_mfma_f32_32x32x16_bf16 v[192:207], v[40:43], v[216:219], v[192:207]
    s_sub_u32 s56, s53, s55
    s_sub_u32 s57, s54, s55
    s_add_u32 m0, s57, 40960
    s_add_u32 s56, s56, 40960
    buffer_load_dwordx4 v6, s[4:7], s56 offen sc1 lds
    ds_read_b128 v[216:219], v15 offset:10240
    s_waitcnt lgkmcnt(3)
    v_mfma_f32_32x32x16_bf16 v[192:207], v[44:47], v[220:223], v[192:207]
    ds_read_b128 v[220:223], v15 offset:11264
    s_waitcnt lgkmcnt(3)
    v_mfma_f32_32x32x16_bf16 v[192:207], v[48:51], v[208:211], v[192:207]
    ds_read_b128 v[208:211], v15 offset:12288
    s_waitcnt lgkmcnt(3)
    v_mfma_f32_32x32x16_bf16 v[192:207], v[52:55], v[212:215], v[192:207]
    buffer_load_dwordx4 v[160:163], v6, s[4:7], s70 offen offset:0 sc1
    ds_read_b128 v[212:215], v15 offset:13312
    s_waitcnt lgkmcnt(3)
    v_mfma_f32_32x32x16_bf16 v[192:207], v[56:59], v[216:219], v[192:207]
    buffer_load_dwordx4 v[164:167], v6, s[4:7], s70 offen offset:1024 sc1
    ds_read_b128 v[216:219], v15 offset:14336
    s_waitcnt lgkmcnt(3)
    v_mfma_f32_32x32x16_bf16 v[192:207], v[60:63], v[220:223], v[192:207]
    buffer_load_dwordx4 v[168:171], v6, s[4:7], s70 offen offset:2048 sc1
    ds_read_b128 v[220:223], v15 offset:15360
    s_waitcnt lgkmcnt(3)
    v_mfma_f32_32x32x16_bf16 v[192:207], v[64:67], v[208:211], v[192:207]
    buffer_load_dwordx4 v[172:175], v6, s[4:7], s70 offen offset:3072 sc1
    s_waitcnt lgkmcnt(2)
    v_mfma_f32_32x32x16_bf16 v[192:207], v[68:71], v[212:215], v[192:207]
    s_add_u32 s70, s70, 4096
    buffer_load_dwordx4 v[176:179], v6, s[4:7], s70 offen offset:0 sc1
    s_waitcnt lgkmcnt(1)
    v_mfma_f32_32x32x16_bf16 v[192:207], v[72:75], v[216:219], v[192:207]
    buffer_load_dwordx4 v[180:183], v6, s[4:7], s70 offen offset:1024 sc1
    s_waitcnt lgkmcnt(0)
    v_mfma_f32_32x32x16_bf16 v[192:207], v[76:79], v[220:223], v[192:207]
    buffer_load_dwordx4 v[184:187], v6, s[4:7], s70 offen offset:2048 sc1
    s_waitcnt vmcnt(10)
    s_barrier
    ds_read_b128 v[208:211], v15 offset:16384
    ds_read_b128 v[212:215], v15 offset:17408
    ds_read_b128 v[216:219], v15 offset:18432
    ds_read_b128 v[220:223], v15 offset:19456
    s_waitcnt lgkmcnt(3)
    v_mfma_f32_32x32x16_bf16 v[192:207], v[80:83], v[208:211], v[192:207]
    ds_read_b128 v[208:211], v15 offset:20480
    s_waitcnt lgkmcnt(3)
    v_mfma_f32_32x32x16_bf16 v[192:207], v[84:87], v[212:215], v[192:207]
    ds_read_b128 v[212:215], v15 offset:21504
    s_waitcnt lgkmcnt(3)
    v_mfma_f32_32x32x16_bf16 v[192:207], v[88:91], v[216:219], v[192:207]
    ds_read_b128 v[216:219], v15 offset:22528
    s_waitcnt lgkmcnt(3)
    v_mfma_f32_32x32x16_bf16 v[192:207], v[92:95], v[220:223], v[192:207]
    ds_read_b128 v[220:223], v15 offset:23552
    s_waitcnt lgkmcnt(3)
    v_mfma_f32_32x32x16_bf16 v[192:207], v[96:99], v[208:211], v[192:207]
    ds_read_b128 v[208:211], v15 offset:24576
    s_waitcnt lgkmcnt(3)
    v_mfma_f32_32x32x16_bf16 v[192:207], v[100:103], v[212:215], v[192:207]
    ds_read_b128 v[212:215], v15 offset:25600
    s_waitcnt lgkmcnt(3)
    v_mfma_f32_32x32x16_bf16 v[192:207], v[104:107], v[216:219], v[192:207]
    ds_read_b128 v[216:219], v15 offset:26624
    s_waitcnt lgkmcnt(3)
    v_mfma_f32_32x32x16_bf16 v[192:207], v[108:111], v[220:223], v[192:207]
    ds_read_b128 v[220:223], v15 offset:27648
    s_waitcnt lgkmcnt(3)
    v_mfma_f32_32x32x16_bf16 v[192:207], v[112:115], v[208:211], v[192:207]
    ds_read_b128 v[208:211], v15 offset:28672
    s_waitcnt lgkmcnt(3)
    v_mfma_f32_32x32x16_bf16 v[192:207], v[116:119], v[212:215], v[192:207]
    ds_read_b128 v[212:215], v15 offset:29696
    s_waitcnt lgkmcnt(3)
    v_mfma_f32_32x32x16_bf16 v[192:207], v[120:123], v[216:219], v[192:207]
    ds_read_b128 v[216:219], v15 offset:30720
    s_waitcnt lgkmcnt(3)
    v_mfma_f32_32x32x16_bf16 v[192:207], v[124:127], v[220:223], v[192:207]
    ds_read_b128 v[220:223], v15 offset:31744
    s_waitcnt lgkmcnt(3)
    v_mfma_f32_32x32x16_bf16 v[192:207], v[128:131], v[208:211], v[192:207]
    s_waitcnt lgkmcnt(2)
    v_mfma_f32_32x32x16_bf16 v[192:207], v[132:135], v[212:215], v[192:207]
    s_waitcnt lgkmcnt(1)
    v_mfma_f32_32x32x16_bf16 v[192:207], v[136:139], v[216:219], v[192:207]
    s_waitcnt lgkmcnt(0)
    v_mfma_f32_32x32x16_bf16 v[192:207], v[140:143], v[220:223], v[192:207]
    s_waitcnt vmcnt(0)
    s_barrier
    ds_read_b128 v[208:211], v15 offset:32768
    ds_read_b128 v[212:215], v15 offset:33792
    ds_read_b128 v[216:219], v15 offset:34816
    ds_read_b128 v[220:223], v15 offset:35840
    s_waitcnt lgkmcnt(3)
    v_mfma_f32_32x32x16_bf16 v[192:207], v[144:147], v[208:211], v[192:207]
    ds_read_b128 v[208:211], v15 offset:36864
    s_waitcnt lgkmcnt(3)
    v_mfma_f32_32x32x16_bf16 v[192:207], v[148:151], v[212:215], v[192:207]
    ds_read_b128 v[212:215], v15 offset:37888
    s_waitcnt lgkmcnt(3)
    v_mfma_f32_32x32x16_bf16 v[192:207], v[152:155], v[216:219], v[192:207]
    ds_read_b128 v[216:219], v15 offset:38912
    s_waitcnt lgkmcnt(3)
    v_mfma_f32_32x32x16_bf16 v[192:207], v[156:159], v[220:223], v[192:207]
    ds_read_b128 v[220:223], v15 offset:39936
    s_waitcnt lgkmcnt(3)
    v_mfma_f32_32x32x16_bf16 v[192:207], v[160:163], v[208:211], v[192:207]
    ds_read_b128 v[208:211], v15 offset:40960
    s_waitcnt lgkmcnt(3)
    v_mfma_f32_32x32x16_bf16 v[192:207], v[164:167], v[212:215], v[192:207]
    ds_read_b128 v[212:215], v15 offset:41984
    s_waitcnt lgkmcnt(3)
    v_mfma_f32_32x32x16_bf16 v[192:207], v[168:171], v[216:219], v[192:207]
    ds_read_b128 v[216:219], v15 offset:43008
    s_waitcnt lgkmcnt(3)
    v_mfma_f32_32x32x16_bf16 v[192:207], v[172:175], v[220:223], v[192:207]
    s_waitcnt lgkmcnt(2)
    v_mfma_f32_32x32x16_bf16 v[192:207], v[176:179], v[208:211], v[192:207]
    s_waitcnt lgkmcnt(1)
    v_mfma_f32_32x32x16_bf16 v[192:207], v[180:183], v[212:215], v[192:207]
    s_waitcnt lgkmcnt(0)
    v_mfma_f32_32x32x16_bf16 v[192:207], v[184:187], v[216:219], v[192:207]
    s_lshl_b32 s53, s50, 1
    s_add_u32 s54, s53, s51
    s_xor_b32 s55, s54, 1
    s_lshl_b32 s54, s54, 11
    s_lshl_b32 s55, s55, 11
    v_lshlrev_b32 v6, 4, v1
    v_add_u32 v7, s55, v6
    v_add_u32 v6, s54, v6
    v_add_u32 v7, 99328, v7
    v_add_u32 v6, 99328, v6
    s_cmp_eq_u32 s51, 0
    s_cbranch_scc0 L_m_RH52_k1
    ds_write_b128 v7, v[200:203] offset:0
    ds_write_b128 v7, v[204:207] offset:1024
    s_branch L_m_RH52_j
L_m_RH52_k1:
    ds_write_b128 v7, v[192:195] offset:0
    ds_write_b128 v7, v[196:199] offset:1024
    v_mov_b32 v192, v200
    v_mov_b32 v193, v201
    v_mov_b32 v194, v202
    v_mov_b32 v195, v203
    v_mov_b32 v196, v204
    v_mov_b32 v197, v205
    v_mov_b32 v198, v206
    v_mov_b32 v199, v207
L_m_RH52_j:
    s_waitcnt lgkmcnt(0)
    s_barrier
    ds_read_b128 v[200:203], v6 offset:0
    ds_read_b128 v[204:207], v6 offset:1024
    s_waitcnt lgkmcnt(0)
    v_pk_add_f32 v[192:193], v[192:193], v[200:201]
    v_pk_add_f32 v[194:195], v[194:195], v[202:203]
    v_pk_add_f32 v[196:197], v[196:197], v[204:205]
    v_pk_add_f32 v[198:199], v[198:199], v[206:207]
    s_mov_b32 s86, 4194304
    s_mov_b32 s87, 30474240
    v_lshlrev_b32 v6, 16, v224
    v_and_b32 v7, 0xffff0000, v224
    v_add_f32 v192, v192, v6
    v_add_f32 v193, v193, v7
    v_lshlrev_b32 v6, 16, v225
    v_and_b32 v7, 0xffff0000, v225
    v_add_f32 v194, v194, v6
    v_add_f32 v195, v195, v7
    v_lshlrev_b32 v6, 16, v226
    v_and_b32 v7, 0xffff0000, v226
    v_add_f32 v196, v196, v6
    v_add_f32 v197, v197, v7
    v_lshlrev_b32 v6, 16, v227
    v_and_b32 v7, 0xffff0000, v227
    v_add_f32 v198, v198, v6
    v_add_f32 v199, v199, v7
    v_cvt_pk_bf16_f32 v200, v192, v193
    v_cvt_pk_bf16_f32 v201, v194, v195
    v_cvt_pk_bf16_f32 v202, v196, v197
    v_cvt_pk_bf16_f32 v203, v198, v199
    v_min_u32 v200, -2, v200
    v_min_u32 v201, -2, v201
    v_min_u32 v202, -2, v202
    v_min_u32 v203, -2, v203
    v_lshlrev_b32 v9, 14, v3
    v_lshl_add_u32 v9, v2, 3, v9
    s_lshl_b32 s56, s52, 1
    s_add_u32 s56, s56, s51
    s_lshl_b32 s56, s56, 16
    s_lshl_b32 s57, s48, 8
    s_add_u32 s56, s56, s57
    s_add_u32 s56, s56, s86
    buffer_store_dwordx2 v[200:201], v9, s[4:7], s56 offen offset:0 sc1
    s_add_u32 s56, s56, 32768
    buffer_store_dwordx2 v[202:203], v9, s[4:7], s56 offen offset:0 sc1
    s_or_b32 s53, s52, s51
    s_cmp_eq_u32 s53, 0
    s_cselect_b32 s53, 32, 0
    v_cmp_le_u32 vcc, s53, v1
    s_lshl_b32 s53, s3, 7
    s_add_u32 s53, s53, 115712
    v_lshl_add_u32 v10, v2, 2, s53
    v_cndmask_b32 v6, 0, v193, vcc
    v_mul_f32 v7, v192, v192
    v_fmac_f32 v7, v6, v6
    v_fmac_f32 v7, v194, v194
    v_fmac_f32 v7, v195, v195
    v_fmac_f32 v7, v196, v196
    v_fmac_f32 v7, v197, v197
    v_fmac_f32 v7, v198, v198
    v_fmac_f32 v7, v199, v199
    v_mov_b32 v8, v7
    s_nop 1
    v_permlane32_swap_b32 v7, v8
    v_add_f32 v7, v7, v8
    ds_write_b32 v10, v7 offset:0
    s_waitcnt lgkmcnt(0)
    s_barrier
    s_cmp_ge_u32 s3, 1
    s_cbranch_scc1 L_m_SS53
    v_lshlrev_b32 v6, 2, v2
    s_mul_i32 s53, s3, 17408
    s_add_u32 s53, s53, 115712
    v_add_u32 v7, s53, v6
    ds_read_b32 v192, v7 offset:0
    ds_read_b32 v193, v7 offset:128
    ds_read_b32 v194, v7 offset:256
    ds_read_b32 v195, v7 offset:384
    ds_read_b32 v196, v7 offset:512
    ds_read_b32 v197, v7 offset:640
    ds_read_b32 v198, v7 offset:768
    ds_read_b32 v199, v7 offset:896
    s_waitcnt lgkmcnt(0)
    v_add_f32 v192, v192, v193
    v_add_f32 v192, v192, v194
    v_add_f32 v192, v192, v195
    v_add_f32 v192, v192, v196
    v_add_f32 v192, v192, v197
    v_add_f32 v192, v192, v198
    v_add_f32 v192, v192, v199
    v_min_u32 v192, -2, v192
    s_lshl_b32 s53, s49, 13
    s_lshl_b32 s54, s48, 7
    s_add_u32 s53, s53, s54
    s_mul_i32 s54, s3, 1024
    s_add_u32 s53, s53, s54
    s_add_u32 s53, s53, s87
    s_mov_b32 exec_hi, 0
    buffer_store_dword v192, v6, s[4:7], s53 offen sc1
    s_mov_b32 exec_hi, -1
L_m_SS53:
    s_mov_b32 s41, 4194304
    s_mov_b32 s42, 6291456
    s_mov_b32 s43, 30474240
    s_mov_b32 s44, 14680064
    s_add_u32 s92, s92, 3
    s_mov_b32 s93, 1
    s_branch L_LAYER
L_P6:
    v_and_b32 v13, 1, v1
    v_lshlrev_b32 v13, 15, v13
    v_or_b32 v13, 0x3d353d35, v13
    s_cmp_eq_u32 s51, 0
    s_cselect_b32 s53, 32, 0
    v_lshlrev_b32 v14, 9, v3
    v_lshl_add_u32 v14, v2, 3, v14
    s_lshl_b32 s54, s51, 14
    s_add_u32 s54, s54, 124928
    v_add_u32 v14, s54, v14
    s_cmp_eq_u32 s72, 1
    s_cbranch_scc1 L_P6R
    s_waitcnt vmcnt(0)
    s_barrier
L_P6R:
    v_lshlrev_b32 v12, 4, v1
    ds_read_b64 v[208:209], v14 offset:0
    ds_read_b64 v[210:211], v14 offset:256
    ds_read_b64 v[212:213], v14 offset:1024
    ds_read_b64 v[214:215], v14 offset:1280
    ds_read_b64 v[216:217], v14 offset:2048
    ds_read_b64 v[218:219], v14 offset:2304
    v_cvt_pk_bf16_f32 v224, v244, v245
    v_cvt_pk_bf16_f32 v225, v246, v247
    v_cvt_pk_bf16_f32 v226, v248, v249
    v_cvt_pk_bf16_f32 v227, v250, v251
    v_cmp_gt_u32 vcc, s53, v1
    s_nop 1
    v_cndmask_b32 v224, v224, v13, vcc
    buffer_load_dwordx4 v[96:99], v12, s[4:7], s70 offen offset:0 sc1
    v_pk_fma_f32 v[236:237], v[252:253], v[244:245], v[236:237] op_sel_hi:[0,1,1] neg_lo:[0,0,1] neg_hi:[0,0,1]
    v_pk_fma_f32 v[238:239], v[252:253], v[246:247], v[238:239] op_sel_hi:[0,1,1] neg_lo:[0,0,1] neg_hi:[0,0,1]
    v_pk_fma_f32 v[240:241], v[252:253], v[248:249], v[240:241] op_sel_hi:[0,1,1] neg_lo:[0,0,1] neg_hi:[0,0,1]
    v_pk_fma_f32 v[242:243], v[252:253], v[250:251], v[242:243] op_sel_hi:[0,1,1] neg_lo:[0,0,1] neg_hi:[0,0,1]
    buffer_load_dwordx4 v[100:103], v12, s[4:7], s70 offen offset:1024 sc1
    s_waitcnt lgkmcnt(4)
    v_mfma_f32_32x32x16_bf16 v[192:207], v[224:227], v[208:211], 0
    ds_read_b64 v[220:221], v14 offset:3072
    ds_read_b64 v[222:223], v14 offset:3328
    v_cvt_pk_bf16_f32 v228, v236, v237
    v_cvt_pk_bf16_f32 v229, v238, v239
    v_cvt_pk_bf16_f32 v230, v240, v241
    v_cvt_pk_bf16_f32 v231, v242, v243
    buffer_load_dwordx4 v[104:107], v12, s[4:7], s70 offen offset:2048 sc1
    v_pk_fma_f32 v[244:245], v[252:253], v[236:237], v[244:245] op_sel_hi:[0,1,1] neg_lo:[0,0,1] neg_hi:[0,0,1]
    v_pk_fma_f32 v[246:247], v[252:253], v[238:239], v[246:247] op_sel_hi:[0,1,1] neg_lo:[0,0,1] neg_hi:[0,0,1]
    v_pk_fma_f32 v[248:249], v[252:253], v[240:241], v[248:249] op_sel_hi:[0,1,1] neg_lo:[0,0,1] neg_hi:[0,0,1]
    v_pk_fma_f32 v[250:251], v[252:253], v[242:243], v[250:251] op_sel_hi:[0,1,1] neg_lo:[0,0,1] neg_hi:[0,0,1]
    buffer_load_dwordx4 v[108:111], v12, s[4:7], s70 offen offset:3072 sc1
    s_add_u32 s70, s70, 4096
    s_waitcnt lgkmcnt(4)
    v_mfma_f32_32x32x16_bf16 v[192:207], v[228:231], v[212:215], v[192:207]
    ds_read_b64 v[208:209], v14 offset:4096
    ds_read_b64 v[210:211], v14 offset:4352
    v_cvt_pk_bf16_f32 v224, v244, v245
    v_cvt_pk_bf16_f32 v225, v246, v247
    v_cvt_pk_bf16_f32 v226, v248, v249
    v_cvt_pk_bf16_f32 v227, v250, v251
    buffer_load_dwordx4 v[112:115], v12, s[4:7], s70 offen offset:0 sc1
    v_pk_fma_f32 v[236:237], v[252:253], v[244:245], v[236:237] op_sel_hi:[0,1,1] neg_lo:[0,0,1] neg_hi:[0,0,1]
    v_pk_fma_f32 v[238:239], v[252:253], v[246:247], v[238:239] op_sel_hi:[0,1,1] neg_lo:[0,0,1] neg_hi:[0,0,1]
    v_pk_fma_f32 v[240:241], v[252:253], v[248:249], v[240:241] op_sel_hi:[0,1,1] neg_lo:[0,0,1] neg_hi:[0,0,1]
    v_pk_fma_f32 v[242:243], v[252:253], v[250:251], v[242:243] op_sel_hi:[0,1,1] neg_lo:[0,0,1] neg_hi:[0,0,1]
    buffer_load_dwordx4 v[116:119], v12, s[4:7], s70 offen offset:1024 sc1
    s_waitcnt lgkmcnt(4)
    v_mfma_f32_32x32x16_bf16 v[192:207], v[224:227], v[216:219], v[192:207]
    ds_read_b64 v[212:213], v14 offset:5120
    ds_read_b64 v[214:215], v14 offset:5376
    v_cvt_pk_bf16_f32 v228, v236, v237
    v_cvt_pk_bf16_f32 v229, v238, v239
    v_cvt_pk_bf16_f32 v230, v240, v241
    v_cvt_pk_bf16_f32 v231, v242, v243
    buffer_load_dwordx4 v[120:123], v12, s[4:7], s70 offen offset:2048 sc1
    v_pk_fma_f32 v[244:245], v[252:253], v[236:237], v[244:245] op_sel_hi:[0,1,1] neg_lo:[0,0,1] neg_hi:[0,0,1]
    v_pk_fma_f32 v[246:247], v[252:253], v[238:239], v[246:247] op_sel_hi:[0,1,1] neg_lo:[0,0,1] neg_hi:[0,0,1]
    v_pk_fma_f32 v[248:249], v[252:253], v[240:241], v[248:249] op_sel_hi:[0,1,1] neg_lo:[0,0,1] neg_hi:[0,0,1]
    v_pk_fma_f32 v[250:251], v[252:253], v[242:243], v[250:251] op_sel_hi:[0,1,1] neg_lo:[0,0,1] neg_hi:[0,0,1]
    buffer_load_dwordx4 v[124:127], v12, s[4:7], s70 offen offset:3072 sc1
    s_add_u32 s70, s70, 4096
    s_waitcnt lgkmcnt(4)
    v_mfma_f32_32x32x16_bf16 v[192:207], v[228:231], v[220:223], v[192:207]
    ds_read_b64 v[216:217], v14 offset:6144
    ds_read_b64 v[218:219], v14 offset:6400
    v_cvt_pk_bf16_f32 v224, v244, v245
    v_cvt_pk_bf16_f32 v225, v246, v247
    v_cvt_pk_bf16_f32 v226, v248, v249
    v_cvt_pk_bf16_f32 v227, v250, v251
    buffer_load_dwordx4 v[128:131], v12, s[4:7], s70 offen offset:0 sc1
    v_pk_fma_f32 v[236:237], v[252:253], v[244:245], v[236:237] op_sel_hi:[0,1,1] neg_lo:[0,0,1] neg_hi:[0,0,1]
    v_pk_fma_f32 v[238:239], v[252:253], v[246:247], v[238:239] op_sel_hi:[0,1,1] neg_lo:[0,0,1] neg_hi:[0,0,1]
    v_pk_fma_f32 v[240:241], v[252:253], v[248:249], v[240:241] op_sel_hi:[0,1,1] neg_lo:[0,0,1] neg_hi:[0,0,1]
    v_pk_fma_f32 v[242:243], v[252:253], v[250:251], v[242:243] op_sel_hi:[0,1,1] neg_lo:[0,0,1] neg_hi:[0,0,1]
    buffer_load_dwordx4 v[132:135], v12, s[4:7], s70 offen offset:1024 sc1
    s_waitcnt lgkmcnt(4)
    v_mfma_f32_32x32x16_bf16 v[192:207], v[224:227], v[208:211], v[192:207]
    ds_read_b64 v[220:221], v14 offset:7168
    ds_read_b64 v[222:223], v14 offset:7424
    v_cvt_pk_bf16_f32 v228, v236, v237
    v_cvt_pk_bf16_f32 v229, v238, v239
    v_cvt_pk_bf16_f32 v230, v240, v241
    v_cvt_pk_bf16_f32 v231, v242, v243
    buffer_load_dwordx4 v[136:139], v12, s[4:7], s70 offen offset:2048 sc1
    v_pk_fma_f32 v[244:245], v[252:253], v[236:237], v[244:245] op_sel_hi:[0,1,1] neg_lo:[0,0,1] neg_hi:[0,0,1]
    v_pk_fma_f32 v[246:247], v[252:253], v[238:239], v[246:247] op_sel_hi:[0,1,1] neg_lo:[0,0,1] neg_hi:[0,0,1]
    v_pk_fma_f32 v[248:249], v[252:253], v[240:241], v[248:249] op_sel_hi:[0,1,1] neg_lo:[0,0,1] neg_hi:[0,0,1]
    v_pk_fma_f32 v[250:251], v[252:253], v[242:243], v[250:251] op_sel_hi:[0,1,1] neg_lo:[0,0,1] neg_hi:[0,0,1]
    buffer_load_dwordx4 v[140:143], v12, s[4:7], s70 offen offset:3072 sc1
    s_add_u32 s70, s70, 4096
    s_waitcnt lgkmcnt(4)
    v_mfma_f32_32x32x16_bf16 v[192:207], v[228:231], v[212:215], v[192:207]
    ds_read_b64 v[208:209], v14 offset:8192
    ds_read_b64 v[210:211], v14 offset:8448
    v_cvt_pk_bf16_f32 v224, v244, v245
    v_cvt_pk_bf16_f32 v225, v246, v247
    v_cvt_pk_bf16_f32 v226, v248, v249
    v_cvt_pk_bf16_f32 v227, v250, v251
    buffer_load_dwordx4 v[144:147], v12, s[4:7], s70 offen offset:0 sc1
    v_pk_fma_f32 v[236:237], v[252:253], v[244:245], v[236:237] op_sel_hi:[0,1,1] neg_lo:[0,0,1] neg_hi:[0,0,1]
    v_pk_fma_f32 v[238:239], v[252:253], v[246:247], v[238:239] op_sel_hi:[0,1,1] neg_lo:[0,0,1] neg_hi:[0,0,1]
    v_pk_fma_f32 v[240:241], v[252:253], v[248:249], v[240:241] op_sel_hi:[0,1,1] neg_lo:[0,0,1] neg_hi:[0,0,1]
    v_pk_fma_f32 v[242:243], v[252:253], v[250:251], v[242:243] op_sel_hi:[0,1,1] neg_lo:[0,0,1] neg_hi:[0,0,1]
    buffer_load_dwordx4 v[148:151], v12, s[4:7], s70 offen offset:1024 sc1
    s_waitcnt lgkmcnt(4)
    v_mfma_f32_32x32x16_bf16 v[192:207], v[224:227], v[216:219], v[192:207]
    ds_read_b64 v[212:213], v14 offset:9216
    ds_read_b64 v[214:215], v14 offset:9472
    v_cvt_pk_bf16_f32 v228, v236, v237
    v_cvt_pk_bf16_f32 v229, v238, v239
    v_cvt_pk_bf16_f32 v230, v240, v241
    v_cvt_pk_bf16_f32 v231, v242, v243
    buffer_load_dwordx4 v[152:155], v12, s[4:7], s70 offen offset:2048 sc1
    v_pk_fma_f32 v[244:245], v[252:253], v[236:237], v[244:245] op_sel_hi:[0,1,1] neg_lo:[0,0,1] neg_hi:[0,0,1]
    v_pk_fma_f32 v[246:247], v[252:253], v[238:239], v[246:247] op_sel_hi:[0,1,1] neg_lo:[0,0,1] neg_hi:[0,0,1]
    v_pk_fma_f32 v[248:249], v[252:253], v[240:241], v[248:249] op_sel_hi:[0,1,1] neg_lo:[0,0,1] neg_hi:[0,0,1]
    v_pk_fma_f32 v[250:251], v[252:253], v[242:243], v[250:251] op_sel_hi:[0,1,1] neg_lo:[0,0,1] neg_hi:[0,0,1]
    buffer_load_dwordx4 v[156:159], v12, s[4:7], s70 offen offset:3072 sc1
    s_add_u32 s70, s70, 4096
    s_waitcnt lgkmcnt(4)
    v_mfma_f32_32x32x16_bf16 v[192:207], v[228:231], v[220:223], v[192:207]
    ds_read_b64 v[216:217], v14 offset:10240
    ds_read_b64 v[218:219], v14 offset:10496
    v_cvt_pk_bf16_f32 v224, v244, v245
    v_cvt_pk_bf16_f32 v225, v246, v247
    v_cvt_pk_bf16_f32 v226, v248, v249
    v_cvt_pk_bf16_f32 v227, v250, v251
    v_pk_fma_f32 v[236:237], v[252:253], v[244:245], v[236:237] op_sel_hi:[0,1,1] neg_lo:[0,0,1] neg_hi:[0,0,1]
    v_pk_fma_f32 v[238:239], v[252:253], v[246:247], v[238:239] op_sel_hi:[0,1,1] neg_lo:[0,0,1] neg_hi:[0,0,1]
    v_pk_fma_f32 v[240:241], v[252:253], v[248:249], v[240:241] op_sel_hi:[0,1,1] neg_lo:[0,0,1] neg_hi:[0,0,1]
    v_pk_fma_f32 v[242:243], v[252:253], v[250:251], v[242:243] op_sel_hi:[0,1,1] neg_lo:[0,0,1] neg_hi:[0,0,1]
    s_waitcnt lgkmcnt(4)
    v_mfma_f32_32x32x16_bf16 v[192:207], v[224:227], v[208:211], v[192:207]
    ds_read_b64 v[220:221], v14 offset:11264
    ds_read_b64 v[222:223], v14 offset:11520
    v_cvt_pk_bf16_f32 v228, v236, v237
    v_cvt_pk_bf16_f32 v229, v238, v239
    v_cvt_pk_bf16_f32 v230, v240, v241
    v_cvt_pk_bf16_f32 v231, v242, v243
    v_pk_fma_f32 v[244:245], v[252:253], v[236:237], v[244:245] op_sel_hi:[0,1,1] neg_lo:[0,0,1] neg_hi:[0,0,1]
    v_pk_fma_f32 v[246:247], v[252:253], v[238:239], v[246:247] op_sel_hi:[0,1,1] neg_lo:[0,0,1] neg_hi:[0,0,1]
    v_pk_fma_f32 v[248:249], v[252:253], v[240:241], v[248:249] op_sel_hi:[0,1,1] neg_lo:[0,0,1] neg_hi:[0,0,1]
    v_pk_fma_f32 v[250:251], v[252:253], v[242:243], v[250:251] op_sel_hi:[0,1,1] neg_lo:[0,0,1] neg_hi:[0,0,1]
    s_waitcnt lgkmcnt(4)
    v_mfma_f32_32x32x16_bf16 v[192:207], v[228:231], v[212:215], v[192:207]
    ds_read_b64 v[208:209], v14 offset:12288
    ds_read_b64 v[210:211], v14 offset:12544
    v_cvt_pk_bf16_f32 v224, v244, v245
    v_cvt_pk_bf16_f32 v225, v246, v247
    v_cvt_pk_bf16_f32 v226, v248, v249
    v_cvt_pk_bf16_f32 v227, v250, v251
    v_pk_fma_f32 v[236:237], v[252:253], v[244:245], v[236:237] op_sel_hi:[0,1,1] neg_lo:[0,0,1] neg_hi:[0,0,1]
    v_pk_fma_f32 v[238:239], v[252:253], v[246:247], v[238:239] op_sel_hi:[0,1,1] neg_lo:[0,0,1] neg_hi:[0,0,1]
    v_pk_fma_f32 v[240:241], v[252:253], v[248:249], v[240:241] op_sel_hi:[0,1,1] neg_lo:[0,0,1] neg_hi:[0,0,1]
    v_pk_fma_f32 v[242:243], v[252:253], v[250:251], v[242:243] op_sel_hi:[0,1,1] neg_lo:[0,0,1] neg_hi:[0,0,1]
    s_waitcnt lgkmcnt(4)
    v_mfma_f32_32x32x16_bf16 v[192:207], v[224:227], v[216:219], v[192:207]
    ds_read_b64 v[212:213], v14 offset:13312
    ds_read_b64 v[214:215], v14 offset:13568
    v_cvt_pk_bf16_f32 v228, v236, v237
    v_cvt_pk_bf16_f32 v229, v238, v239
    v_cvt_pk_bf16_f32 v230, v240, v241
    v_cvt_pk_bf16_f32 v231, v242, v243
    v_pk_fma_f32 v[244:245], v[252:253], v[236:237], v[244:245] op_sel_hi:[0,1,1] neg_lo:[0,0,1] neg_hi:[0,0,1]
    v_pk_fma_f32 v[246:247], v[252:253], v[238:239], v[246:247] op_sel_hi:[0,1,1] neg_lo:[0,0,1] neg_hi:[0,0,1]
    v_pk_fma_f32 v[248:249], v[252:253], v[240:241], v[248:249] op_sel_hi:[0,1,1] neg_lo:[0,0,1] neg_hi:[0,0,1]
    v_pk_fma_f32 v[250:251], v[252:253], v[242:243], v[250:251] op_sel_hi:[0,1,1] neg_lo:[0,0,1] neg_hi:[0,0,1]
    s_waitcnt lgkmcnt(4)
    v_mfma_f32_32x32x16_bf16 v[192:207], v[228:231], v[220:223], v[192:207]
    ds_read_b64 v[216:217], v14 offset:14336
    ds_read_b64 v[218:219], v14 offset:14592
    v_cvt_pk_bf16_f32 v224, v244, v245
    v_cvt_pk_bf16_f32 v225, v246, v247
    v_cvt_pk_bf16_f32 v226, v248, v249
    v_cvt_pk_bf16_f32 v227, v250, v251
    v_pk_fma_f32 v[236:237], v[252:253], v[244:245], v[236:237] op_sel_hi:[0,1,1] neg_lo:[0,0,1] neg_hi:[0,0,1]
    v_pk_fma_f32 v[238:239], v[252:253], v[246:247], v[238:239] op_sel_hi:[0,1,1] neg_lo:[0,0,1] neg_hi:[0,0,1]
    v_pk_fma_f32 v[240:241], v[252:253], v[248:249], v[240:241] op_sel_hi:[0,1,1] neg_lo:[0,0,1] neg_hi:[0,0,1]
    v_pk_fma_f32 v[242:243], v[252:253], v[250:251], v[242:243] op_sel_hi:[0,1,1] neg_lo:[0,0,1] neg_hi:[0,0,1]
    s_waitcnt lgkmcnt(4)
    v_mfma_f32_32x32x16_bf16 v[192:207], v[224:227], v[208:211], v[192:207]
    ds_read_b64 v[220:221], v14 offset:15360
    ds_read_b64 v[222:223], v14 offset:15616
    v_cvt_pk_bf16_f32 v228, v236, v237
    v_cvt_pk_bf16_f32 v229, v238, v239
    v_cvt_pk_bf16_f32 v230, v240, v241
    v_cvt_pk_bf16_f32 v231, v242, v243
    v_pk_fma_f32 v[244:245], v[252:253], v[236:237], v[244:245] op_sel_hi:[0,1,1] neg_lo:[0,0,1] neg_hi:[0,0,1]
    v_pk_fma_f32 v[246:247], v[252:253], v[238:239], v[246:247] op_sel_hi:[0,1,1] neg_lo:[0,0,1] neg_hi:[0,0,1]
    v_pk_fma_f32 v[248:249], v[252:253], v[240:241], v[248:249] op_sel_hi:[0,1,1] neg_lo:[0,0,1] neg_hi:[0,0,1]
    v_pk_fma_f32 v[250:251], v[252:253], v[242:243], v[250:251] op_sel_hi:[0,1,1] neg_lo:[0,0,1] neg_hi:[0,0,1]
    s_waitcnt lgkmcnt(4)
    v_mfma_f32_32x32x16_bf16 v[192:207], v[228:231], v[212:215], v[192:207]
    v_cvt_pk_bf16_f32 v224, v244, v245
    v_cvt_pk_bf16_f32 v225, v246, v247
    v_cvt_pk_bf16_f32 v226, v248, v249
    v_cvt_pk_bf16_f32 v227, v250, v251
    v_pk_fma_f32 v[236:237], v[252:253], v[244:245], v[236:237] op_sel_hi:[0,1,1] neg_lo:[0,0,1] neg_hi:[0,0,1]
    v_pk_fma_f32 v[238:239], v[252:253], v[246:247], v[238:239] op_sel_hi:[0,1,1] neg_lo:[0,0,1] neg_hi:[0,0,1]
    v_pk_fma_f32 v[240:241], v[252:253], v[248:249], v[240:241] op_sel_hi:[0,1,1] neg_lo:[0,0,1] neg_hi:[0,0,1]
    v_pk_fma_f32 v[242:243], v[252:253], v[250:251], v[242:243] op_sel_hi:[0,1,1] neg_lo:[0,0,1] neg_hi:[0,0,1]
    s_waitcnt lgkmcnt(2)
    v_mfma_f32_32x32x16_bf16 v[192:207], v[224:227], v[216:219], v[192:207]
    v_cvt_pk_bf16_f32 v228, v236, v237
    v_cvt_pk_bf16_f32 v229, v238, v239
    v_cvt_pk_bf16_f32 v230, v240, v241
    v_cvt_pk_bf16_f32 v231, v242, v243
    s_waitcnt lgkmcnt(0)
    s_nop 0
    v_mfma_f32_32x32x16_bf16 v[192:207], v[228:231], v[220:223], v[192:207]
    s_mul_i32 s88, s48, 21846
    s_lshr_b32 s88, s88, 16
    s_cmp_eq_u32 s3, 0
    s_nop 7
    s_cbranch_scc0 L_m_W54_skip
    s_add_u32 s91, s92, 1
    s_cmp_ge_u32 s88, 11
    s_cselect_b32 s86, 1, 0
    s_mul_i32 s87, s86, 11
    s_sub_u32 s87, s88, s87
    v_min_u32 v12, 10, v1
    v_mul_u32_u24 v13, 86, v12
    v_lshrrev_b32 v13, 8, v13
    v_mul_u32_u24 v14, 3, v13
    v_sub_u32 v14, v12, v14
    s_mul_i32 s85, s87, 3
    v_add_u32 v14, s85, v14
    v_lshlrev_b32 v15, 3, v14
    v_lshl_add_u32 v15, v13, 1, v15
    v_add_u32 v8, 22, v13
    v_lshlrev_b32 v8, 3, v8
    v_add_u32 v8, 6, v8
    v_cmp_eq_u32 vcc, 32, v14
    s_nop 1
    v_cndmask_b32 v15, v15, v8, vcc
    s_lshl_b32 s85, s87, 1
    v_add_u32 v8, s85, v12
    v_add_u32 v8, -9, v8
    v_lshlrev_b32 v8, 3, v8
    v_add_u32 v8, 6, v8
    v_cmp_le_u32 vcc, 9, v12
    s_nop 1
    v_cndmask_b32 v15, v15, v8, vcc
    v_add_u32 v12, s86, v15
    v_mov_b32 v13, 255
    v_cmp_eq_u32 vcc, 11, v1
    s_nop 1
    v_cndmask_b32 v12, v12, v13, vcc
    v_lshlrev_b32 v12, 7, v12
    s_add_u32 s87, s40, 4
    v_mov_b32 v13, s91
    v_mov_b32 v14, s87
    v_cndmask_b32 v13, v13, v14, vcc
    s_mov_b32 s90, 31457280
    s_mov_b32 s89, 0x40000
    v_mov_b32 v11, v13
L_m_W54_loop:
    buffer_load_dword v232, v12, s[4:7], s90 offen sc1
    s_waitcnt vmcnt(0)
    v_sub_u32 v8, v232, v11
    v_cmp_gt_u32 vcc, 16, v8
    s_cmp_eq_u64 vcc, exec
    s_nop 2
    s_cbranch_scc1 L_m_W54_skip
    s_sleep 1
    s_sub_u32 s89, s89, 1
    s_cmp_lg_u32 s89, 0
    s_cbranch_scc1 L_m_W54_loop
L_m_W54_skip:
    s_barrier
    s_mul_i32 s53, s48, 86
    s_mul_i32 s54, s51, 43
    s_add_u32 s53, s53, s54
    s_add_u32 s53, s53, s50
    s_lshl_b32 s53, s53, 10
    s_add_u32 s53, s53, s44
    s_add_u32 s54, s54, s50
    s_lshl_b32 s54, s54, 10
    v_lshlrev_b32 v6, 4, v1
    s_cmp_eq_u32 s50, 3
    s_cselect_b32 s55, 1024, 0
    s_add_u32 m0, s54, 0
    s_add_u32 s56, s53, 0
    buffer_load_dwordx4 v6, s[4:7], s56 offen sc1 lds
    s_add_u32 m0, s54, 4096
    s_add_u32 s56, s53, 4096
    buffer_load_dwordx4 v6, s[4:7], s56 offen sc1 lds
    s_add_u32 m0, s54, 8192
    s_add_u32 s56, s53, 8192
    buffer_load_dwordx4 v6, s[4:7], s56 offen sc1 lds
    s_add_u32 m0, s54, 12288
    s_add_u32 s56, s53, 12288
    buffer_load_dwordx4 v6, s[4:7], s56 offen sc1 lds
    s_mul_i32 s57, s51, 44032
    v_lshl_add_u32 v15, v1, 4, s57
    s_waitcnt vmcnt(0)
    s_barrier
    ds_read_b128 v[208:211], v15 offset:0
    ds_read_b128 v[212:215], v15 offset:1024
    ds_read_b128 v[216:219], v15 offset:2048
    ds_read_b128 v[220:223], v15 offset:3072
    s_waitcnt lgkmcnt(3)
    v_mfma_f32_32x32x16_bf16 v[192:207], v[16:19], v[208:211], v[192:207]
    s_add_u32 m0, s54, 16384
    s_add_u32 s56, s53, 16384
    buffer_load_dwordx4 v6, s[4:7], s56 offen sc1 lds
    ds_read_b128 v[208:211], v15 offset:4096
    s_waitcnt lgkmcnt(3)
    v_mfma_f32_32x32x16_bf16 v[192:207], v[20:23], v[212:215], v[192:207]
    s_add_u32 m0, s54, 20480
    s_add_u32 s56, s53, 20480
    buffer_load_dwordx4 v6, s[4:7], s56 offen sc1 lds
    ds_read_b128 v[212:215], v15 offset:5120
    s_waitcnt lgkmcnt(3)
    v_mfma_f32_32x32x16_bf16 v[192:207], v[24:27], v[216:219], v[192:207]
    s_add_u32 m0, s54, 24576
    s_add_u32 s56, s53, 24576
    buffer_load_dwordx4 v6, s[4:7], s56 offen sc1 lds
    ds_read_b128 v[216:219], v15 offset:6144
    s_waitcnt lgkmcnt(3)
    v_mfma_f32_32x32x16_bf16 v[192:207], v[28:31], v[220:223], v[192:207]
    s_add_u32 m0, s54, 28672
    s_add_u32 s56, s53, 28672
    buffer_load_dwordx4 v6, s[4:7], s56 offen sc1 lds
    ds_read_b128 v[220:223], v15 offset:7168
    s_waitcnt lgkmcnt(3)
    v_mfma_f32_32x32x16_bf16 v[192:207], v[32:35], v[208:211], v[192:207]
    s_add_u32 m0, s54, 32768
    s_add_u32 s56, s53, 32768
    buffer_load_dwordx4 v6, s[4:7], s56 offen sc1 lds
    ds_read_b128 v[208:211], v15 offset:8192
    s_waitcnt lgkmcnt(3)
    v_mfma_f32_32x32x16_bf16 v[192:207], v[36:39], v[212:215], v[192:207]
    s_add_u32 m0, s54, 36864
    s_add_u32 s56, s53, 36864
    buffer_load_dwordx4 v6, s[4:7], s56 offen sc1 lds
    ds_read_b128 v[212:215], v15 offset:9216
    s_waitcnt lgkmcnt(3)
    v_mfma_f32_32x32x16_bf16 v[192:207], v[40:43], v[216:219], v[192:207]
    s_sub_u32 s56, s53, s55
    s_sub_u32 s57, s54, s55
    s_add_u32 m0, s57, 40960
    s_add_u32 s56, s56, 40960
    buffer_load_dwordx4 v6, s[4:7], s56 offen sc1 lds
    ds_read_b128 v[216:219], v15 offset:10240
    s_waitcnt lgkmcnt(3)
    v_mfma_f32_32x32x16_bf16 v[192:207], v[44:47], v[220:223], v[192:207]
    ds_read_b128 v[220:223], v15 offset:11264
    s_waitcnt lgkmcnt(3)
    v_mfma_f32_32x32x16_bf16 v[192:207], v[48:51], v[208:211], v[192:207]
    ds_read_b128 v[208:211], v15 offset:12288
    s_waitcnt lgkmcnt(3)
    v_mfma_f32_32x32x16_bf16 v[192:207], v[52:55], v[212:215], v[192:207]
    buffer_load_dwordx4 v[160:163], v6, s[4:7], s70 offen offset:0 sc1
    ds_read_b128 v[212:215], v15 offset:13312
    s_waitcnt lgkmcnt(3)
    v_mfma_f32_32x32x16_bf16 v[192:207], v[56:59], v[216:219], v[192:207]
    buffer_load_dwordx4 v[164:167], v6, s[4:7], s70 offen offset:1024 sc1
    ds_read_b128 v[216:219], v15 offset:14336
    s_waitcnt lgkmcnt(3)
    v_mfma_f32_32x32x16_bf16 v[192:207], v[60:63], v[220:223], v[192:207]
    buffer_load_dwordx4 v[168:171], v6, s[4:7], s70 offen offset:2048 sc1
    ds_read_b128 v[220:223], v15 offset:15360
    s_waitcnt lgkmcnt(3)
    v_mfma_f32_32x32x16_bf16 v[192:207], v[64:67], v[208:211], v[192:207]
    buffer_load_dwordx4 v[172:175], v6, s[4:7], s70 offen offset:3072 sc1
    s_waitcnt lgkmcnt(2)
    v_mfma_f32_32x32x16_bf16 v[192:207], v[68:71], v[212:215], v[192:207]
    s_add_u32 s70, s70, 4096
    buffer_load_dwordx4 v[176:179], v6, s[4:7], s70 offen offset:0 sc1
    s_waitcnt lgkmcnt(1)
    v_mfma_f32_32x32x16_bf16 v[192:207], v[72:75], v[216:219], v[192:207]
    buffer_load_dwordx4 v[180:183], v6, s[4:7], s70 offen offset:1024 sc1
    s_waitcnt lgkmcnt(0)
    v_mfma_f32_32x32x16_bf16 v[192:207], v[76:79], v[220:223], v[192:207]
    buffer_load_dwordx4 v[184:187], v6, s[4:7], s70 offen offset:2048 sc1
    s_waitcnt vmcnt(10)
    s_barrier
    ds_read_b128 v[208:211], v15 offset:16384
    ds_read_b128 v[212:215], v15 offset:17408
    ds_read_b128 v[216:219], v15 offset:18432
    ds_read_b128 v[220:223], v15 offset:19456
    s_waitcnt lgkmcnt(3)
    v_mfma_f32_32x32x16_bf16 v[192:207], v[80:83], v[208:211], v[192:207]
    ds_read_b128 v[208:211], v15 offset:20480
    s_waitcnt lgkmcnt(3)
    v_mfma_f32_32x32x16_bf16 v[192:207], v[84:87], v[212:215], v[192:207]
    ds_read_b128 v[212:215], v15 offset:21504
    s_waitcnt lgkmcnt(3)
    v_mfma_f32_32x32x16_bf16 v[192:207], v[88:91], v[216:219], v[192:207]
    ds_read_b128 v[216:219], v15 offset:22528
    s_waitcnt lgkmcnt(3)
    v_mfma_f32_32x32x16_bf16 v[192:207], v[92:95], v[220:223], v[192:207]
    ds_read_b128 v[220:223], v15 offset:23552
    s_waitcnt lgkmcnt(3)
    v_mfma_f32_32x32x16_bf16 v[192:207], v[96:99], v[208:211], v[192:207]
    ds_read_b128 v[208:211], v15 offset:24576
    s_waitcnt lgkmcnt(3)
    v_mfma_f32_32x32x16_bf16 v[192:207], v[100:103], v[212:215], v[192:207]
    ds_read_b128 v[212:215], v15 offset:25600
    s_waitcnt lgkmcnt(3)
    v_mfma_f32_32x32x16_bf16 v[192:207], v[104:107], v[216:219], v[192:207]
    ds_read_b128 v[216:219], v15 offset:26624
    s_waitcnt lgkmcnt(3)
    v_mfma_f32_32x32x16_bf16 v[192:207], v[108:111], v[220:223], v[192:207]
    ds_read_b128 v[220:223], v15 offset:27648
    s_waitcnt lgkmcnt(3)
    v_mfma_f32_32x32x16_bf16 v[192:207], v[112:115], v[208:211], v[192:207]
    ds_read_b128 v[208:211], v15 offset:28672
    s_waitcnt lgkmcnt(3)
    v_mfma_f32_32x32x16_bf16 v[192:207], v[116:119], v[212:215], v[192:207]
    ds_read_b128 v[212:215], v15 offset:29696
    s_waitcnt lgkmcnt(3)
    v_mfma_f32_32x32x16_bf16 v[192:207], v[120:123], v[216:219], v[192:207]
    ds_read_b128 v[216:219], v15 offset:30720
    s_waitcnt lgkmcnt(3)
    v_mfma_f32_32x32x16_bf16 v[192:207], v[124:127], v[220:223], v[192:207]
    ds_read_b128 v[220:223], v15 offset:31744
    s_waitcnt lgkmcnt(3)
    v_mfma_f32_32x32x16_bf16 v[192:207], v[128:131], v[208:211], v[192:207]
    s_waitcnt lgkmcnt(2)
    v_mfma_f32_32x32x16_bf16 v[192:207], v[132:135], v[212:215], v[192:207]
    s_waitcnt lgkmcnt(1)
    v_mfma_f32_32x32x16_bf16 v[192:207], v[136:139], v[216:219], v[192:207]
    s_waitcnt lgkmcnt(0)
    v_mfma_f32_32x32x16_bf16 v[192:207], v[140:143], v[220:223], v[192:207]
    s_waitcnt vmcnt(0)
    s_barrier
    ds_read_b128 v[208:211], v15 offset:32768
    ds_read_b128 v[212:215], v15 offset:33792
    ds_read_b128 v[216:219], v15 offset:34816
    ds_read_b128 v[220:223], v15 offset:35840
    s_waitcnt lgkmcnt(3)
    v_mfma_f32_32x32x16_bf16 v[192:207], v[144:147], v[208:211], v[192:207]
    ds_read_b128 v[208:211], v15 offset:36864
    s_waitcnt lgkmcnt(3)
    v_mfma_f32_32x32x16_bf16 v[192:207], v[148:151], v[212:215], v[192:207]
    ds_read_b128 v[212:215], v15 offset:37888
    s_waitcnt lgkmcnt(3)
    v_mfma_f32_32x32x16_bf16 v[192:207], v[152:155], v[216:219], v[192:207]
    ds_read_b128 v[216:219], v15 offset:38912
    s_waitcnt lgkmcnt(3)
    v_mfma_f32_32x32x16_bf16 v[192:207], v[156:159], v[220:223], v[192:207]
    ds_read_b128 v[220:223], v15 offset:39936
    s_waitcnt lgkmcnt(3)
    v_mfma_f32_32x32x16_bf16 v[192:207], v[160:163], v[208:211], v[192:207]
    ds_read_b128 v[208:211], v15 offset:40960
    s_waitcnt lgkmcnt(3)
    v_mfma_f32_32x32x16_bf16 v[192:207], v[164:167], v[212:215], v[192:207]
    ds_read_b128 v[212:215], v15 offset:41984
    s_waitcnt lgkmcnt(3)
    v_mfma_f32_32x32x16_bf16 v[192:207], v[168:171], v[216:219], v[192:207]
    ds_read_b128 v[216:219], v15 offset:43008
    s_waitcnt lgkmcnt(3)
    v_mfma_f32_32x32x16_bf16 v[192:207], v[172:175], v[220:223], v[192:207]
    s_waitcnt lgkmcnt(2)
    v_mfma_f32_32x32x16_bf16 v[192:207], v[176:179], v[208:211], v[192:207]
    s_waitcnt lgkmcnt(1)
    v_mfma_f32_32x32x16_bf16 v[192:207], v[180:183], v[212:215], v[192:207]
    s_waitcnt lgkmcnt(0)
    v_mfma_f32_32x32x16_bf16 v[192:207], v[184:187], v[216:219], v[192:207]
    s_lshl_b32 s53, s50, 1
    s_add_u32 s54, s53, s51
    s_xor_b32 s55, s54, 1
    s_lshl_b32 s54, s54, 11
    s_lshl_b32 s55, s55, 11
    v_lshlrev_b32 v6, 4, v1
    v_add_u32 v7, s55, v6
    v_add_u32 v6, s54, v6
    v_add_u32 v7, 99328, v7
    v_add_u32 v6, 99328, v6
    s_cmp_eq_u32 s51, 0
    s_cbranch_scc0 L_m_RH55_k1
    ds_write_b128 v7, v[200:203] offset:0
    ds_write_b128 v7, v[204:207] offset:1024
    s_branch L_m_RH55_j
L_m_RH55_k1:
    ds_write_b128 v7, v[192:195] offset:0
    ds_write_b128 v7, v[196:199] offset:1024
    v_mov_b32 v192, v200
    v_mov_b32 v193, v201
    v_mov_b32 v194, v202
    v_mov_b32 v195, v203
    v_mov_b32 v196, v204
    v_mov_b32 v197, v205
    v_mov_b32 v198, v206
    v_mov_b32 v199, v207
L_m_RH55_j:
    s_waitcnt lgkmcnt(0)
    s_barrier
    ds_read_b128 v[200:203], v6 offset:0
    ds_read_b128 v[204:207], v6 offset:1024
    s_waitcnt lgkmcnt(0)
    v_pk_add_f32 v[192:193], v[192:193], v[200:201]
    v_pk_add_f32 v[194:195], v[194:195], v[202:203]
    v_pk_add_f32 v[196:197], v[196:197], v[204:205]
    v_pk_add_f32 v[198:199], v[198:199], v[206:207]
    v_cvt_pk_bf16_f32 v200, v192, v193
    v_cvt_pk_bf16_f32 v201, v194, v195
    v_cvt_pk_bf16_f32 v202, v196, v197
    v_cvt_pk_bf16_f32 v203, v198, v199
    s_nop 0
    v_permlane32_swap_b32 v200, v202
    v_permlane32_swap_b32 v201, v203
    s_lshl_b32 s53, s50, 2
    s_lshl_b32 s54, s51, 1
    s_add_u32 s53, s53, s54
    v_add_u32 v6, s53, v3
    v_and_b32 v7, 15, v2
    v_xor_b32 v6, v6, v7
    v_lshlrev_b32 v6, 4, v6
    v_lshl_add_u32 v6, v2, 8, v6
    ds_write_b128 v6, v[200:203]
    v_lshrrev_b32 v7, 4, v0
    v_and_b32 v8, 15, v0
    v_and_b32 v9, 15, v7
    v_xor_b32 v9, v9, v8
    v_lshlrev_b32 v9, 4, v9
    v_lshl_add_u32 v9, v7, 8, v9
    v_lshlrev_b32 v7, 15, v7
    v_lshl_add_u32 v7, v8, 4, v7
    s_and_b32 s53, s48, 1
    s_lshl_b32 s53, s53, 20
    s_lshr_b32 s54, s48, 1
    s_lshl_b32 s54, s54, 10
    s_add_u32 s53, s53, s54
    s_lshl_b32 s54, s49, 8
    s_add_u32 s53, s53, s54
    s_waitcnt lgkmcnt(0)
    s_barrier
    ds_read_b128 v[192:195], v9
    s_waitcnt lgkmcnt(0)
    buffer_store_dwordx4 v[192:195], v7, s[12:15], s53 offen sc1
L_END_m:
    s_endpgm
.section .rodata,"a"
.p2align 6
.amdhsa_kernel interleave_layers__spectral_gfnet__glu_gated_geglu__prompt_kernel
  .amdhsa_next_free_vgpr 256
  .amdhsa_next_free_sgpr 96
  .amdhsa_accum_offset 256
  .amdhsa_group_segment_fixed_size 0
  .amdhsa_kernarg_size 80
  .amdhsa_user_sgpr_count 2
  .amdhsa_user_sgpr_kernarg_segment_ptr 1
  .amdhsa_system_sgpr_workgroup_id_x 1
.end_amdhsa_kernel
```
